```python
import torch

def _softmax(x, axis=-1):
    return torch.softmax(x, dim=axis)
def _gelu(x):
    return torch.nn.functional.gelu(x, approximate="tanh")
def _silu(x):
    return torch.nn.functional.silu(x)
def _sigmoid(x):
    return torch.sigmoid(x)
def _layernorm(x, axis=-1, eps=1e-5):
    m = x.mean(dim=axis, keepdim=True)
    v = x.var(dim=axis, keepdim=True, unbiased=False)
    return (x - m) / torch.sqrt(v + eps)
def _scatter_add(tgt, idx, src, axis=0):
    return tgt.clone().index_add_(axis, idx, src)
def _segment_sum(src, seg, n):
    out = torch.zeros((n,) + src.shape[1:], dtype=src.dtype)
    return out.index_add_(0, seg, src)
def _pad(x, pw):
    flat = tuple(v for pair in reversed(pw) for v in pair)
    return torch.nn.functional.pad(x, flat)

kernel_name = 'parallel_sum__sliding_local_dilated__mixer_channel_mlp__prompt'

def setup_inputs():

    _w = (lambda a: (lambda t: t.to(torch.bfloat16) if t.is_floating_point() else t)(torch.as_tensor(a)))
    def _A_setup():
        B, S, D = 1, 2048, 448
        return {
            "x": _w((lambda *s: torch.randn(*s, dtype=torch.bfloat16) * 0.05)(B, S, D)),
            "wqkv": _w((lambda *s: torch.randn(*s, dtype=torch.bfloat16) * 0.05)(D, 3 * D)),
            "wo": _w((lambda *s: torch.randn(*s, dtype=torch.bfloat16) * 0.05)(D, D)),
        }
    _A_in = _A_setup()

    def _B_setup():
        B, S, D, F = 1, 2048, 448, 1792
        return {
            "x": _w((lambda *s: torch.randn(*s, dtype=torch.bfloat16) * 0.05)(B, S, D)),
            "w1": _w((lambda *s: torch.randn(*s, dtype=torch.bfloat16) * 3.2)(D, F) * (D ** -0.5)),
            "b1": _w((lambda *s: torch.randn(*s, dtype=torch.bfloat16) * 1.6)(F)),
            "w2": _w((lambda *s: torch.randn(*s, dtype=torch.bfloat16) * 0.2)(F, D) * (F ** -0.5)),
            "b2": _w((lambda *s: torch.randn(*s, dtype=torch.bfloat16) * 0.2)(D)),
        }
    _B_in = _B_setup()

    return {
        "A_x": _A_in["x"],
        "A_wqkv": _A_in["wqkv"],
        "A_wo": _A_in["wo"],
        "B_x": _B_in["x"],
        "B_w1": _B_in["w1"],
        "B_b1": _B_in["b1"],
        "B_w2": _B_in["w2"],
        "B_b2": _B_in["b2"],
    }

def reference(A_x, A_wqkv, A_wo, B_x, B_w1, B_b1, B_w2, B_b2):
    def _A_ref(x, wqkv, wo):
        B, S, D = x.shape
        H = 16; Dh = D // H
        W, dil = 8, 2
        qkv = (lambda x, *d: x.permute(*d))((x @ wqkv).reshape(B, S, 3, H, Dh), 2, 0, 3, 1, 4)
        q, k, v = qkv[0], qkv[1], qkv[2]
        scale = Dh ** -0.5
        pos = torch.arange(S)
        off = torch.arange(W) * dil
        idx = pos[:, None] - off[None, :]
        mask = idx >= 0
        idx_c = torch.where(mask, idx, 0).reshape(-1)
        kg = k[:, :, idx_c, :].reshape(B, H, S, W, Dh)
        vg = v[:, :, idx_c, :].reshape(B, H, S, W, Dh)
        logits = torch.einsum("bhsd,bhswd->bhsw", q, kg) * scale
        logits = torch.where(mask[None, None, :, :], logits, -1e9)
        attn = _softmax(logits, axis=-1)
        o = torch.einsum("bhsw,bhswd->bhsd", attn, vg)
        return (lambda x, *d: x.permute(*d))(o, 0, 2, 1, 3).reshape(B, S, D) @ wo

    def _B_ref(x, w1, b1, w2, b2):
        y = _layernorm(x, axis=-1)
        h = _gelu(torch.einsum("bsd,df->bsf", y, w1) + b1)
        return torch.einsum("bsf,fd->bsd", h, w2) + b2

    x = A_x
    xn = _layernorm(x, axis=-1)
    return x + _A_ref(xn, A_wqkv, A_wo) + _B_ref(xn, B_w1, B_b1, B_w2, B_b2)
```

```asm
; @launch grid=(248,1,1) block=(256,1,1) lds=163840
.amdgcn_target "amdgcn-amd-amdhsa--gfx950"
.text
.globl parallel_sum__sliding_local_dilated__mixer_channel_mlp__prompt_kernel
.p2align 8
.type parallel_sum__sliding_local_dilated__mixer_channel_mlp__prompt_kernel,@function
parallel_sum__sliding_local_dilated__mixer_channel_mlp__prompt_kernel:
Lcode_beg:
    s_cmp_ge_u32 s2, 240
    s_cbranch_scc1 Lextra
    s_load_dwordx2 s[4:5], s[0:1], 0
    s_load_dwordx2 s[8:9], s[0:1], 32
    s_load_dwordx2 s[100:101], s[0:1], 8
    v_lshrrev_b32 v1, 6, v0
    s_lshr_b32 s46, s2, 4
    s_bfe_u32 s49, s2, 0x10003
    v_readfirstlane_b32 s44, v1
    s_and_b32 s50, s2, 7
    s_lshl1_add_u32 s45, s50, s49
    s_cmp_ge_u32 s46, 7
    s_cselect_b32 s51, 7, 0
    s_addc_u32 s47, s45, s45
    s_sub_u32 s48, s46, s51
    s_mul_i32 s78, s44, 40960
    v_and_b32 v1, 63, v0
    s_mov_b32 s6, 1835008
    s_mov_b32 s7, 0x00020000
    s_mov_b32 s10, 1605632
    s_mov_b32 s11, 0x00020000
    s_getpc_b64 s[40:41]
Lpc0:
    s_sub_u32 s40, s40, Lpc0-Lcode_beg
    s_subb_u32 s41, s41, 0
    s_lshr_b32 s42, s2, 3
    v_lshlrev_b32 v14, 4, v0
    v_lshl_add_u32 v14, s42, 12, v14
    v_min_u32 v14, Lcode_end-Lcode_beg-4, v14
    global_load_dword v15, v14, s[40:41]
    s_cmp_ge_u32 s46, 7
    s_cbranch_scc1 Lk1_qkv
    s_and_b32 s49, s45, 1
    s_mul_i32 s49, s49, 3
    s_add_u32 s49, s49, s46
    s_cmp_ge_u32 s49, 7
    s_cselect_b32 s50, 7, 0
    s_sub_u32 s49, s49, s50
    s_lshl_b32 s66, s49, 7
    s_lshl_b32 s49, s45, 7
    s_lshr_b32 s50, s44, 1
    s_lshl_b32 s50, s50, 6
    s_add_u32 s49, s49, s50
    s_and_b32 s50, s44, 1
    s_add_u32 s49, s49, s50
    s_mul_i32 s49, s49, 896
    v_lshrrev_b32 v16, 3, v1
    v_mul_u32_u24 v19, 1792, v16
    v_lshrrev_b32 v17, 4, v1
    v_and_b32 v18, 7, v1
    v_xor_b32 v18, v18, v17
    v_lshlrev_b32 v18, 4, v18
    v_add3_u32 v180, v19, v18, s49
    v_xor_b32 v181, 64, v180
    s_mov_b32 m0, s78
    v_add_u32 v181, 13312, v181
    v_add_u32 v182, 26624, v180
    v_add_u32 v183, 26624, v181
    s_waitcnt lgkmcnt(0)
    buffer_load_dwordx4 v180, s[4:7], s66 offen offset:0 lds
    v_lshrrev_b32 v17, 2, v1
    v_mul_u32_u24 v17, 3584, v17
    v_and_b32 v16, 1, v16
    v_lshlrev_b32 v16, 1, v16
    buffer_load_dwordx4 v181, s[4:7], s66 offen offset:1024 lds
    v_and_b32 v18, 3, v1
    v_xor_b32 v16, v16, v18
    s_lshl_b32 s49, s46, 9
    buffer_load_dwordx4 v182, s[4:7], s66 offen offset:2048 lds
    s_lshl_b32 s50, s44, 6
    s_add_u32 s49, s49, s50
    v_lshlrev_b32 v16, 4, v16
    v_add3_u32 v184, v17, v16, s49
    buffer_load_dwordx4 v183, s[4:7], s66 offen offset:3072 lds
    v_add_u32 v185, 56320, v184
    v_add_u32 v186, 112640, v184
    v_add_u32 v187, 168960, v184
    s_add_u32 m0, s78, 28672
    s_mul_i32 s73, s66, 1792
    buffer_load_dwordx4 v184, s[8:11], s73 offen offset:0 lds
    s_add_u32 s67, s66, 128
    s_cmp_eq_u32 s67, 896
    s_cselect_b32 s67, 0, s67
    buffer_load_dwordx4 v185, s[8:11], s73 offen offset:1024 lds
    s_add_u32 s68, s67, 128
    s_cmp_eq_u32 s68, 896
    s_cselect_b32 s68, 0, s68
    buffer_load_dwordx4 v186, s[8:11], s73 offen offset:2048 lds
    s_add_u32 s69, s68, 128
    s_cmp_eq_u32 s69, 896
    s_cselect_b32 s69, 0, s69
    buffer_load_dwordx4 v187, s[8:11], s73 offen offset:3072 lds
    s_add_u32 s70, s69, 128
    s_cmp_eq_u32 s70, 896
    s_cselect_b32 s70, 0, s70
    s_add_u32 m0, s78, 4096
    s_add_u32 s71, s70, 128
    s_cmp_eq_u32 s71, 896
    s_cselect_b32 s71, 0, s71
    s_add_u32 s72, s71, 128
    s_cmp_eq_u32 s72, 896
    s_cselect_b32 s72, 0, s72
    buffer_load_dwordx4 v180, s[4:7], s67 offen offset:0 lds
    v_and_b32 v16, 31, v1
    v_lshlrev_b32 v16, 7, v16
    v_bfe_u32 v17, v1, 1, 3
    v_lshrrev_b32 v18, 5, v1
    v_xor_b32 v17, v17, v18
    buffer_load_dwordx4 v181, s[4:7], s67 offen offset:1024 lds
    v_lshl_add_u32 v16, v17, 4, v16
    v_add_u32 v164, s78, v16
    v_xor_b32 v165, 32, v164
    v_xor_b32 v166, 64, v164
    v_xor_b32 v167, 96, v164
    buffer_load_dwordx4 v182, s[4:7], s67 offen offset:2048 lds
    s_xor_b32 s49, s44, 1
    s_mul_i32 s49, s49, 40960
    v_add_u32 v168, s49, v16
    v_xor_b32 v169, 32, v168
    v_xor_b32 v170, 64, v168
    buffer_load_dwordx4 v183, s[4:7], s67 offen offset:3072 lds
    v_xor_b32 v171, 96, v168
    s_xor_b32 s49, s44, 2
    s_mul_i32 s49, s49, 40960
    v_add_u32 v172, s49, v16
    s_add_u32 m0, s78, 32768
    s_mul_i32 s73, s67, 1792
    buffer_load_dwordx4 v184, s[8:11], s73 offen offset:0 lds
    v_xor_b32 v173, 32, v172
    v_xor_b32 v174, 64, v172
    v_xor_b32 v175, 96, v172
    s_xor_b32 s49, s44, 3
    s_mul_i32 s49, s49, 40960
    buffer_load_dwordx4 v185, s[8:11], s73 offen offset:1024 lds
    v_add_u32 v176, s49, v16
    v_xor_b32 v177, 32, v176
    v_xor_b32 v178, 64, v176
    v_xor_b32 v179, 96, v176
    v_bfe_u32 v16, v1, 2, 2
    buffer_load_dwordx4 v186, s[8:11], s73 offen offset:2048 lds
    v_lshl_add_u32 v17, v18, 3, v16
    v_lshlrev_b32 v17, 6, v17
    v_lshrrev_b32 v16, 1, v16
    v_bfe_u32 v19, v1, 4, 1
    v_xor_b32 v16, v16, v19
    buffer_load_dwordx4 v187, s[8:11], s73 offen offset:3072 lds
    v_lshl_add_u32 v17, v16, 5, v17
    v_and_b32 v16, 3, v1
    v_lshl_add_u32 v17, v16, 3, v17
    s_add_u32 s49, s78, 28672
    v_add_u32 v188, s49, v17
    s_load_dwordx2 s[28:29], s[0:1], 40
    s_mov_b32 s30, 3584
    s_mov_b32 s31, 0x00020000
    s_load_dwordx2 s[20:21], s[0:1], 80
    s_mov_b32 s22, 268435456
    s_mov_b32 s23, 0x00020000
    s_load_dwordx2 s[16:17], s[0:1], 16
    s_mov_b32 s18, 401408
    s_mov_b32 s19, 0x00020000
    s_load_dwordx2 s[12:13], s[0:1], 48
    s_mov_b32 s14, 1605632
    s_mov_b32 s15, 0x00020000
    s_load_dwordx2 s[32:33], s[0:1], 56
    s_mov_b32 s34, 896
    s_mov_b32 s35, 0x00020000
    s_load_dwordx2 s[24:25], s[0:1], 64
    s_mov_b32 s26, 1835008
    s_mov_b32 s27, 0x00020000
    s_load_dwordx2 s[36:37], s[0:1], 72
    s_mov_b32 s38, 256
    s_mov_b32 s39, 0x00020000
    s_mov_b32 s77, 0x8000
    s_lshl_b32 s49, s46, 9
    s_lshl_b32 s50, s44, 6
    s_add_u32 s49, s49, s50
    v_and_b32 v16, 31, v1
    v_lshl_add_u32 v16, v16, 1, s49
    v_and_b32 v17, 32, v1
    v_lshl_add_u32 v16, v17, 12, v16
    s_waitcnt lgkmcnt(0)
    buffer_load_ushort v218, v16, s[28:31], 0 offen
    buffer_load_ushort v222, v16, s[28:31], 0 offen offset:256
    v_lshrrev_b32 v18, 2, v1
    v_xor_b32 v18, v18, v1
    v_and_b32 v18, 4, v18
    v_and_or_b32 v18, v1, 3, v18
    v_mov_b32 v17, 0x3f803f80
    v_cmp_eq_u32 vcc, 0, v18
    s_mov_b32 s74, -1
    s_mov_b32 s75, 0
    v_cndmask_b32 v212, 0, v17, vcc
    s_movk_i32 s3, 16384
    v_mov_b32 v213, v212
    v_mov_b32 v214, v212
    v_mov_b32 v215, v212
    s_mul_i32 s73, s68, 1792
    s_waitcnt vmcnt(13)
    s_barrier
    ds_read_b64_tr_b16 a[160:161], v188 offset:0
    ds_read_b64_tr_b16 a[162:163], v188 offset:256
    ds_read_b128 v[144:147], v164 offset:0
    ds_read_b128 a[180:183], v168 offset:0
    ds_read_b128 a[184:187], v172 offset:0
    ds_read_b128 a[188:191], v176 offset:0
    s_waitcnt vmcnt(12) lgkmcnt(2)
    v_mfma_f32_32x32x16_bf16 v[16:31], a[160:163], v[144:147], 0
    s_add_u32 m0, s78, 28672
    ds_read_b64_tr_b16 a[164:165], v188 offset:1024
    ds_read_b64_tr_b16 a[166:167], v188 offset:1280
    buffer_load_dwordx4 v184, s[8:11], s73 offen offset:0 lds
    v_lshlrev_b32 v206, 16, v144
    v_and_b32 v207, 0xffff0000, v144
    v_mfma_f32_32x32x16_bf16 v[32:47], a[160:163], a[180:183], 0
    s_waitcnt lgkmcnt(2)
    ds_read_b128 v[148:151], v165 offset:0
    ds_read_b128 a[196:199], v169 offset:0
    v_mul_f32 v204, v206, v206
    v_mul_f32 v205, v207, v207
    v_lshlrev_b32 v208, 16, v145
    v_and_b32 v209, 0xffff0000, v145
    v_mfma_f32_32x32x16_bf16 v[48:63], a[160:163], a[184:187], 0
    s_add_u32 m0, s78, 8192
    v_fmac_f32 v204, v208, v208
    v_fmac_f32 v205, v209, v209
    v_lshlrev_b32 v206, 16, v146
    v_and_b32 v207, 0xffff0000, v146
    v_fmac_f32 v204, v206, v206
    v_fmac_f32 v205, v207, v207
    v_mfma_f32_32x32x16_bf16 v[64:79], a[160:163], a[188:191], 0
    s_waitcnt vmcnt(12) lgkmcnt(0)
    ds_read_b128 a[200:203], v173 offset:0
    ds_read_b128 a[204:207], v177 offset:0
    buffer_load_dwordx4 v180, s[4:7], s68 offen offset:0 lds
    buffer_load_dwordx4 v181, s[4:7], s68 offen offset:1024 lds
    v_mfma_f32_32x32x16_bf16 v[16:31], a[164:167], v[148:151], v[16:31]
    s_add_u32 m0, s78, 28672
    ds_read_b64_tr_b16 a[168:169], v188 offset:2048
    ds_read_b64_tr_b16 a[170:171], v188 offset:2304
    buffer_load_dwordx4 v185, s[8:11], s73 offen offset:1024 lds
    v_lshlrev_b32 v208, 16, v147
    v_and_b32 v209, 0xffff0000, v147
    v_mfma_f32_32x32x16_bf16 v[32:47], a[164:167], a[196:199], v[32:47]
    s_waitcnt lgkmcnt(2)
    ds_read_b128 v[152:155], v166 offset:0
    ds_read_b128 a[180:183], v170 offset:0
    v_fmac_f32 v204, v208, v208
    v_fmac_f32 v205, v209, v209
    v_lshlrev_b32 v206, 16, v148
    v_and_b32 v207, 0xffff0000, v148
    s_and_b32 s49, s47, 3
    v_mfma_f32_32x32x16_bf16 v[48:63], a[164:167], a[200:203], v[48:63]
    s_add_u32 m0, s78, 8192
    v_fmac_f32 v204, v206, v206
    v_fmac_f32 v205, v207, v207
    v_lshlrev_b32 v208, 16, v149
    v_and_b32 v209, 0xffff0000, v149
    v_fmac_f32 v204, v208, v208
    v_fmac_f32 v205, v209, v209
    v_mfma_f32_32x32x16_bf16 v[64:79], a[164:167], a[204:207], v[64:79]
    s_waitcnt vmcnt(14) lgkmcnt(0)
    ds_read_b128 a[184:187], v174 offset:0
    ds_read_b128 a[188:191], v178 offset:0
    buffer_load_dwordx4 v182, s[4:7], s68 offen offset:2048 lds
    buffer_load_dwordx4 v183, s[4:7], s68 offen offset:3072 lds
    s_lshl_b32 s53, s48, 15
    v_mfma_f32_32x32x16_bf16 v[16:31], a[168:171], v[152:155], v[16:31]
    s_add_u32 m0, s78, 28672
    ds_read_b64_tr_b16 a[172:173], v188 offset:3072
    ds_read_b64_tr_b16 a[174:175], v188 offset:3328
    buffer_load_dwordx4 v186, s[8:11], s73 offen offset:2048 lds
    v_lshlrev_b32 v206, 16, v150
    v_and_b32 v207, 0xffff0000, v150
    v_mfma_f32_32x32x16_bf16 v[32:47], a[168:171], a[180:183], v[32:47]
    s_waitcnt lgkmcnt(2)
    ds_read_b128 v[156:159], v167 offset:0
    ds_read_b128 a[196:199], v171 offset:0
    v_fmac_f32 v204, v206, v206
    v_fmac_f32 v205, v207, v207
    v_lshlrev_b32 v208, 16, v151
    v_and_b32 v209, 0xffff0000, v151
    s_add_u32 s49, s49, s48
    v_mfma_f32_32x32x16_bf16 v[48:63], a[168:171], a[184:187], v[48:63]
    s_add_u32 m0, s78, 12288
    v_fmac_f32 v204, v208, v208
    v_fmac_f32 v205, v209, v209
    v_lshlrev_b32 v206, 16, v152
    v_and_b32 v207, 0xffff0000, v152
    v_fmac_f32 v204, v206, v206
    v_fmac_f32 v205, v207, v207
    v_mfma_f32_32x32x16_bf16 v[64:79], a[168:171], a[188:191], v[64:79]
    s_waitcnt vmcnt(12) lgkmcnt(0)
    ds_read_b128 a[200:203], v175 offset:0
    ds_read_b128 a[204:207], v179 offset:0
    buffer_load_dwordx4 v180, s[4:7], s69 offen offset:0 lds
    buffer_load_dwordx4 v181, s[4:7], s69 offen offset:1024 lds
    s_add_u32 s62, s49, 0
    v_mfma_f32_16x16x32_bf16 v[196:199], v[212:215], a[160:163], 0
    s_and_b32 s62, s62, 3
    v_lshlrev_b32 v208, 16, v153
    v_and_b32 v209, 0xffff0000, v153
    v_mfma_f32_16x16x32_bf16 v[192:195], v[212:215], v[144:147], 0
    s_add_u32 s63, s49, 1
    v_fmac_f32 v204, v208, v208
    v_fmac_f32 v205, v209, v209
    s_and_b32 s63, s63, 3
    v_mfma_f32_16x16x32_bf16 v[196:199], v[212:215], a[164:167], v[196:199]
    s_add_u32 s64, s49, 2
    v_lshlrev_b32 v206, 16, v154
    v_and_b32 v207, 0xffff0000, v154
    v_mfma_f32_16x16x32_bf16 v[192:195], v[212:215], v[148:151], v[192:195]
    s_and_b32 s64, s64, 3
    v_fmac_f32 v204, v206, v206
    v_fmac_f32 v205, v207, v207
    s_add_u32 s65, s49, 3
    v_mfma_f32_16x16x32_bf16 v[196:199], v[212:215], a[168:171], v[196:199]
    s_and_b32 s65, s65, 3
    v_lshlrev_b32 v208, 16, v155
    v_and_b32 v209, 0xffff0000, v155
    v_mfma_f32_16x16x32_bf16 v[192:195], v[212:215], v[152:155], v[192:195]
    s_and_b32 s61, s45, 1
    v_fmac_f32 v204, v208, v208
    v_fmac_f32 v205, v209, v209
    s_mul_i32 s61, s61, 65536
    v_mfma_f32_16x16x32_bf16 v[196:199], v[212:215], a[172:175], v[196:199]
    s_add_u32 s61, s61, 32768
    v_lshlrev_b32 v206, 16, v156
    v_and_b32 v207, 0xffff0000, v156
    s_add_u32 s54, s53, s61
    v_mfma_f32_16x16x32_bf16 v[192:195], v[212:215], v[156:159], v[192:195]
    v_fmac_f32 v204, v206, v206
    v_fmac_f32 v205, v207, v207
    v_mfma_f32_32x32x16_bf16 v[16:31], a[172:175], v[156:159], v[16:31]
    s_add_u32 m0, s78, 28672
    ds_read_b64_tr_b16 a[160:161], v188 offset:4096
    ds_read_b64_tr_b16 a[162:163], v188 offset:4352
    buffer_load_dwordx4 v187, s[8:11], s73 offen offset:3072 lds
    v_lshlrev_b32 v208, 16, v157
    v_and_b32 v209, 0xffff0000, v157
    v_mfma_f32_32x32x16_bf16 v[32:47], a[172:175], a[196:199], v[32:47]
    s_waitcnt lgkmcnt(2)
    s_barrier
    ds_read_b128 v[144:147], v164 offset:4096
    ds_read_b128 a[180:183], v168 offset:4096
    v_fmac_f32 v204, v208, v208
    v_fmac_f32 v205, v209, v209
    v_lshlrev_b32 v206, 16, v158
    v_mfma_f32_32x32x16_bf16 v[48:63], a[172:175], a[200:203], v[48:63]
    s_add_u32 m0, s78, 12288
    s_mul_i32 s73, s69, 1792
    v_and_b32 v207, 0xffff0000, v158
    v_fmac_f32 v204, v206, v206
    v_fmac_f32 v205, v207, v207
    v_lshlrev_b32 v208, 16, v159
    v_and_b32 v209, 0xffff0000, v159
    s_cmp_ge_u32 s54, 229376
    s_cselect_b32 s50, 229376, 0
    v_mfma_f32_32x32x16_bf16 v[64:79], a[172:175], a[204:207], v[64:79]
    s_waitcnt vmcnt(14) lgkmcnt(0)
    ds_read_b128 a[184:187], v172 offset:4096
    ds_read_b128 a[188:191], v176 offset:4096
    buffer_load_dwordx4 v182, s[4:7], s69 offen offset:2048 lds
    buffer_load_dwordx4 v183, s[4:7], s69 offen offset:3072 lds
    v_mfma_f32_32x32x16_bf16 v[16:31], a[160:163], v[144:147], v[16:31]
    s_add_u32 m0, s78, 32768
    ds_read_b64_tr_b16 a[164:165], v188 offset:5120
    ds_read_b64_tr_b16 a[166:167], v188 offset:5376
    buffer_load_dwordx4 v184, s[8:11], s73 offen offset:0 lds
    v_fmac_f32 v204, v208, v208
    v_fmac_f32 v205, v209, v209
    s_sub_u32 s54, s54, s50
    v_mfma_f32_32x32x16_bf16 v[32:47], a[160:163], a[180:183], v[32:47]
    s_waitcnt lgkmcnt(2)
    ds_read_b128 v[148:151], v165 offset:4096
    ds_read_b128 a[196:199], v169 offset:4096
    v_lshlrev_b32 v206, 16, v144
    v_and_b32 v207, 0xffff0000, v144
    v_fmac_f32 v204, v206, v206
    v_fmac_f32 v205, v207, v207
    v_mfma_f32_32x32x16_bf16 v[48:63], a[160:163], a[184:187], v[48:63]
    s_add_u32 m0, s78, 16384
    v_lshlrev_b32 v208, 16, v145
    v_and_b32 v209, 0xffff0000, v145
    v_fmac_f32 v204, v208, v208
    v_fmac_f32 v205, v209, v209
    v_lshlrev_b32 v206, 16, v146
    v_and_b32 v207, 0xffff0000, v146
    s_add_u32 s55, s54, s61
    v_mfma_f32_32x32x16_bf16 v[64:79], a[160:163], a[188:191], v[64:79]
    s_waitcnt vmcnt(16) lgkmcnt(0)
    ds_read_b128 a[200:203], v173 offset:4096
    ds_read_b128 a[204:207], v177 offset:4096
    buffer_load_dwordx4 v180, s[4:7], s70 offen offset:0 lds
    v_fmac_f32 v204, v206, v206
    v_fmac_f32 v205, v207, v207
    v_mfma_f32_32x32x16_bf16 v[16:31], a[164:167], v[148:151], v[16:31]
    s_add_u32 m0, s78, 32768
    ds_read_b64_tr_b16 a[168:169], v188 offset:6144
    ds_read_b64_tr_b16 a[170:171], v188 offset:6400
    buffer_load_dwordx4 v185, s[8:11], s73 offen offset:1024 lds
    v_lshlrev_b32 v208, 16, v147
    v_and_b32 v209, 0xffff0000, v147
    s_lshl_b32 s51, s47, 6
    v_mfma_f32_32x32x16_bf16 v[32:47], a[164:167], a[196:199], v[32:47]
    s_waitcnt lgkmcnt(2)
    ds_read_b128 v[152:155], v166 offset:4096
    ds_read_b128 a[180:183], v170 offset:4096
    v_fmac_f32 v204, v208, v208
    v_fmac_f32 v205, v209, v209
    v_lshlrev_b32 v206, 16, v148
    v_and_b32 v207, 0xffff0000, v148
    v_mfma_f32_32x32x16_bf16 v[48:63], a[164:167], a[200:203], v[48:63]
    s_add_u32 m0, s78, 16384
    v_fmac_f32 v204, v206, v206
    v_fmac_f32 v205, v207, v207
    v_lshlrev_b32 v208, 16, v149
    v_and_b32 v209, 0xffff0000, v149
    v_fmac_f32 v204, v208, v208
    v_fmac_f32 v205, v209, v209
    s_cmp_ge_u32 s55, 229376
    s_cselect_b32 s50, 229376, 0
    v_mfma_f32_32x32x16_bf16 v[64:79], a[164:167], a[204:207], v[64:79]
    s_waitcnt vmcnt(17) lgkmcnt(0)
    ds_read_b128 a[184:187], v174 offset:4096
    ds_read_b128 a[188:191], v178 offset:4096
    buffer_load_dwordx4 v181, s[4:7], s70 offen offset:1024 lds
    v_lshlrev_b32 v206, 16, v150
    v_and_b32 v207, 0xffff0000, v150
    v_mfma_f32_32x32x16_bf16 v[16:31], a[168:171], v[152:155], v[16:31]
    s_add_u32 m0, s78, 32768
    ds_read_b64_tr_b16 a[172:173], v188 offset:7168
    ds_read_b64_tr_b16 a[174:175], v188 offset:7424
    buffer_load_dwordx4 v186, s[8:11], s73 offen offset:2048 lds
    v_fmac_f32 v204, v206, v206
    v_fmac_f32 v205, v207, v207
    s_sub_u32 s55, s55, s50
    v_mfma_f32_32x32x16_bf16 v[32:47], a[168:171], a[180:183], v[32:47]
    s_waitcnt lgkmcnt(2)
    ds_read_b128 v[156:159], v167 offset:4096
    ds_read_b128 a[196:199], v171 offset:4096
    v_lshlrev_b32 v208, 16, v151
    v_and_b32 v209, 0xffff0000, v151
    v_fmac_f32 v204, v208, v208
    v_fmac_f32 v205, v209, v209
    s_add_u32 s56, s55, s61
    s_and_b32 s52, s44, 1
    v_mfma_f32_32x32x16_bf16 v[48:63], a[168:171], a[184:187], v[48:63]
    s_add_u32 m0, s78, 16384
    v_lshlrev_b32 v206, 16, v152
    v_and_b32 v207, 0xffff0000, v152
    v_fmac_f32 v204, v206, v206
    v_fmac_f32 v205, v207, v207
    v_lshlrev_b32 v208, 16, v153
    v_and_b32 v209, 0xffff0000, v153
    v_mfma_f32_32x32x16_bf16 v[64:79], a[168:171], a[188:191], v[64:79]
    s_waitcnt vmcnt(16) lgkmcnt(0)
    ds_read_b128 a[200:203], v175 offset:4096
    ds_read_b128 a[204:207], v179 offset:4096
    buffer_load_dwordx4 v182, s[4:7], s70 offen offset:2048 lds
    v_fmac_f32 v204, v208, v208
    v_fmac_f32 v205, v209, v209
    v_mfma_f32_16x16x32_bf16 v[196:199], v[212:215], a[160:163], v[196:199]
    s_cmp_ge_u32 s56, 229376
    s_cselect_b32 s50, 229376, 0
    v_lshlrev_b32 v206, 16, v154
    v_and_b32 v207, 0xffff0000, v154
    v_mfma_f32_16x16x32_bf16 v[192:195], v[212:215], v[144:147], v[192:195]
    s_sub_u32 s56, s56, s50
    v_fmac_f32 v204, v206, v206
    v_fmac_f32 v205, v207, v207
    s_add_u32 s57, s56, s61
    v_mfma_f32_16x16x32_bf16 v[196:199], v[212:215], a[164:167], v[196:199]
    s_add_u32 s51, s51, s52
    v_lshlrev_b32 v208, 16, v155
    v_and_b32 v209, 0xffff0000, v155
    s_mul_i32 s51, s51, 896
    v_mfma_f32_16x16x32_bf16 v[192:195], v[212:215], v[148:151], v[192:195]
    s_cmp_ge_u32 s57, 229376
    s_cselect_b32 s50, 229376, 0
    v_fmac_f32 v204, v208, v208
    v_fmac_f32 v205, v209, v209
    v_mfma_f32_16x16x32_bf16 v[196:199], v[212:215], a[168:171], v[196:199]
    s_sub_u32 s57, s57, s50
    v_lshlrev_b32 v206, 16, v156
    v_and_b32 v207, 0xffff0000, v156
    v_mfma_f32_16x16x32_bf16 v[192:195], v[212:215], v[152:155], v[192:195]
    s_add_u32 s58, s57, s61
    v_fmac_f32 v204, v206, v206
    v_fmac_f32 v205, v207, v207
    v_mfma_f32_16x16x32_bf16 v[196:199], v[212:215], a[172:175], v[196:199]
    s_cmp_ge_u32 s58, 229376
    s_cselect_b32 s50, 229376, 0
    v_lshlrev_b32 v208, 16, v157
    v_and_b32 v209, 0xffff0000, v157
    v_mfma_f32_16x16x32_bf16 v[192:195], v[212:215], v[156:159], v[192:195]
    s_sub_u32 s58, s58, s50
    v_fmac_f32 v204, v208, v208
    v_fmac_f32 v205, v209, v209
    s_add_u32 s59, s58, s61
    v_and_b32 v80, 31, v1
    v_mfma_f32_32x32x16_bf16 v[16:31], a[172:175], v[156:159], v[16:31]
    s_add_u32 m0, s78, 32768
    ds_read_b64_tr_b16 a[160:161], v188 offset:0
    ds_read_b64_tr_b16 a[162:163], v188 offset:256
    buffer_load_dwordx4 v187, s[8:11], s73 offen offset:3072 lds
    v_lshlrev_b32 v206, 16, v158
    v_and_b32 v207, 0xffff0000, v158
    v_mfma_f32_32x32x16_bf16 v[32:47], a[172:175], a[196:199], v[32:47]
    s_waitcnt vmcnt(13) lgkmcnt(2)
    s_barrier
    ds_read_b128 v[144:147], v164 offset:8192
    ds_read_b128 a[180:183], v168 offset:8192
    v_fmac_f32 v204, v206, v206
    v_fmac_f32 v205, v207, v207
    v_lshlrev_b32 v208, 16, v159
    v_mfma_f32_32x32x16_bf16 v[48:63], a[172:175], a[200:203], v[48:63]
    s_add_u32 m0, s78, 16384
    s_mul_i32 s73, s70, 1792
    v_and_b32 v209, 0xffff0000, v159
    v_fmac_f32 v204, v208, v208
    v_fmac_f32 v205, v209, v209
    s_cmp_ge_u32 s59, 229376
    s_cselect_b32 s50, 229376, 0
    s_sub_u32 s59, s59, s50
    v_mfma_f32_32x32x16_bf16 v[64:79], a[172:175], a[204:207], v[64:79]
    s_waitcnt lgkmcnt(0)
    ds_read_b128 a[184:187], v172 offset:8192
    ds_read_b128 a[188:191], v176 offset:8192
    buffer_load_dwordx4 v183, s[4:7], s70 offen offset:3072 lds
    v_lshlrev_b32 v206, 16, v144
    v_and_b32 v207, 0xffff0000, v144
    s_mul_i32 s60, s44, 12288
    v_mul_u32_u24 v80, 1792, v80
    v_mfma_f32_32x32x16_bf16 v[16:31], a[160:163], v[144:147], v[16:31]
    s_add_u32 m0, s78, 28672
    ds_read_b64_tr_b16 a[164:165], v188 offset:1024
    ds_read_b64_tr_b16 a[166:167], v188 offset:1280
    buffer_load_dwordx4 v184, s[8:11], s73 offen offset:0 lds
    v_fmac_f32 v204, v206, v206
    v_fmac_f32 v205, v207, v207
    s_add_u32 s60, s60, 229376
    v_mfma_f32_32x32x16_bf16 v[32:47], a[160:163], a[180:183], v[32:47]
    s_waitcnt lgkmcnt(2)
    ds_read_b128 v[148:151], v165 offset:8192
    ds_read_b128 a[196:199], v169 offset:8192
    v_lshlrev_b32 v208, 16, v145
    v_and_b32 v209, 0xffff0000, v145
    v_fmac_f32 v204, v208, v208
    v_fmac_f32 v205, v209, v209
    v_mfma_f32_32x32x16_bf16 v[48:63], a[160:163], a[184:187], v[48:63]
    s_add_u32 m0, s78, 20480
    v_lshlrev_b32 v206, 16, v146
    v_and_b32 v207, 0xffff0000, v146
    v_fmac_f32 v204, v206, v206
    v_fmac_f32 v205, v207, v207
    v_lshlrev_b32 v208, 16, v147
    v_and_b32 v209, 0xffff0000, v147
    s_mul_i32 s61, s44, 71680
    v_mfma_f32_32x32x16_bf16 v[64:79], a[160:163], a[188:191], v[64:79]
    s_waitcnt vmcnt(14) lgkmcnt(0)
    ds_read_b128 a[200:203], v173 offset:8192
    ds_read_b128 a[204:207], v177 offset:8192
    buffer_load_dwordx4 v180, s[4:7], s71 offen offset:0 lds
    v_fmac_f32 v204, v208, v208
    v_fmac_f32 v205, v209, v209
    v_mfma_f32_32x32x16_bf16 v[16:31], a[164:167], v[148:151], v[16:31]
    s_add_u32 m0, s78, 28672
    ds_read_b64_tr_b16 a[168:169], v188 offset:2048
    ds_read_b64_tr_b16 a[170:171], v188 offset:2304
    buffer_load_dwordx4 v185, s[8:11], s73 offen offset:1024 lds
    v_lshlrev_b32 v206, 16, v148
    v_and_b32 v207, 0xffff0000, v148
    v_lshrrev_b32 v14, 3, v1
    v_add_u32 v80, s51, v80
    v_mfma_f32_32x32x16_bf16 v[32:47], a[164:167], a[196:199], v[32:47]
    s_waitcnt lgkmcnt(2)
    ds_read_b128 v[152:155], v166 offset:8192
    ds_read_b128 a[180:183], v170 offset:8192
    v_fmac_f32 v204, v206, v206
    v_fmac_f32 v205, v207, v207
    v_lshlrev_b32 v208, 16, v149
    v_and_b32 v209, 0xffff0000, v149
    v_mfma_f32_32x32x16_bf16 v[48:63], a[164:167], a[200:203], v[48:63]
    s_add_u32 m0, s78, 20480
    v_fmac_f32 v204, v208, v208
    v_fmac_f32 v205, v209, v209
    v_lshlrev_b32 v206, 16, v150
    v_and_b32 v207, 0xffff0000, v150
    v_fmac_f32 v204, v206, v206
    v_fmac_f32 v205, v207, v207
    v_mul_u32_u24 v2, 896, v14
    v_mfma_f32_32x32x16_bf16 v[64:79], a[164:167], a[204:207], v[64:79]
    s_waitcnt vmcnt(13) lgkmcnt(0)
    ds_read_b128 a[184:187], v174 offset:8192
    ds_read_b128 a[188:191], v178 offset:8192
    buffer_load_dwordx4 v181, s[4:7], s71 offen offset:1024 lds
    v_lshlrev_b32 v208, 16, v151
    v_and_b32 v209, 0xffff0000, v151
    v_mfma_f32_32x32x16_bf16 v[16:31], a[168:171], v[152:155], v[16:31]
    s_add_u32 m0, s78, 28672
    ds_read_b64_tr_b16 a[172:173], v188 offset:3072
    ds_read_b64_tr_b16 a[174:175], v188 offset:3328
    buffer_load_dwordx4 v186, s[8:11], s73 offen offset:2048 lds
    v_fmac_f32 v204, v208, v208
    v_fmac_f32 v205, v209, v209
    v_lshrrev_b32 v14, 2, v1
    v_mfma_f32_32x32x16_bf16 v[32:47], a[168:171], a[180:183], v[32:47]
    s_waitcnt lgkmcnt(2)
    ds_read_b128 v[156:159], v167 offset:8192
    ds_read_b128 a[196:199], v171 offset:8192
    v_lshlrev_b32 v206, 16, v152
    v_and_b32 v207, 0xffff0000, v152
    v_fmac_f32 v204, v206, v206
    v_fmac_f32 v205, v207, v207
    s_lshr_b32 s51, s44, 1
    v_mfma_f32_32x32x16_bf16 v[48:63], a[168:171], a[184:187], v[48:63]
    s_add_u32 m0, s78, 20480
    v_lshlrev_b32 v208, 16, v153
    v_and_b32 v209, 0xffff0000, v153
    v_fmac_f32 v204, v208, v208
    v_fmac_f32 v205, v209, v209
    v_lshlrev_b32 v206, 16, v154
    v_and_b32 v207, 0xffff0000, v154
    v_and_b32 v14, 4, v14
    s_and_b32 s40, s47, 1
    v_mfma_f32_32x32x16_bf16 v[64:79], a[168:171], a[188:191], v[64:79]
    s_waitcnt vmcnt(12) lgkmcnt(0)
    ds_read_b128 a[200:203], v175 offset:8192
    ds_read_b128 a[204:207], v179 offset:8192
    buffer_load_dwordx4 v182, s[4:7], s71 offen offset:2048 lds
    v_fmac_f32 v204, v206, v206
    v_fmac_f32 v205, v207, v207
    v_mfma_f32_16x16x32_bf16 v[196:199], v[212:215], a[160:163], v[196:199]
    s_lshl_b32 s51, s51, 6
    v_lshlrev_b32 v208, 16, v155
    v_and_b32 v209, 0xffff0000, v155
    v_and_b32 v3, 7, v1
    v_mfma_f32_16x16x32_bf16 v[192:195], v[212:215], v[144:147], v[192:195]
    s_lshl_b32 s52, s48, 7
    v_fmac_f32 v204, v208, v208
    v_fmac_f32 v205, v209, v209
    s_lshl3_add_u32 s43, s47, s48
    v_mfma_f32_16x16x32_bf16 v[196:199], v[212:215], a[164:167], v[196:199]
    s_add_u32 s51, s51, s52
    v_lshlrev_b32 v206, 16, v156
    v_and_b32 v207, 0xffff0000, v156
    v_xor_b32 v14, v14, v3
    v_lshrrev_b32 v81, 5, v1
    v_mfma_f32_16x16x32_bf16 v[192:195], v[212:215], v[148:151], v[192:195]
    s_sub_u32 s43, s43, s40
    v_fmac_f32 v204, v206, v206
    v_fmac_f32 v205, v207, v207
    v_lshl_add_u32 v2, v14, 4, v2
    v_mfma_f32_16x16x32_bf16 v[196:199], v[212:215], a[168:171], v[196:199]
    s_lshl_b32 s49, s48, 7
    v_lshlrev_b32 v208, 16, v157
    v_and_b32 v209, 0xffff0000, v157
    s_lshl2_add_u32 s43, s43, s44
    v_mfma_f32_16x16x32_bf16 v[192:195], v[212:215], v[152:155], v[192:195]
    s_mul_i32 s50, s44, 28672
    v_fmac_f32 v204, v208, v208
    v_fmac_f32 v205, v209, v209
    s_add_u32 s49, s49, s50
    v_mfma_f32_16x16x32_bf16 v[196:199], v[212:215], a[172:175], v[196:199]
    s_lshl_b32 s43, s43, 7
    v_lshlrev_b32 v206, 16, v158
    v_and_b32 v207, 0xffff0000, v158
    v_mfma_f32_16x16x32_bf16 v[192:195], v[212:215], v[156:159], v[192:195]
    s_add_u32 s43, s43, 12615680
    v_fmac_f32 v204, v206, v206
    v_fmac_f32 v205, v207, v207
    v_add_u32 v2, s49, v2
    v_lshl_add_u32 v81, v81, 4, s51
    s_lshl_b32 s40, s45, 6
    v_mfma_f32_32x32x16_bf16 v[16:31], a[172:175], v[156:159], v[16:31]
    s_add_u32 m0, s78, 28672
    ds_read_b64_tr_b16 a[160:161], v188 offset:4096
    ds_read_b64_tr_b16 a[162:163], v188 offset:4352
    buffer_load_dwordx4 v187, s[8:11], s73 offen offset:3072 lds
    v_lshlrev_b32 v208, 16, v159
    v_and_b32 v209, 0xffff0000, v159
    v_mfma_f32_32x32x16_bf16 v[32:47], a[172:175], a[196:199], v[32:47]
    s_waitcnt lgkmcnt(2)
    s_barrier
    ds_read_b128 v[144:147], v164 offset:12288
    ds_read_b128 a[180:183], v168 offset:12288
    v_fmac_f32 v204, v208, v208
    v_fmac_f32 v205, v209, v209
    v_add_u32 v3, 6144, v2
    v_add_u32 v4, 12288, v2
    s_add_u32 s40, s40, s44
    v_mfma_f32_32x32x16_bf16 v[48:63], a[172:175], a[200:203], v[48:63]
    s_add_u32 m0, s78, 20480
    s_mul_i32 s73, s71, 1792
    v_add_u32 v5, 18432, v2
    v_add_u32 v80, v80, v81
    s_lshl_b32 s40, s40, 5
    s_add_u32 s40, s40, s46
    s_lshl_b32 s40, s40, 2
    v_mfma_f32_32x32x16_bf16 v[64:79], a[172:175], a[204:207], v[64:79]
    s_waitcnt vmcnt(12) lgkmcnt(0)
    ds_read_b128 a[184:187], v172 offset:12288
    ds_read_b128 a[188:191], v176 offset:12288
    buffer_load_dwordx4 v183, s[4:7], s71 offen offset:3072 lds
    v_lshlrev_b32 v206, 16, v144
    v_and_b32 v207, 0xffff0000, v144
    v_mfma_f32_32x32x16_bf16 v[16:31], a[160:163], v[144:147], v[16:31]
    s_add_u32 m0, s78, 32768
    ds_read_b64_tr_b16 a[164:165], v188 offset:5120
    ds_read_b64_tr_b16 a[166:167], v188 offset:5376
    buffer_load_dwordx4 v184, s[8:11], s73 offen offset:0 lds
    v_fmac_f32 v204, v206, v206
    v_fmac_f32 v205, v207, v207
    s_add_u32 s40, s40, 12615680
    v_mfma_f32_32x32x16_bf16 v[32:47], a[160:163], a[180:183], v[32:47]
    s_waitcnt lgkmcnt(2)
    ds_read_b128 v[148:151], v165 offset:12288
    ds_read_b128 a[196:199], v169 offset:12288
    buffer_load_dwordx4 a[240:243], v80, s[4:7], 0 offen
    v_lshlrev_b32 v208, 16, v145
    v_and_b32 v209, 0xffff0000, v145
    v_fmac_f32 v204, v208, v208
    v_fmac_f32 v205, v209, v209
    v_mfma_f32_32x32x16_bf16 v[48:63], a[160:163], a[184:187], v[48:63]
    s_add_u32 m0, s78, 24576
    v_lshlrev_b32 v206, 16, v146
    v_and_b32 v207, 0xffff0000, v146
    v_fmac_f32 v204, v206, v206
    v_fmac_f32 v205, v207, v207
    v_lshlrev_b32 v208, 16, v147
    v_and_b32 v209, 0xffff0000, v147
    v_mfma_f32_32x32x16_bf16 v[64:79], a[160:163], a[188:191], v[64:79]
    s_waitcnt vmcnt(13) lgkmcnt(0)
    ds_read_b128 a[200:203], v173 offset:12288
    ds_read_b128 a[204:207], v177 offset:12288
    buffer_load_dwordx4 v180, s[4:7], s72 offen offset:0 lds
    v_fmac_f32 v204, v208, v208
    v_fmac_f32 v205, v209, v209
    v_lshl_add_u32 v11, v1, 9, s40
    v_mfma_f32_32x32x16_bf16 v[16:31], a[164:167], v[148:151], v[16:31]
    s_add_u32 m0, s78, 32768
    ds_read_b64_tr_b16 a[168:169], v188 offset:6144
    ds_read_b64_tr_b16 a[170:171], v188 offset:6400
    buffer_load_dwordx4 v185, s[8:11], s73 offen offset:1024 lds
    v_lshlrev_b32 v206, 16, v148
    v_and_b32 v207, 0xffff0000, v148
    v_mfma_f32_32x32x16_bf16 v[32:47], a[164:167], a[196:199], v[32:47]
    s_waitcnt lgkmcnt(2)
    ds_read_b128 v[152:155], v166 offset:12288
    ds_read_b128 a[180:183], v170 offset:12288
    buffer_load_dwordx4 a[244:247], v80, s[4:7], 0 offen offset:32
    v_fmac_f32 v204, v206, v206
    v_fmac_f32 v205, v207, v207
    v_lshlrev_b32 v208, 16, v149
    v_and_b32 v209, 0xffff0000, v149
    v_mfma_f32_32x32x16_bf16 v[48:63], a[164:167], a[200:203], v[48:63]
    s_add_u32 m0, s78, 24576
    v_fmac_f32 v204, v208, v208
    v_fmac_f32 v205, v209, v209
    v_lshlrev_b32 v206, 16, v150
    v_and_b32 v207, 0xffff0000, v150
    v_fmac_f32 v204, v206, v206
    v_fmac_f32 v205, v207, v207
    v_mov_b32 v12, 2146435072
    v_mfma_f32_32x32x16_bf16 v[64:79], a[164:167], a[204:207], v[64:79]
    s_waitcnt vmcnt(14) lgkmcnt(0)
    ds_read_b128 a[184:187], v174 offset:12288
    ds_read_b128 a[188:191], v178 offset:12288
    buffer_load_dwordx4 v181, s[4:7], s72 offen offset:1024 lds
    v_lshlrev_b32 v208, 16, v151
    v_and_b32 v209, 0xffff0000, v151
    v_mfma_f32_32x32x16_bf16 v[16:31], a[168:171], v[152:155], v[16:31]
    s_add_u32 m0, s78, 32768
    ds_read_b64_tr_b16 a[172:173], v188 offset:7168
    ds_read_b64_tr_b16 a[174:175], v188 offset:7424
    buffer_load_dwordx4 v186, s[8:11], s73 offen offset:2048 lds
    v_fmac_f32 v204, v208, v208
    v_fmac_f32 v205, v209, v209
    v_mfma_f32_32x32x16_bf16 v[32:47], a[168:171], a[180:183], v[32:47]
    s_waitcnt lgkmcnt(2)
    ds_read_b128 v[156:159], v167 offset:12288
    ds_read_b128 a[196:199], v171 offset:12288
    buffer_load_dwordx4 a[248:251], v81, s[32:35], 0 offen
    v_lshlrev_b32 v206, 16, v152
    v_and_b32 v207, 0xffff0000, v152
    v_fmac_f32 v204, v206, v206
    v_fmac_f32 v205, v207, v207
    v_mfma_f32_32x32x16_bf16 v[48:63], a[168:171], a[184:187], v[48:63]
    s_add_u32 m0, s78, 24576
    v_lshlrev_b32 v208, 16, v153
    v_and_b32 v209, 0xffff0000, v153
    v_fmac_f32 v204, v208, v208
    v_fmac_f32 v205, v209, v209
    v_lshlrev_b32 v206, 16, v154
    v_and_b32 v207, 0xffff0000, v154
    v_mfma_f32_32x32x16_bf16 v[64:79], a[168:171], a[188:191], v[64:79]
    s_waitcnt vmcnt(15) lgkmcnt(0)
    ds_read_b128 a[200:203], v175 offset:12288
    ds_read_b128 a[204:207], v179 offset:12288
    buffer_load_dwordx4 v182, s[4:7], s72 offen offset:2048 lds
    v_fmac_f32 v204, v206, v206
    v_fmac_f32 v205, v207, v207
    v_cmp_gt_u32 vcc, 14, v1
    s_nop 1
    v_cndmask_b32 v11, v12, v11, vcc
    v_mfma_f32_16x16x32_bf16 v[196:199], v[212:215], a[160:163], v[196:199]
    v_lshlrev_b32 v208, 16, v155
    v_and_b32 v209, 0xffff0000, v155
    v_mfma_f32_16x16x32_bf16 v[192:195], v[212:215], v[144:147], v[192:195]
    v_fmac_f32 v204, v208, v208
    v_fmac_f32 v205, v209, v209
    v_mfma_f32_16x16x32_bf16 v[196:199], v[212:215], a[164:167], v[196:199]
    v_lshlrev_b32 v206, 16, v156
    v_and_b32 v207, 0xffff0000, v156
    v_mfma_f32_16x16x32_bf16 v[192:195], v[212:215], v[148:151], v[192:195]
    v_fmac_f32 v204, v206, v206
    v_fmac_f32 v205, v207, v207
    v_mfma_f32_16x16x32_bf16 v[196:199], v[212:215], a[168:171], v[196:199]
    v_lshlrev_b32 v208, 16, v157
    v_and_b32 v209, 0xffff0000, v157
    v_mfma_f32_16x16x32_bf16 v[192:195], v[212:215], v[152:155], v[192:195]
    v_fmac_f32 v204, v208, v208
    v_fmac_f32 v205, v209, v209
    v_mfma_f32_16x16x32_bf16 v[196:199], v[212:215], a[172:175], v[196:199]
    v_lshlrev_b32 v206, 16, v158
    v_and_b32 v207, 0xffff0000, v158
    v_mfma_f32_16x16x32_bf16 v[192:195], v[212:215], v[156:159], v[192:195]
    v_fmac_f32 v204, v206, v206
    v_fmac_f32 v205, v207, v207
    v_mfma_f32_32x32x16_bf16 v[16:31], a[172:175], v[156:159], v[16:31]
    s_add_u32 m0, s78, 32768
    ds_read_b64_tr_b16 a[160:161], v188 offset:0
    ds_read_b64_tr_b16 a[162:163], v188 offset:256
    buffer_load_dwordx4 v187, s[8:11], s73 offen offset:3072 lds
    v_lshlrev_b32 v208, 16, v159
    v_and_b32 v209, 0xffff0000, v159
    v_mfma_f32_32x32x16_bf16 v[32:47], a[172:175], a[196:199], v[32:47]
    s_waitcnt lgkmcnt(2)
    s_barrier
    ds_read_b128 v[144:147], v164 offset:16384
    ds_read_b128 a[180:183], v168 offset:16384
    buffer_load_dwordx4 a[252:255], v81, s[32:35], 0 offen offset:32
    v_fmac_f32 v204, v208, v208
    v_fmac_f32 v205, v209, v209
    v_mfma_f32_32x32x16_bf16 v[48:63], a[172:175], a[200:203], v[48:63]
    s_add_u32 m0, s78, 24576
    s_mul_i32 s73, s72, 1792
    s_add_u32 s49, s78, 36864
    v_lshl_add_u32 v244, v1, 4, s49
    s_xor_b32 s49, s44, 1
    s_mul_i32 s49, s49, 40960
    s_add_u32 s49, s49, 36864
    v_mfma_f32_32x32x16_bf16 v[64:79], a[172:175], a[204:207], v[64:79]
    s_waitcnt vmcnt(16) lgkmcnt(0)
    ds_read_b128 a[184:187], v172 offset:16384
    ds_read_b128 a[188:191], v176 offset:16384
    buffer_load_dwordx4 v183, s[4:7], s72 offen offset:3072 lds
    v_lshlrev_b32 v206, 16, v144
    v_and_b32 v207, 0xffff0000, v144
    v_mfma_f32_32x32x16_bf16 v[16:31], a[160:163], v[144:147], v[16:31]
    s_add_u32 m0, s78, 28672
    ds_read_b64_tr_b16 a[164:165], v188 offset:1024
    ds_read_b64_tr_b16 a[166:167], v188 offset:1280
    buffer_load_dwordx4 v184, s[8:11], s73 offen offset:0 lds
    v_fmac_f32 v204, v206, v206
    v_fmac_f32 v205, v207, v207
    v_mfma_f32_32x32x16_bf16 v[32:47], a[160:163], a[180:183], v[32:47]
    s_waitcnt lgkmcnt(2)
    ds_read_b128 v[148:151], v165 offset:16384
    ds_read_b128 a[196:199], v169 offset:16384
    v_lshlrev_b32 v208, 16, v145
    v_and_b32 v209, 0xffff0000, v145
    v_fmac_f32 v204, v208, v208
    v_fmac_f32 v205, v209, v209
    v_mfma_f32_32x32x16_bf16 v[48:63], a[160:163], a[184:187], v[48:63]
    s_mul_i32 s40, s63, 25088
    s_add_u32 s40, s40, s61
    v_lshlrev_b32 v206, 16, v146
    v_and_b32 v207, 0xffff0000, v146
    v_fmac_f32 v204, v206, v206
    v_fmac_f32 v205, v207, v207
    v_lshlrev_b32 v208, 16, v147
    v_and_b32 v209, 0xffff0000, v147
    v_lshl_add_u32 v245, v1, 4, s49
    v_mfma_f32_32x32x16_bf16 v[64:79], a[160:163], a[188:191], v[64:79]
    s_waitcnt vmcnt(16) lgkmcnt(0)
    ds_read_b128 a[200:203], v173 offset:16384
    ds_read_b128 a[204:207], v177 offset:16384
    buffer_load_dwordx4 a[0:3], v2, s[16:19], s40 offen offset:0
    v_fmac_f32 v204, v208, v208
    v_fmac_f32 v205, v209, v209
    v_lshlrev_b32 v206, 16, v148
    v_and_b32 v207, 0xffff0000, v148
    v_mfma_f32_32x32x16_bf16 v[16:31], a[164:167], v[148:151], v[16:31]
    s_xor_b32 s49, s44, 2
    ds_read_b64_tr_b16 a[168:169], v188 offset:2048
    ds_read_b64_tr_b16 a[170:171], v188 offset:2304
    buffer_load_dwordx4 v185, s[8:11], s73 offen offset:1024 lds
    v_fmac_f32 v204, v206, v206
    v_fmac_f32 v205, v207, v207
    v_mfma_f32_32x32x16_bf16 v[32:47], a[164:167], a[196:199], v[32:47]
    s_waitcnt lgkmcnt(2)
    ds_read_b128 v[152:155], v166 offset:16384
    ds_read_b128 a[180:183], v170 offset:16384
    v_lshlrev_b32 v208, 16, v149
    v_and_b32 v209, 0xffff0000, v149
    v_fmac_f32 v204, v208, v208
    v_fmac_f32 v205, v209, v209
    v_mfma_f32_32x32x16_bf16 v[48:63], a[164:167], a[200:203], v[48:63]
    s_mul_i32 s49, s49, 40960
    v_lshlrev_b32 v206, 16, v150
    v_and_b32 v207, 0xffff0000, v150
    v_fmac_f32 v204, v206, v206
    v_fmac_f32 v205, v207, v207
    v_lshlrev_b32 v208, 16, v151
    v_and_b32 v209, 0xffff0000, v151
    v_mfma_f32_32x32x16_bf16 v[64:79], a[164:167], a[204:207], v[64:79]
    s_waitcnt vmcnt(16) lgkmcnt(0)
    ds_read_b128 a[184:187], v174 offset:16384
    ds_read_b128 a[188:191], v178 offset:16384
    buffer_load_dwordx4 a[4:7], v3, s[16:19], s40 offen offset:1024
    v_fmac_f32 v204, v208, v208
    v_fmac_f32 v205, v209, v209
    v_lshlrev_b32 v206, 16, v152
    v_and_b32 v207, 0xffff0000, v152
    v_mfma_f32_32x32x16_bf16 v[16:31], a[168:171], v[152:155], v[16:31]
    s_add_u32 s49, s49, 36864
    ds_read_b64_tr_b16 a[172:173], v188 offset:3072
    ds_read_b64_tr_b16 a[174:175], v188 offset:3328
    buffer_load_dwordx4 v186, s[8:11], s73 offen offset:2048 lds
    v_fmac_f32 v204, v206, v206
    v_fmac_f32 v205, v207, v207
    v_lshl_add_u32 v246, v1, 4, s49
    v_mfma_f32_32x32x16_bf16 v[32:47], a[168:171], a[180:183], v[32:47]
    s_waitcnt lgkmcnt(2)
    ds_read_b128 v[156:159], v167 offset:16384
    ds_read_b128 a[196:199], v171 offset:16384
    v_lshlrev_b32 v208, 16, v153
    v_and_b32 v209, 0xffff0000, v153
    v_fmac_f32 v204, v208, v208
    v_fmac_f32 v205, v209, v209
    v_mfma_f32_32x32x16_bf16 v[48:63], a[168:171], a[184:187], v[48:63]
    s_xor_b32 s49, s44, 3
    buffer_load_dword v13, off, s[36:39], 0 sc1
    v_lshlrev_b32 v206, 16, v154
    v_and_b32 v207, 0xffff0000, v154
    v_fmac_f32 v204, v206, v206
    v_fmac_f32 v205, v207, v207
    v_mfma_f32_32x32x16_bf16 v[64:79], a[168:171], a[188:191], v[64:79]
    s_waitcnt vmcnt(17) lgkmcnt(0)
    ds_read_b128 a[200:203], v175 offset:16384
    ds_read_b128 a[204:207], v179 offset:16384
    buffer_load_dwordx4 a[8:11], v4, s[16:19], s40 offen offset:2048
    v_lshlrev_b32 v208, 16, v155
    v_and_b32 v209, 0xffff0000, v155
    v_fmac_f32 v204, v208, v208
    v_fmac_f32 v205, v209, v209
    v_mfma_f32_16x16x32_bf16 v[196:199], v[212:215], a[160:163], v[196:199]
    s_mul_i32 s49, s49, 40960
    v_lshlrev_b32 v206, 16, v156
    v_and_b32 v207, 0xffff0000, v156
    v_mfma_f32_16x16x32_bf16 v[192:195], v[212:215], v[144:147], v[192:195]
    s_add_u32 s49, s49, 36864
    v_fmac_f32 v204, v206, v206
    v_fmac_f32 v205, v207, v207
    v_mfma_f32_16x16x32_bf16 v[196:199], v[212:215], a[164:167], v[196:199]
    v_lshlrev_b32 v208, 16, v157
    v_and_b32 v209, 0xffff0000, v157
    v_lshl_add_u32 v247, v1, 4, s49
    v_mfma_f32_16x16x32_bf16 v[192:195], v[212:215], v[148:151], v[192:195]
    s_mul_i32 s49, s45, 589824
    v_fmac_f32 v204, v208, v208
    v_fmac_f32 v205, v209, v209
    v_mfma_f32_16x16x32_bf16 v[196:199], v[212:215], a[168:171], v[196:199]
    s_lshl_b32 s50, s46, 15
    v_lshlrev_b32 v206, 16, v158
    v_and_b32 v207, 0xffff0000, v158
    v_mfma_f32_16x16x32_bf16 v[192:195], v[212:215], v[152:155], v[192:195]
    s_add_u32 s49, s49, s50
    v_fmac_f32 v204, v206, v206
    v_fmac_f32 v205, v207, v207
    v_mfma_f32_16x16x32_bf16 v[196:199], v[212:215], a[172:175], v[196:199]
    s_lshl_b32 s50, s44, 12
    v_lshlrev_b32 v208, 16, v159
    v_and_b32 v209, 0xffff0000, v159
    v_mfma_f32_16x16x32_bf16 v[192:195], v[212:215], v[156:159], v[192:195]
    s_add_u32 s49, s49, s50
    v_fmac_f32 v204, v208, v208
    v_fmac_f32 v205, v209, v209
    v_mfma_f32_32x32x16_bf16 v[16:31], a[172:175], v[156:159], v[16:31]
    s_mov_b32 s42, s49
    ds_read_b64_tr_b16 a[160:161], v188 offset:4096
    ds_read_b64_tr_b16 a[162:163], v188 offset:4352
    buffer_load_dwordx4 v187, s[8:11], s73 offen offset:3072 lds
    s_and_b32 s50, s44, 1
    s_lshl_b32 s50, s50, 10
    s_add_u32 s49, s49, s50
    v_mfma_f32_32x32x16_bf16 v[32:47], a[172:175], a[196:199], v[32:47]
    s_waitcnt lgkmcnt(2)
    s_barrier
    ds_read_b128 v[144:147], v164 offset:20480
    ds_read_b128 a[180:183], v168 offset:20480
    s_lshr_b32 s50, s44, 1
    s_mul_i32 s50, s50, 294912
    s_sub_u32 s51, 294912, s50
    v_mfma_f32_32x32x16_bf16 v[48:63], a[172:175], a[200:203], v[48:63]
    s_add_u32 s50, s50, s49
    s_mul_i32 s73, s66, 1792
    s_add_u32 s73, s73, 256
    s_add_u32 s51, s51, s49
    v_lshl_add_u32 v240, v1, 4, s50
    v_lshl_add_u32 v242, v1, 4, s51
    v_xor_b32 v241, 1024, v240
    v_mfma_f32_32x32x16_bf16 v[64:79], a[172:175], a[204:207], v[64:79]
    s_waitcnt vmcnt(16) lgkmcnt(0)
    ds_read_b128 a[184:187], v172 offset:20480
    ds_read_b128 a[188:191], v176 offset:20480
    buffer_load_dwordx4 a[12:15], v5, s[16:19], s40 offen offset:3072
    v_lshlrev_b32 v206, 16, v144
    v_and_b32 v207, 0xffff0000, v144
    v_fmac_f32 v204, v206, v206
    v_fmac_f32 v205, v207, v207
    v_mfma_f32_32x32x16_bf16 v[16:31], a[160:163], v[144:147], v[16:31]
    s_add_u32 m0, s78, 32768
    ds_read_b64_tr_b16 a[164:165], v188 offset:5120
    ds_read_b64_tr_b16 a[166:167], v188 offset:5376
    buffer_load_dwordx4 v184, s[8:11], s73 offen offset:0 lds
    v_lshlrev_b32 v208, 16, v145
    v_and_b32 v209, 0xffff0000, v145
    v_mfma_f32_32x32x16_bf16 v[32:47], a[160:163], a[180:183], v[32:47]
    s_waitcnt lgkmcnt(2)
    ds_read_b128 v[148:151], v165 offset:20480
    ds_read_b128 a[196:199], v169 offset:20480
    v_fmac_f32 v204, v208, v208
    v_fmac_f32 v205, v209, v209
    v_lshlrev_b32 v206, 16, v146
    v_and_b32 v207, 0xffff0000, v146
    v_mfma_f32_32x32x16_bf16 v[48:63], a[160:163], a[184:187], v[48:63]
    s_mul_i32 s40, s64, 25088
    s_add_u32 s40, s40, s61
    v_fmac_f32 v204, v206, v206
    v_fmac_f32 v205, v207, v207
    v_lshlrev_b32 v208, 16, v147
    v_and_b32 v209, 0xffff0000, v147
    v_fmac_f32 v204, v208, v208
    v_fmac_f32 v205, v209, v209
    v_xor_b32 v243, 1024, v242
    v_mfma_f32_32x32x16_bf16 v[64:79], a[160:163], a[188:191], v[64:79]
    s_waitcnt vmcnt(15) lgkmcnt(0)
    ds_read_b128 a[200:203], v173 offset:20480
    ds_read_b128 a[204:207], v177 offset:20480
    buffer_load_dwordx4 a[16:19], v2, s[16:19], s40 offen offset:0
    v_lshlrev_b32 v206, 16, v148
    v_and_b32 v207, 0xffff0000, v148
    v_fmac_f32 v204, v206, v206
    v_fmac_f32 v205, v207, v207
    v_mfma_f32_32x32x16_bf16 v[16:31], a[164:167], v[148:151], v[16:31]
    s_lshl2_add_u32 s49, s45, s44
    ds_read_b64_tr_b16 a[168:169], v188 offset:6144
    ds_read_b64_tr_b16 a[170:171], v188 offset:6400
    buffer_load_dwordx4 v185, s[8:11], s73 offen offset:1024 lds
    v_lshlrev_b32 v208, 16, v149
    v_and_b32 v209, 0xffff0000, v149
    v_mfma_f32_32x32x16_bf16 v[32:47], a[164:167], a[196:199], v[32:47]
    s_waitcnt lgkmcnt(2)
    ds_read_b128 v[152:155], v166 offset:20480
    ds_read_b128 a[180:183], v170 offset:20480
    v_fmac_f32 v204, v208, v208
    v_fmac_f32 v205, v209, v209
    v_lshlrev_b32 v206, 16, v150
    v_and_b32 v207, 0xffff0000, v150
    v_mfma_f32_32x32x16_bf16 v[48:63], a[164:167], a[200:203], v[48:63]
    s_lshl_b32 s49, s49, 6
    v_fmac_f32 v204, v206, v206
    v_fmac_f32 v205, v207, v207
    v_lshlrev_b32 v208, 16, v151
    v_and_b32 v209, 0xffff0000, v151
    v_fmac_f32 v204, v208, v208
    v_fmac_f32 v205, v209, v209
    v_mfma_f32_32x32x16_bf16 v[64:79], a[164:167], a[204:207], v[64:79]
    s_waitcnt vmcnt(14) lgkmcnt(0)
    ds_read_b128 a[184:187], v174 offset:20480
    ds_read_b128 a[188:191], v178 offset:20480
    buffer_load_dwordx4 a[20:23], v3, s[16:19], s40 offen offset:1024
    v_lshlrev_b32 v206, 16, v152
    v_and_b32 v207, 0xffff0000, v152
    v_fmac_f32 v204, v206, v206
    v_fmac_f32 v205, v207, v207
    v_mfma_f32_32x32x16_bf16 v[16:31], a[168:171], v[152:155], v[16:31]
    s_add_u32 s49, s49, s46
    ds_read_b64_tr_b16 a[172:173], v188 offset:7168
    ds_read_b64_tr_b16 a[174:175], v188 offset:7424
    buffer_load_dwordx4 v186, s[8:11], s73 offen offset:2048 lds
    v_lshlrev_b32 v208, 16, v153
    v_and_b32 v209, 0xffff0000, v153
    s_lshl_b32 s49, s49, 2
    v_mfma_f32_32x32x16_bf16 v[32:47], a[168:171], a[180:183], v[32:47]
    s_waitcnt lgkmcnt(2)
    ds_read_b128 v[156:159], v167 offset:20480
    ds_read_b128 a[196:199], v171 offset:20480
    v_fmac_f32 v204, v208, v208
    v_fmac_f32 v205, v209, v209
    v_lshlrev_b32 v206, 16, v154
    v_and_b32 v207, 0xffff0000, v154
    v_mfma_f32_32x32x16_bf16 v[48:63], a[168:171], a[184:187], v[48:63]
    s_add_u32 s49, s49, 12582912
    v_fmac_f32 v204, v206, v206
    v_fmac_f32 v205, v207, v207
    v_lshlrev_b32 v208, 16, v155
    v_and_b32 v209, 0xffff0000, v155
    v_fmac_f32 v204, v208, v208
    v_fmac_f32 v205, v209, v209
    v_mfma_f32_32x32x16_bf16 v[64:79], a[168:171], a[188:191], v[64:79]
    s_waitcnt vmcnt(13) lgkmcnt(0)
    ds_read_b128 a[200:203], v175 offset:20480
    ds_read_b128 a[204:207], v179 offset:20480
    buffer_load_dwordx4 a[24:27], v4, s[16:19], s40 offen offset:2048
    v_lshlrev_b32 v206, 16, v156
    v_and_b32 v207, 0xffff0000, v156
    v_fmac_f32 v204, v206, v206
    v_fmac_f32 v205, v207, v207
    v_mfma_f32_16x16x32_bf16 v[196:199], v[212:215], a[160:163], v[196:199]
    v_lshlrev_b32 v208, 16, v157
    v_and_b32 v209, 0xffff0000, v157
    v_mfma_f32_16x16x32_bf16 v[192:195], v[212:215], v[144:147], v[192:195]
    v_fmac_f32 v204, v208, v208
    v_fmac_f32 v205, v209, v209
    v_mfma_f32_16x16x32_bf16 v[196:199], v[212:215], a[164:167], v[196:199]
    v_lshlrev_b32 v206, 16, v158
    v_and_b32 v207, 0xffff0000, v158
    v_lshrrev_b32 v0, 1, v1
    v_mfma_f32_16x16x32_bf16 v[192:195], v[212:215], v[148:151], v[192:195]
    v_fmac_f32 v204, v206, v206
    v_fmac_f32 v205, v207, v207
    v_mfma_f32_16x16x32_bf16 v[196:199], v[212:215], a[168:171], v[196:199]
    v_lshlrev_b32 v208, 16, v159
    v_and_b32 v209, 0xffff0000, v159
    v_mfma_f32_16x16x32_bf16 v[192:195], v[212:215], v[152:155], v[192:195]
    v_fmac_f32 v204, v208, v208
    v_fmac_f32 v205, v209, v209
    v_mfma_f32_16x16x32_bf16 v[196:199], v[212:215], a[172:175], v[196:199]
    v_min_u32 v0, 1, v0
    v_mul_u32_u24 v0, 0x7ff000, v0
    v_mfma_f32_16x16x32_bf16 v[192:195], v[212:215], v[156:159], v[192:195]
    v_lshl_add_u32 v0, v0, 8, s49
    v_mul_u32_u24 v14, 28, v1
    v_mfma_f32_32x32x16_bf16 v[16:31], a[172:175], v[156:159], v[16:31]
    ds_read_b64_tr_b16 a[160:161], v188 offset:0
    ds_read_b64_tr_b16 a[162:163], v188 offset:256
    buffer_load_dwordx4 v187, s[8:11], s73 offen offset:3072 lds
    v_sub_u32 v0, v0, v14
    v_mfma_f32_32x32x16_bf16 v[32:47], a[172:175], a[196:199], v[32:47]
    s_waitcnt lgkmcnt(2)
    s_barrier
    ds_read_b128 v[144:147], v164 offset:24576
    ds_read_b128 a[180:183], v168 offset:24576
    v_mfma_f32_32x32x16_bf16 v[48:63], a[172:175], a[200:203], v[48:63]
    s_mul_i32 s73, s67, 1792
    s_add_u32 s73, s73, 256
    v_mfma_f32_32x32x16_bf16 v[64:79], a[172:175], a[204:207], v[64:79]
    s_waitcnt vmcnt(13) lgkmcnt(0)
    ds_read_b128 a[184:187], v172 offset:24576
    ds_read_b128 a[188:191], v176 offset:24576
    buffer_load_dwordx4 a[28:31], v5, s[16:19], s40 offen offset:3072
    v_lshlrev_b32 v206, 16, v144
    v_and_b32 v207, 0xffff0000, v144
    v_fmac_f32 v204, v206, v206
    v_fmac_f32 v205, v207, v207
    v_mfma_f32_32x32x16_bf16 v[16:31], a[160:163], v[144:147], v[16:31]
    s_add_u32 m0, s78, 28672
    ds_read_b64_tr_b16 a[164:165], v188 offset:1024
    ds_read_b64_tr_b16 a[166:167], v188 offset:1280
    buffer_load_dwordx4 v184, s[8:11], s73 offen offset:0 lds
    v_lshlrev_b32 v208, 16, v145
    v_and_b32 v209, 0xffff0000, v145
    s_mul_i32 s41, s54, 7
    s_add_u32 s41, s41, 114688
    v_mfma_f32_32x32x16_bf16 v[32:47], a[160:163], a[180:183], v[32:47]
    s_waitcnt lgkmcnt(2)
    ds_read_b128 v[148:151], v165 offset:24576
    ds_read_b128 a[196:199], v169 offset:24576
    v_fmac_f32 v204, v208, v208
    v_fmac_f32 v205, v209, v209
    v_lshlrev_b32 v206, 16, v146
    v_and_b32 v207, 0xffff0000, v146
    v_mfma_f32_32x32x16_bf16 v[48:63], a[160:163], a[184:187], v[48:63]
    s_mul_i32 s40, s65, 25088
    s_add_u32 s40, s40, s61
    buffer_load_dwordx4 a[48:51], v2, s[12:15], s41 offen offset:0
    v_fmac_f32 v204, v206, v206
    v_fmac_f32 v205, v207, v207
    v_lshlrev_b32 v208, 16, v147
    v_and_b32 v209, 0xffff0000, v147
    v_fmac_f32 v204, v208, v208
    v_fmac_f32 v205, v209, v209
    v_mfma_f32_32x32x16_bf16 v[64:79], a[160:163], a[188:191], v[64:79]
    s_waitcnt vmcnt(14) lgkmcnt(0)
    ds_read_b128 a[200:203], v173 offset:24576
    ds_read_b128 a[204:207], v177 offset:24576
    buffer_load_dwordx4 a[32:35], v2, s[16:19], s40 offen offset:0
    v_lshlrev_b32 v206, 16, v148
    v_and_b32 v207, 0xffff0000, v148
    v_fmac_f32 v204, v206, v206
    v_fmac_f32 v205, v207, v207
    v_mfma_f32_32x32x16_bf16 v[16:31], a[164:167], v[148:151], v[16:31]
    ds_read_b64_tr_b16 a[168:169], v188 offset:2048
    ds_read_b64_tr_b16 a[170:171], v188 offset:2304
    buffer_load_dwordx4 v185, s[8:11], s73 offen offset:1024 lds
    v_lshlrev_b32 v208, 16, v149
    v_and_b32 v209, 0xffff0000, v149
    v_mfma_f32_32x32x16_bf16 v[32:47], a[164:167], a[196:199], v[32:47]
    s_waitcnt lgkmcnt(2)
    ds_read_b128 v[152:155], v166 offset:24576
    ds_read_b128 a[180:183], v170 offset:24576
    v_fmac_f32 v204, v208, v208
    v_fmac_f32 v205, v209, v209
    v_lshlrev_b32 v206, 16, v150
    v_and_b32 v207, 0xffff0000, v150
    v_mfma_f32_32x32x16_bf16 v[48:63], a[164:167], a[200:203], v[48:63]
    buffer_load_dwordx4 a[52:55], v3, s[12:15], s41 offen offset:1024
    v_fmac_f32 v204, v206, v206
    v_fmac_f32 v205, v207, v207
    v_lshlrev_b32 v208, 16, v151
    v_and_b32 v209, 0xffff0000, v151
    v_fmac_f32 v204, v208, v208
    v_fmac_f32 v205, v209, v209
    v_mfma_f32_32x32x16_bf16 v[64:79], a[164:167], a[204:207], v[64:79]
    s_waitcnt vmcnt(14) lgkmcnt(0)
    ds_read_b128 a[184:187], v174 offset:24576
    ds_read_b128 a[188:191], v178 offset:24576
    buffer_load_dwordx4 a[36:39], v3, s[16:19], s40 offen offset:1024
    v_lshlrev_b32 v206, 16, v152
    v_and_b32 v207, 0xffff0000, v152
    v_fmac_f32 v204, v206, v206
    v_fmac_f32 v205, v207, v207
    v_mfma_f32_32x32x16_bf16 v[16:31], a[168:171], v[152:155], v[16:31]
    ds_read_b64_tr_b16 a[172:173], v188 offset:3072
    ds_read_b64_tr_b16 a[174:175], v188 offset:3328
    buffer_load_dwordx4 v186, s[8:11], s73 offen offset:2048 lds
    v_lshlrev_b32 v208, 16, v153
    v_and_b32 v209, 0xffff0000, v153
    v_mfma_f32_32x32x16_bf16 v[32:47], a[168:171], a[180:183], v[32:47]
    s_waitcnt lgkmcnt(2)
    ds_read_b128 v[156:159], v167 offset:24576
    ds_read_b128 a[196:199], v171 offset:24576
    v_fmac_f32 v204, v208, v208
    v_fmac_f32 v205, v209, v209
    v_lshlrev_b32 v206, 16, v154
    v_and_b32 v207, 0xffff0000, v154
    v_mfma_f32_32x32x16_bf16 v[48:63], a[168:171], a[184:187], v[48:63]
    buffer_load_dwordx4 a[56:59], v4, s[12:15], s41 offen offset:2048
    v_fmac_f32 v204, v206, v206
    v_fmac_f32 v205, v207, v207
    v_lshlrev_b32 v208, 16, v155
    v_and_b32 v209, 0xffff0000, v155
    v_fmac_f32 v204, v208, v208
    v_fmac_f32 v205, v209, v209
    v_mfma_f32_32x32x16_bf16 v[64:79], a[168:171], a[188:191], v[64:79]
    s_waitcnt vmcnt(15) lgkmcnt(0)
    ds_read_b128 a[200:203], v175 offset:24576
    ds_read_b128 a[204:207], v179 offset:24576
    buffer_load_dwordx4 a[40:43], v4, s[16:19], s40 offen offset:2048
    v_lshlrev_b32 v206, 16, v156
    v_and_b32 v207, 0xffff0000, v156
    v_fmac_f32 v204, v206, v206
    v_fmac_f32 v205, v207, v207
    v_mfma_f32_16x16x32_bf16 v[196:199], v[212:215], a[160:163], v[196:199]
    v_lshlrev_b32 v208, 16, v157
    v_and_b32 v209, 0xffff0000, v157
    v_mfma_f32_16x16x32_bf16 v[192:195], v[212:215], v[144:147], v[192:195]
    v_fmac_f32 v204, v208, v208
    v_fmac_f32 v205, v209, v209
    v_mfma_f32_16x16x32_bf16 v[196:199], v[212:215], a[164:167], v[196:199]
    v_lshlrev_b32 v206, 16, v158
    v_and_b32 v207, 0xffff0000, v158
    v_mfma_f32_16x16x32_bf16 v[192:195], v[212:215], v[148:151], v[192:195]
    v_fmac_f32 v204, v206, v206
    v_fmac_f32 v205, v207, v207
    v_mfma_f32_16x16x32_bf16 v[196:199], v[212:215], a[168:171], v[196:199]
    v_lshlrev_b32 v208, 16, v159
    v_and_b32 v209, 0xffff0000, v159
    v_mfma_f32_16x16x32_bf16 v[192:195], v[212:215], v[152:155], v[192:195]
    v_fmac_f32 v204, v208, v208
    v_fmac_f32 v205, v209, v209
    v_mfma_f32_16x16x32_bf16 v[196:199], v[212:215], a[172:175], v[196:199]
    v_mfma_f32_16x16x32_bf16 v[192:195], v[212:215], v[156:159], v[192:195]
    v_mfma_f32_32x32x16_bf16 v[16:31], a[172:175], v[156:159], v[16:31]
    ds_read_b64_tr_b16 a[160:161], v188 offset:4096
    ds_read_b64_tr_b16 a[162:163], v188 offset:4352
    buffer_load_dwordx4 v187, s[8:11], s73 offen offset:3072 lds
    v_mfma_f32_32x32x16_bf16 v[32:47], a[172:175], a[196:199], v[32:47]
    s_waitcnt lgkmcnt(2)
    ds_read_b128 a[176:179], v164 offset:0
    ds_read_b128 a[180:183], v168 offset:0
    v_add_f32 v252, v204, v205
    v_mul_f32 v255, 0xbb124925, v192
    v_mov_b32 v253, v252
    v_cvt_pk_bf16_f32 v248, v255, v255
    v_mfma_f32_32x32x16_bf16 v[48:63], a[172:175], a[200:203], v[48:63]
    buffer_load_dwordx4 a[60:63], v5, s[12:15], s41 offen offset:3072
    s_mul_i32 s73, s68, 1792
    s_add_u32 s73, s73, 256
    v_and_b32 v254, 0xffff0000, v248
    v_permlane32_swap_b32 v252, v253
    v_sub_f32 v249, v255, v254
    v_add_f32 v252, v252, v253
    v_mfma_f32_32x32x16_bf16 v[64:79], a[172:175], a[204:207], v[64:79]
    s_waitcnt vmcnt(16) lgkmcnt(0)
    ds_read_b128 a[184:187], v172 offset:0
    ds_read_b128 a[188:191], v176 offset:0
    buffer_load_dwordx4 a[44:47], v5, s[16:19], s40 offen offset:3072
    v_mul_f32 v252, 0x3b124925, v252
    v_fma_f32 v252, -v255, v255, v252
    v_max_f32 v252, 0, v252
    v_add_f32 v253, 0x3727c5ac, v252
    v_mfma_f32_32x32x16_bf16 v[80:95], a[160:163], a[176:179], 0
    s_add_u32 m0, s78, 32768
    ds_read_b64_tr_b16 a[164:165], v188 offset:5120
    ds_read_b64_tr_b16 a[166:167], v188 offset:5376
    buffer_load_dwordx4 v184, s[8:11], s73 offen offset:0 lds
    v_rsq_f32 v253, v253
    s_mul_i32 s41, s55, 7
    s_add_u32 s41, s41, 114688
    v_mfma_f32_32x32x16_bf16 v[96:111], a[160:163], a[180:183], 0
    s_waitcnt lgkmcnt(2)
    ds_read_b128 a[192:195], v165 offset:0
    ds_read_b128 a[196:199], v169 offset:0
    v_mov_b32 v227, 0
    v_mul_f32 v254, v253, v253
    v_fmaak_f32 v254, v254, v252, 0x3727c5ac
    v_mfma_f32_32x32x16_bf16 v[112:127], a[160:163], a[184:187], 0
    buffer_load_dwordx4 a[64:67], v2, s[12:15], s41 offen offset:0
    v_rsq_f32 v254, v254
    v_mov_b32 v251, 0
    v_mul_f32 v253, v253, v254
    v_rcp_f32 v224, v253
    v_mul_f32 v225, 0xc0135761, v253
    v_mfma_f32_32x32x16_bf16 v[128:143], a[160:163], a[188:191], 0
    s_waitcnt vmcnt(17) lgkmcnt(0)
    ds_read_b128 a[200:203], v173 offset:0
    ds_read_b128 a[204:207], v177 offset:0
    v_mul_f32 v253, v253, v253
    v_cvt_pk_bf16_f32 v249, v249, v224
    v_mul_f32 v253, v253, v225
    v_and_b32 v254, 0xffff0000, v249
    v_mfma_f32_32x32x16_bf16 v[80:95], a[164:167], a[192:195], v[80:95]
    ds_read_b64_tr_b16 a[168:169], v188 offset:6144
    ds_read_b64_tr_b16 a[170:171], v188 offset:6400
    buffer_load_dwordx4 v185, s[8:11], s73 offen offset:1024 lds
    v_mul_f32 v226, 0x3d372713, v253
    v_sub_f32 v254, v224, v254
    v_mfma_f32_32x32x16_bf16 v[96:111], a[164:167], a[196:199], v[96:111]
    s_waitcnt lgkmcnt(2)
    ds_read_b128 a[176:179], v166 offset:0
    ds_read_b128 a[180:183], v170 offset:0
    v_cvt_pk_bf16_f32 v250, v254, 0
    ds_write_b128 v244, v[224:227] offset:1024
    ds_write_b128 v244, v[248:251]
    v_cndmask_b32 v206, 0, v196, s[74:75]
    v_mfma_f32_32x32x16_bf16 v[112:127], a[164:167], a[200:203], v[112:127]
    buffer_load_dwordx4 a[68:71], v3, s[12:15], s41 offen offset:1024
    v_lshlrev_b32 v208, 16, v218
    v_cvt_pk_bf16_f32 v217, v206, v208
    v_mov_b32 v219, 0
    v_lshlrev_b32 v207, 16, v217
    v_sub_f32 v207, v206, v207
    v_cvt_pk_bf16_f32 v216, v206, v207
    v_mfma_f32_32x32x16_bf16 v[128:143], a[164:167], a[204:207], v[128:143]
    s_waitcnt vmcnt(17) lgkmcnt(2)
    ds_read_b128 a[184:187], v174 offset:0
    ds_read_b128 a[188:191], v178 offset:0
    v_mfma_f32_32x32x16_bf16 v[16:31], v[216:219], v[248:251], v[16:31]
    v_mfma_f32_32x32x16_bf16 v[80:95], a[168:171], a[176:179], v[80:95]
    ds_read_b64_tr_b16 a[172:173], v188 offset:7168
    ds_read_b64_tr_b16 a[174:175], v188 offset:7424
    buffer_load_dwordx4 v186, s[8:11], s73 offen offset:2048 lds
    v_mfma_f32_32x32x16_bf16 v[96:111], a[168:171], a[180:183], v[96:111]
    s_waitcnt lgkmcnt(2)
    ds_read_b128 a[192:195], v167 offset:0
    ds_read_b128 a[196:199], v171 offset:0
    s_nop 3
    v_mul_f32 v144, v16, v16
    v_mul_f32 v145, v17, v17
    v_mul_f32 v146, v18, v18
    v_readfirstlane_b32 s76, v13
    s_nop 0
    s_cmp_eq_u32 s76, 0
    s_cbranch_scc1 Lnon_s
Lnon_k:
    v_mfma_f32_32x32x16_bf16 v[112:127], a[168:171], a[184:187], v[112:127]
    v_mul_f32 v147, v19, v19
    v_fma_f32 v144, v144, v226, v225
    v_fma_f32 v145, v145, v226, v225
    v_fma_f32 v146, v146, v226, v225
    v_fma_f32 v147, v147, v226, v225
    v_mul_f32 v144, v144, v16
    v_mul_f32 v145, v145, v17
    v_mul_f32 v146, v146, v18
    v_mul_f32 v147, v147, v19
    v_mfma_f32_32x32x16_bf16 v[128:143], a[168:171], a[188:191], v[128:143]
    s_waitcnt vmcnt(16) lgkmcnt(0)
    ds_read_b128 a[200:203], v175 offset:0
    ds_read_b128 a[204:207], v179 offset:0
    v_exp_f32 v144, v144
    v_mul_f32 v148, v20, v20
    v_mul_f32 v149, v21, v21
    v_exp_f32 v145, v145
    v_mfma_f32_16x16x32_bf16 v[200:203], v[212:215], a[160:163], 0
    v_mul_f32 v150, v22, v22
    v_mul_f32 v151, v23, v23
    v_exp_f32 v146, v146
    v_fma_f32 v148, v148, v226, v225
    v_mfma_f32_16x16x32_bf16 v[192:195], v[212:215], a[164:167], 0
    v_fma_f32 v149, v149, v226, v225
    v_exp_f32 v147, v147
    v_fma_f32 v150, v150, v226, v225
    v_fma_f32 v151, v151, v226, v225
    v_mfma_f32_16x16x32_bf16 v[200:203], v[212:215], a[168:171], v[200:203]
    v_fma_f32 v144, v144, v224, v224
    v_fma_f32 v145, v145, v224, v224
    v_rcp_f32 v144, v144
    v_mfma_f32_16x16x32_bf16 v[192:195], v[212:215], a[172:175], v[192:195]
    v_mul_f32 v148, v148, v20
    v_mul_f32 v149, v149, v21
    v_mul_f32 v150, v150, v22
    v_rcp_f32 v145, v145
    v_mfma_f32_32x32x16_bf16 v[80:95], a[172:175], a[192:195], v[80:95]
    ds_read_b64_tr_b16 a[160:161], v188 offset:0
    ds_read_b64_tr_b16 a[162:163], v188 offset:256
    buffer_load_dwordx4 v187, s[8:11], s73 offen offset:3072 lds
    v_mul_f32 v151, v151, v23
    v_fma_f32 v146, v146, v224, v224
    v_fma_f32 v147, v147, v224, v224
    v_rcp_f32 v146, v146
    v_mfma_f32_32x32x16_bf16 v[96:111], a[172:175], a[196:199], v[96:111]
    s_waitcnt lgkmcnt(2)
    s_barrier
    ds_read_b128 a[176:179], v164 offset:4096
    ds_read_b128 a[180:183], v168 offset:4096
    ds_read_b128 a[208:211], v245
    ds_read_b128 a[212:215], v246
    ds_read_b128 a[216:219], v247
    v_mul_f32 v144, v144, v16
    v_mfma_f32_32x32x16_bf16 v[112:127], a[172:175], a[200:203], v[112:127]
    s_add_u32 m0, s78, 0
    ds_read_b128 v[228:231], v245 offset:1024
    ds_read_b128 v[232:235], v246 offset:1024
    ds_read_b128 v[236:239], v247 offset:1024
    buffer_load_dwordx4 a[72:75], v4, s[12:15], s41 offen offset:2048
    s_mul_i32 s73, s69, 1792
    s_add_u32 s73, s73, 256
    s_mul_i32 s49, s53, 7
    v_rcp_f32 v147, v147
    v_mul_f32 v145, v145, v17
    v_mfma_f32_32x32x16_bf16 v[128:143], a[172:175], a[204:207], v[128:143]
    s_waitcnt vmcnt(15) lgkmcnt(0)
    ds_read_b128 a[184:187], v172 offset:4096
    ds_read_b128 a[188:191], v176 offset:4096
    buffer_load_dwordx4 v2, s[12:15], s49 offen offset:0 lds
    v_exp_f32 v148, v148
    v_cvt_pk_bf16_f32 v16, v144, v145
    v_exp_f32 v149, v149
    v_mfma_f32_32x32x16_bf16 v[32:47], v[216:219], a[208:211], v[32:47]
    v_exp_f32 v150, v150
    v_mul_f32 v146, v146, v18
    v_exp_f32 v151, v151
    v_mul_f32 v147, v147, v19
    v_cvt_pk_bf16_f32 v17, v146, v147
    v_fma_f32 v148, v148, v224, v224
    v_fma_f32 v149, v149, v224, v224
    v_mfma_f32_32x32x16_bf16 v[48:63], v[216:219], a[212:215], v[48:63]
    v_rcp_f32 v148, v148
    v_fma_f32 v150, v150, v224, v224
    v_rcp_f32 v149, v149
    v_fma_f32 v151, v151, v224, v224
    v_rcp_f32 v150, v150
    v_mfma_f32_32x32x16_bf16 v[64:79], v[216:219], a[216:219], v[64:79]
    v_rcp_f32 v151, v151
    v_mul_f32 v148, v148, v20
    v_mul_f32 v149, v149, v21
    v_mul_f32 v150, v150, v22
    v_mul_f32 v151, v151, v23
    v_cvt_pk_bf16_f32 v18, v148, v149
    v_cvt_pk_bf16_f32 v19, v150, v151
    v_mul_f32 v144, v24, v24
    v_mfma_f32_32x32x16_bf16 v[80:95], a[160:163], a[176:179], v[80:95]
    s_add_u32 m0, s78, 28672
    ds_read_b64_tr_b16 a[164:165], v188 offset:1024
    ds_read_b64_tr_b16 a[166:167], v188 offset:1280
    buffer_load_dwordx4 v184, s[8:11], s73 offen offset:0 lds
    v_mul_f32 v145, v25, v25
    v_mul_f32 v146, v26, v26
    v_mul_f32 v147, v27, v27
    v_fma_f32 v144, v144, v226, v225
    v_fma_f32 v145, v145, v226, v225
    v_mfma_f32_32x32x16_bf16 v[96:111], a[160:163], a[180:183], v[96:111]
    s_waitcnt lgkmcnt(2)
    ds_read_b128 a[192:195], v165 offset:4096
    ds_read_b128 a[196:199], v169 offset:4096
    v_fma_f32 v146, v146, v226, v225
    v_fma_f32 v147, v147, v226, v225
    v_mul_f32 v144, v144, v24
    v_mul_f32 v145, v145, v25
    v_mul_f32 v146, v146, v26
    v_mul_f32 v147, v147, v27
    v_mfma_f32_32x32x16_bf16 v[112:127], a[160:163], a[184:187], v[112:127]
    s_add_u32 m0, s78, 0
    buffer_load_dwordx4 a[76:79], v5, s[12:15], s41 offen offset:3072
    v_exp_f32 v144, v144
    v_mul_f32 v148, v28, v28
    v_mul_f32 v149, v29, v29
    v_exp_f32 v145, v145
    v_mul_f32 v150, v30, v30
    v_mfma_f32_32x32x16_bf16 v[128:143], a[160:163], a[188:191], v[128:143]
    s_waitcnt vmcnt(15) lgkmcnt(0)
    ds_read_b128 a[200:203], v173 offset:4096
    ds_read_b128 a[204:207], v177 offset:4096
    buffer_load_dwordx4 v3, s[12:15], s49 offen offset:1024 lds
    v_mul_f32 v151, v31, v31
    v_exp_f32 v146, v146
    v_fma_f32 v148, v148, v226, v225
    v_fma_f32 v149, v149, v226, v225
    v_mfma_f32_32x32x16_bf16 v[80:95], a[164:167], a[192:195], v[80:95]
    s_add_u32 m0, s78, 28672
    ds_read_b64_tr_b16 a[168:169], v188 offset:2048
    ds_read_b64_tr_b16 a[170:171], v188 offset:2304
    buffer_load_dwordx4 v185, s[8:11], s73 offen offset:1024 lds
    v_exp_f32 v147, v147
    v_fma_f32 v150, v150, v226, v225
    v_fma_f32 v151, v151, v226, v225
    v_mfma_f32_32x32x16_bf16 v[96:111], a[164:167], a[196:199], v[96:111]
    s_waitcnt lgkmcnt(2)
    ds_read_b128 a[176:179], v166 offset:4096
    ds_read_b128 a[180:183], v170 offset:4096
    buffer_load_dword v15, off, s[20:23], s43
    v_fma_f32 v144, v144, v224, v224
    v_fma_f32 v145, v145, v224, v224
    v_rcp_f32 v144, v144
    v_mul_f32 v148, v148, v28
    v_mul_f32 v149, v149, v29
    v_mul_f32 v150, v150, v30
    v_mfma_f32_32x32x16_bf16 v[112:127], a[164:167], a[200:203], v[112:127]
    s_add_u32 m0, s78, 0
    v_rcp_f32 v145, v145
    v_mul_f32 v151, v151, v31
    v_fma_f32 v146, v146, v224, v224
    v_fma_f32 v147, v147, v224, v224
    v_rcp_f32 v146, v146
    v_mul_f32 v144, v144, v24
    v_mfma_f32_32x32x16_bf16 v[128:143], a[164:167], a[204:207], v[128:143]
    s_waitcnt vmcnt(15) lgkmcnt(0)
    ds_read_b128 a[184:187], v174 offset:4096
    ds_read_b128 a[188:191], v178 offset:4096
    buffer_load_dwordx4 v4, s[12:15], s49 offen offset:2048 lds
    v_rcp_f32 v147, v147
    v_mul_f32 v145, v145, v25
    v_exp_f32 v148, v148
    v_mfma_f32_32x32x16_bf16 v[80:95], a[168:171], a[176:179], v[80:95]
    s_add_u32 m0, s78, 28672
    ds_read_b64_tr_b16 a[172:173], v188 offset:3072
    ds_read_b64_tr_b16 a[174:175], v188 offset:3328
    buffer_load_dwordx4 v186, s[8:11], s73 offen offset:2048 lds
    s_mul_i32 s41, s56, 7
    s_add_u32 s41, s41, 114688
    v_cvt_pk_bf16_f32 v24, v144, v145
    v_exp_f32 v149, v149
    v_mfma_f32_32x32x16_bf16 v[96:111], a[168:171], a[180:183], v[96:111]
    s_waitcnt lgkmcnt(2)
    ds_read_b128 a[192:195], v167 offset:4096
    ds_read_b128 a[196:199], v171 offset:4096
    v_exp_f32 v150, v150
    v_mul_f32 v146, v146, v26
    v_exp_f32 v151, v151
    v_mul_f32 v147, v147, v27
    v_cvt_pk_bf16_f32 v25, v146, v147
    v_mfma_f32_32x32x16_bf16 v[112:127], a[168:171], a[184:187], v[112:127]
    s_add_u32 m0, s78, 0
    buffer_load_dwordx4 a[80:83], v2, s[12:15], s41 offen offset:0
    v_fma_f32 v148, v148, v224, v224
    v_fma_f32 v149, v149, v224, v224
    v_rcp_f32 v148, v148
    v_fma_f32 v150, v150, v224, v224
    v_mfma_f32_32x32x16_bf16 v[128:143], a[168:171], a[188:191], v[128:143]
    s_waitcnt vmcnt(15) lgkmcnt(0)
    ds_read_b128 a[200:203], v175 offset:4096
    ds_read_b128 a[204:207], v179 offset:4096
    buffer_load_dwordx4 v5, s[12:15], s49 offen offset:3072 lds
    v_rcp_f32 v149, v149
    v_fma_f32 v151, v151, v224, v224
    v_rcp_f32 v150, v150
    v_mfma_f32_16x16x32_bf16 v[200:203], v[212:215], a[160:163], v[200:203]
    v_rcp_f32 v151, v151
    v_mul_f32 v148, v148, v28
    v_mul_f32 v149, v149, v29
    v_mul_f32 v150, v150, v30
    v_mfma_f32_16x16x32_bf16 v[192:195], v[212:215], a[164:167], v[192:195]
    v_mul_f32 v151, v151, v31
    v_cvt_pk_bf16_f32 v26, v148, v149
    v_cvt_pk_bf16_f32 v27, v150, v151
    v_mul_f32 v144, v32, v32
    v_mul_f32 v145, v33, v33
    v_mfma_f32_16x16x32_bf16 v[200:203], v[212:215], a[168:171], v[200:203]
    v_mul_f32 v146, v34, v34
    v_mul_f32 v147, v35, v35
    v_fma_f32 v144, v144, v230, v229
    v_fma_f32 v145, v145, v230, v229
    v_fma_f32 v146, v146, v230, v229
    v_mfma_f32_16x16x32_bf16 v[192:195], v[212:215], a[172:175], v[192:195]
    v_fma_f32 v147, v147, v230, v229
    v_mul_f32 v144, v144, v32
    v_mul_f32 v145, v145, v33
    v_mul_f32 v146, v146, v34
    v_mfma_f32_32x32x16_bf16 v[80:95], a[172:175], a[192:195], v[80:95]
    s_add_u32 m0, s78, 28672
    ds_read_b64_tr_b16 a[160:161], v188 offset:4096
    ds_read_b64_tr_b16 a[162:163], v188 offset:4352
    buffer_load_dwordx4 v187, s[8:11], s73 offen offset:3072 lds
    v_mul_f32 v147, v147, v35
    v_exp_f32 v144, v144
    v_mul_f32 v148, v36, v36
    v_mul_f32 v149, v37, v37
    v_mfma_f32_32x32x16_bf16 v[96:111], a[172:175], a[196:199], v[96:111]
    s_waitcnt lgkmcnt(2)
    s_barrier
    ds_read_b128 a[176:179], v164 offset:8192
    ds_read_b128 a[180:183], v168 offset:8192
    v_exp_f32 v145, v145
    v_mul_f32 v150, v38, v38
    v_mul_f32 v151, v39, v39
    v_exp_f32 v146, v146
    v_mfma_f32_32x32x16_bf16 v[112:127], a[172:175], a[200:203], v[112:127]
    s_add_u32 m0, s78, 4096
    buffer_load_dwordx4 a[84:87], v3, s[12:15], s41 offen offset:1024
    s_mul_i32 s73, s70, 1792
    s_add_u32 s73, s73, 256
    s_mul_i32 s49, s53, 7
    s_add_u32 s49, s49, 114688
    v_fma_f32 v148, v148, v230, v229
    v_fma_f32 v149, v149, v230, v229
    v_mfma_f32_32x32x16_bf16 v[128:143], a[172:175], a[204:207], v[128:143]
    s_waitcnt vmcnt(16) lgkmcnt(0)
    ds_read_b128 a[184:187], v172 offset:8192
    ds_read_b128 a[188:191], v176 offset:8192
    buffer_load_dwordx4 v2, s[12:15], s49 offen offset:0 lds
    v_exp_f32 v147, v147
    v_fma_f32 v150, v150, v230, v229
    v_fma_f32 v151, v151, v230, v229
    v_fma_f32 v144, v144, v228, v228
    v_mfma_f32_32x32x16_bf16 v[80:95], a[160:163], a[176:179], v[80:95]
    s_add_u32 m0, s78, 32768
    ds_read_b64_tr_b16 a[164:165], v188 offset:5120
    ds_read_b64_tr_b16 a[166:167], v188 offset:5376
    buffer_load_dwordx4 v184, s[8:11], s73 offen offset:0 lds
    v_fma_f32 v145, v145, v228, v228
    v_rcp_f32 v144, v144
    v_mul_f32 v148, v148, v36
    v_mfma_f32_32x32x16_bf16 v[96:111], a[160:163], a[180:183], v[96:111]
    s_waitcnt lgkmcnt(2)
    ds_read_b128 a[192:195], v165 offset:8192
    ds_read_b128 a[196:199], v169 offset:8192
    v_mul_f32 v149, v149, v37
    v_mul_f32 v150, v150, v38
    v_rcp_f32 v145, v145
    v_mul_f32 v151, v151, v39
    v_fma_f32 v146, v146, v228, v228
    v_fma_f32 v147, v147, v228, v228
    v_mfma_f32_32x32x16_bf16 v[112:127], a[160:163], a[184:187], v[112:127]
    s_add_u32 m0, s78, 4096
    v_rcp_f32 v146, v146
    v_mul_f32 v144, v144, v32
    v_rcp_f32 v147, v147
    v_mul_f32 v145, v145, v33
    v_exp_f32 v148, v148
    v_cvt_pk_bf16_f32 v32, v144, v145
    v_mfma_f32_32x32x16_bf16 v[128:143], a[160:163], a[188:191], v[128:143]
    s_waitcnt vmcnt(16) lgkmcnt(0)
    ds_read_b128 a[200:203], v173 offset:8192
    ds_read_b128 a[204:207], v177 offset:8192
    buffer_load_dwordx4 v3, s[12:15], s49 offen offset:1024 lds
    v_exp_f32 v149, v149
    v_exp_f32 v150, v150
    v_mfma_f32_32x32x16_bf16 v[80:95], a[164:167], a[192:195], v[80:95]
    s_add_u32 m0, s78, 32768
    ds_read_b64_tr_b16 a[168:169], v188 offset:6144
    ds_read_b64_tr_b16 a[170:171], v188 offset:6400
    buffer_load_dwordx4 v185, s[8:11], s73 offen offset:1024 lds
    v_mul_f32 v146, v146, v34
    v_exp_f32 v151, v151
    v_mul_f32 v147, v147, v35
    v_cvt_pk_bf16_f32 v33, v146, v147
    v_mfma_f32_32x32x16_bf16 v[96:111], a[164:167], a[196:199], v[96:111]
    s_waitcnt lgkmcnt(2)
    ds_read_b128 a[176:179], v166 offset:8192
    ds_read_b128 a[180:183], v170 offset:8192
    v_fma_f32 v148, v148, v228, v228
    v_fma_f32 v149, v149, v228, v228
    v_rcp_f32 v148, v148
    v_fma_f32 v150, v150, v228, v228
    v_rcp_f32 v149, v149
    v_mfma_f32_32x32x16_bf16 v[112:127], a[164:167], a[200:203], v[112:127]
    s_add_u32 m0, s78, 4096
    buffer_load_dwordx4 a[88:91], v4, s[12:15], s41 offen offset:2048
    v_fma_f32 v151, v151, v228, v228
    v_rcp_f32 v150, v150
    v_rcp_f32 v151, v151
    v_mul_f32 v148, v148, v36
    v_mfma_f32_32x32x16_bf16 v[128:143], a[164:167], a[204:207], v[128:143]
    s_waitcnt vmcnt(18) lgkmcnt(0)
    ds_read_b128 a[184:187], v174 offset:8192
    ds_read_b128 a[188:191], v178 offset:8192
    buffer_load_dwordx4 v4, s[12:15], s49 offen offset:2048 lds
    v_mul_f32 v149, v149, v37
    v_mul_f32 v150, v150, v38
    v_mul_f32 v151, v151, v39
    v_cvt_pk_bf16_f32 v34, v148, v149
    v_cvt_pk_bf16_f32 v35, v150, v151
    v_mfma_f32_32x32x16_bf16 v[80:95], a[168:171], a[176:179], v[80:95]
    s_add_u32 m0, s78, 32768
    ds_read_b64_tr_b16 a[172:173], v188 offset:7168
    ds_read_b64_tr_b16 a[174:175], v188 offset:7424
    buffer_load_dwordx4 v186, s[8:11], s73 offen offset:2048 lds
    v_mul_f32 v144, v40, v40
    v_mul_f32 v145, v41, v41
    v_mul_f32 v146, v42, v42
    v_mul_f32 v147, v43, v43
    v_mfma_f32_32x32x16_bf16 v[96:111], a[168:171], a[180:183], v[96:111]
    s_waitcnt lgkmcnt(2)
    ds_read_b128 a[192:195], v167 offset:8192
    ds_read_b128 a[196:199], v171 offset:8192
    v_fma_f32 v144, v144, v230, v229
    v_fma_f32 v145, v145, v230, v229
    v_fma_f32 v146, v146, v230, v229
    v_fma_f32 v147, v147, v230, v229
    v_mul_f32 v144, v144, v40
    v_mul_f32 v145, v145, v41
    v_mul_f32 v146, v146, v42
    v_mfma_f32_32x32x16_bf16 v[112:127], a[168:171], a[184:187], v[112:127]
    s_add_u32 m0, s78, 4096
    buffer_load_dwordx4 a[92:95], v5, s[12:15], s41 offen offset:3072
    v_mul_f32 v147, v147, v43
    v_exp_f32 v144, v144
    v_mul_f32 v148, v44, v44
    v_mul_f32 v149, v45, v45
    v_exp_f32 v145, v145
    v_mfma_f32_32x32x16_bf16 v[128:143], a[168:171], a[188:191], v[128:143]
    s_waitcnt vmcnt(18) lgkmcnt(0)
    ds_read_b128 a[200:203], v175 offset:8192
    ds_read_b128 a[204:207], v179 offset:8192
    buffer_load_dwordx4 v5, s[12:15], s49 offen offset:3072 lds
    v_mul_f32 v150, v46, v46
    v_mul_f32 v151, v47, v47
    v_exp_f32 v146, v146
    v_mfma_f32_16x16x32_bf16 v[200:203], v[212:215], a[160:163], v[200:203]
    v_fma_f32 v148, v148, v230, v229
    v_fma_f32 v149, v149, v230, v229
    v_exp_f32 v147, v147
    v_fma_f32 v150, v150, v230, v229
    v_mfma_f32_16x16x32_bf16 v[192:195], v[212:215], a[164:167], v[192:195]
    v_fma_f32 v151, v151, v230, v229
    v_fma_f32 v144, v144, v228, v228
    v_fma_f32 v145, v145, v228, v228
    v_rcp_f32 v144, v144
    v_mfma_f32_16x16x32_bf16 v[200:203], v[212:215], a[168:171], v[200:203]
    v_mul_f32 v148, v148, v44
    v_mul_f32 v149, v149, v45
    v_mul_f32 v150, v150, v46
    v_mfma_f32_16x16x32_bf16 v[192:195], v[212:215], a[172:175], v[192:195]
    v_rcp_f32 v145, v145
    v_mul_f32 v151, v151, v47
    v_fma_f32 v146, v146, v228, v228
    v_fma_f32 v147, v147, v228, v228
    v_mfma_f32_32x32x16_bf16 v[80:95], a[172:175], a[192:195], v[80:95]
    s_add_u32 m0, s78, 32768
    ds_read_b64_tr_b16 a[160:161], v188 offset:0
    ds_read_b64_tr_b16 a[162:163], v188 offset:256
    buffer_load_dwordx4 v187, s[8:11], s73 offen offset:3072 lds
    v_rcp_f32 v146, v146
    v_mul_f32 v144, v144, v40
    v_rcp_f32 v147, v147
    v_mfma_f32_32x32x16_bf16 v[96:111], a[172:175], a[196:199], v[96:111]
    s_waitcnt lgkmcnt(2)
    s_barrier
    ds_read_b128 a[176:179], v164 offset:12288
    ds_read_b128 a[180:183], v168 offset:12288
    v_mul_f32 v145, v145, v41
    v_exp_f32 v148, v148
    v_cvt_pk_bf16_f32 v40, v144, v145
    v_exp_f32 v149, v149
    v_mfma_f32_32x32x16_bf16 v[112:127], a[172:175], a[200:203], v[112:127]
    s_add_u32 m0, s78, 8192
    s_mul_i32 s73, s71, 1792
    s_add_u32 s73, s73, 256
    s_mul_i32 s49, s54, 7
    v_exp_f32 v150, v150
    v_mul_f32 v146, v146, v42
    v_exp_f32 v151, v151
    v_mul_f32 v147, v147, v43
    v_mfma_f32_32x32x16_bf16 v[128:143], a[172:175], a[204:207], v[128:143]
    s_waitcnt vmcnt(17) lgkmcnt(0)
    ds_read_b128 a[184:187], v172 offset:12288
    ds_read_b128 a[188:191], v176 offset:12288
    buffer_load_dwordx4 v2, s[12:15], s49 offen offset:0 lds
    v_cvt_pk_bf16_f32 v41, v146, v147
    v_fma_f32 v148, v148, v228, v228
    v_fma_f32 v149, v149, v228, v228
    v_mfma_f32_32x32x16_bf16 v[80:95], a[160:163], a[176:179], v[80:95]
    s_add_u32 m0, s78, 28672
    ds_read_b64_tr_b16 a[164:165], v188 offset:1024
    ds_read_b64_tr_b16 a[166:167], v188 offset:1280
    buffer_load_dwordx4 v184, s[8:11], s73 offen offset:0 lds
    v_rcp_f32 v148, v148
    v_fma_f32 v150, v150, v228, v228
    v_rcp_f32 v149, v149
    v_fma_f32 v151, v151, v228, v228
    v_mfma_f32_32x32x16_bf16 v[96:111], a[160:163], a[180:183], v[96:111]
    s_waitcnt lgkmcnt(2)
    ds_read_b128 a[192:195], v165 offset:12288
    ds_read_b128 a[196:199], v169 offset:12288
    v_rcp_f32 v150, v150
    v_rcp_f32 v151, v151
    v_mul_f32 v148, v148, v44
    v_mul_f32 v149, v149, v45
    v_mul_f32 v150, v150, v46
    v_mfma_f32_32x32x16_bf16 v[112:127], a[160:163], a[184:187], v[112:127]
    s_add_u32 m0, s78, 8192
    v_mul_f32 v151, v151, v47
    v_cvt_pk_bf16_f32 v42, v148, v149
    v_cvt_pk_bf16_f32 v43, v150, v151
    v_mul_f32 v144, v48, v48
    v_mul_f32 v145, v49, v49
    v_mul_f32 v146, v50, v50
    v_mul_f32 v147, v51, v51
    v_fma_f32 v144, v144, v234, v233
    v_mfma_f32_32x32x16_bf16 v[128:143], a[160:163], a[188:191], v[128:143]
    s_waitcnt vmcnt(16) lgkmcnt(0)
    ds_read_b128 a[200:203], v173 offset:12288
    ds_read_b128 a[204:207], v177 offset:12288
    buffer_load_dwordx4 v3, s[12:15], s49 offen offset:1024 lds
    v_fma_f32 v145, v145, v234, v233
    v_fma_f32 v146, v146, v234, v233
    v_fma_f32 v147, v147, v234, v233
    v_mul_f32 v144, v144, v48
    v_mul_f32 v145, v145, v49
    v_mfma_f32_32x32x16_bf16 v[80:95], a[164:167], a[192:195], v[80:95]
    s_add_u32 m0, s78, 28672
    ds_read_b64_tr_b16 a[168:169], v188 offset:2048
    ds_read_b64_tr_b16 a[170:171], v188 offset:2304
    buffer_load_dwordx4 v185, s[8:11], s73 offen offset:1024 lds
    v_mul_f32 v146, v146, v50
    v_mul_f32 v147, v147, v51
    v_exp_f32 v144, v144
    v_mul_f32 v148, v52, v52
    v_mfma_f32_32x32x16_bf16 v[96:111], a[164:167], a[196:199], v[96:111]
    s_waitcnt lgkmcnt(2)
    ds_read_b128 a[176:179], v166 offset:12288
    ds_read_b128 a[180:183], v170 offset:12288
    v_mul_f32 v149, v53, v53
    v_exp_f32 v145, v145
    v_mul_f32 v150, v54, v54
    v_mul_f32 v151, v55, v55
    v_mfma_f32_32x32x16_bf16 v[112:127], a[164:167], a[200:203], v[112:127]
    s_add_u32 m0, s78, 8192
    v_exp_f32 v146, v146
    v_fma_f32 v148, v148, v234, v233
    v_fma_f32 v149, v149, v234, v233
    v_exp_f32 v147, v147
    v_fma_f32 v150, v150, v234, v233
    v_fma_f32 v151, v151, v234, v233
    v_fma_f32 v144, v144, v232, v232
    v_fma_f32 v145, v145, v232, v232
    v_mfma_f32_32x32x16_bf16 v[128:143], a[164:167], a[204:207], v[128:143]
    s_waitcnt vmcnt(15) lgkmcnt(0)
    ds_read_b128 a[184:187], v174 offset:12288
    ds_read_b128 a[188:191], v178 offset:12288
    buffer_load_dwordx4 v4, s[12:15], s49 offen offset:2048 lds
    v_rcp_f32 v144, v144
    v_mul_f32 v148, v148, v52
    v_mul_f32 v149, v149, v53
    v_mfma_f32_32x32x16_bf16 v[80:95], a[168:171], a[176:179], v[80:95]
    s_add_u32 m0, s78, 28672
    ds_read_b64_tr_b16 a[172:173], v188 offset:3072
    ds_read_b64_tr_b16 a[174:175], v188 offset:3328
    buffer_load_dwordx4 v186, s[8:11], s73 offen offset:2048 lds
    v_mul_f32 v150, v150, v54
    v_rcp_f32 v145, v145
    v_mul_f32 v151, v151, v55
    v_fma_f32 v146, v146, v232, v232
    v_mfma_f32_32x32x16_bf16 v[96:111], a[168:171], a[180:183], v[96:111]
    s_waitcnt lgkmcnt(2)
    ds_read_b128 a[192:195], v167 offset:12288
    ds_read_b128 a[196:199], v171 offset:12288
    v_fma_f32 v147, v147, v232, v232
    v_rcp_f32 v146, v146
    v_mul_f32 v144, v144, v48
    v_rcp_f32 v147, v147
    v_mul_f32 v145, v145, v49
    v_mfma_f32_32x32x16_bf16 v[112:127], a[168:171], a[184:187], v[112:127]
    s_add_u32 m0, s78, 8192
    v_exp_f32 v148, v148
    v_cvt_pk_bf16_f32 v48, v144, v145
    v_exp_f32 v149, v149
    v_exp_f32 v150, v150
    v_mul_f32 v146, v146, v50
    v_mfma_f32_32x32x16_bf16 v[128:143], a[168:171], a[188:191], v[128:143]
    s_waitcnt vmcnt(14) lgkmcnt(0)
    ds_read_b128 a[200:203], v175 offset:12288
    ds_read_b128 a[204:207], v179 offset:12288
    buffer_load_dwordx4 v5, s[12:15], s49 offen offset:3072 lds
    v_exp_f32 v151, v151
    v_mul_f32 v147, v147, v51
    v_cvt_pk_bf16_f32 v49, v146, v147
    v_fma_f32 v148, v148, v232, v232
    v_mfma_f32_16x16x32_bf16 v[200:203], v[212:215], a[160:163], v[200:203]
    v_fma_f32 v149, v149, v232, v232
    v_rcp_f32 v148, v148
    v_fma_f32 v150, v150, v232, v232
    v_mfma_f32_16x16x32_bf16 v[192:195], v[212:215], a[164:167], v[192:195]
    v_rcp_f32 v149, v149
    v_fma_f32 v151, v151, v232, v232
    v_rcp_f32 v150, v150
    v_mfma_f32_16x16x32_bf16 v[200:203], v[212:215], a[168:171], v[200:203]
    v_rcp_f32 v151, v151
    v_mul_f32 v148, v148, v52
    v_mul_f32 v149, v149, v53
    v_mul_f32 v150, v150, v54
    v_mfma_f32_16x16x32_bf16 v[192:195], v[212:215], a[172:175], v[192:195]
    v_mul_f32 v151, v151, v55
    v_cvt_pk_bf16_f32 v50, v148, v149
    v_cvt_pk_bf16_f32 v51, v150, v151
    v_mul_f32 v144, v56, v56
    v_mfma_f32_32x32x16_bf16 v[80:95], a[172:175], a[192:195], v[80:95]
    s_add_u32 m0, s78, 28672
    ds_read_b64_tr_b16 a[160:161], v188 offset:4096
    ds_read_b64_tr_b16 a[162:163], v188 offset:4352
    buffer_load_dwordx4 v187, s[8:11], s73 offen offset:3072 lds
    v_mul_f32 v145, v57, v57
    v_mul_f32 v146, v58, v58
    v_mul_f32 v147, v59, v59
    v_fma_f32 v144, v144, v234, v233
    v_fma_f32 v145, v145, v234, v233
    v_mfma_f32_32x32x16_bf16 v[96:111], a[172:175], a[196:199], v[96:111]
    s_waitcnt lgkmcnt(2)
    s_barrier
    ds_read_b128 a[176:179], v164 offset:16384
    ds_read_b128 a[180:183], v168 offset:16384
    v_fma_f32 v146, v146, v234, v233
    v_fma_f32 v147, v147, v234, v233
    v_mul_f32 v144, v144, v56
    v_mul_f32 v145, v145, v57
    v_mul_f32 v146, v146, v58
    v_mul_f32 v147, v147, v59
    v_mfma_f32_32x32x16_bf16 v[112:127], a[172:175], a[200:203], v[112:127]
    s_add_u32 m0, s78, 12288
    s_mul_i32 s73, s72, 1792
    s_add_u32 s73, s73, 256
    s_mul_i32 s49, s55, 7
    v_exp_f32 v144, v144
    v_mul_f32 v148, v60, v60
    v_mul_f32 v149, v61, v61
    v_mfma_f32_32x32x16_bf16 v[128:143], a[172:175], a[204:207], v[128:143]
    s_waitcnt vmcnt(14) lgkmcnt(0)
    ds_read_b128 a[184:187], v172 offset:16384
    ds_read_b128 a[188:191], v176 offset:16384
    buffer_load_dwordx4 v2, s[12:15], s49 offen offset:0 lds
    v_exp_f32 v145, v145
    v_mul_f32 v150, v62, v62
    v_mul_f32 v151, v63, v63
    v_exp_f32 v146, v146
    v_mfma_f32_32x32x16_bf16 v[80:95], a[160:163], a[176:179], v[80:95]
    s_add_u32 m0, s78, 32768
    ds_read_b64_tr_b16 a[164:165], v188 offset:5120
    ds_read_b64_tr_b16 a[166:167], v188 offset:5376
    buffer_load_dwordx4 v184, s[8:11], s73 offen offset:0 lds
    v_fma_f32 v148, v148, v234, v233
    v_fma_f32 v149, v149, v234, v233
    v_exp_f32 v147, v147
    v_fma_f32 v150, v150, v234, v233
    v_mfma_f32_32x32x16_bf16 v[96:111], a[160:163], a[180:183], v[96:111]
    s_waitcnt lgkmcnt(2)
    ds_read_b128 a[192:195], v165 offset:16384
    ds_read_b128 a[196:199], v169 offset:16384
    buffer_store_dwordx4 v[16:19], v240, s[20:23], 0 offen offset:0 sc1
    v_fma_f32 v151, v151, v234, v233
    v_fma_f32 v144, v144, v232, v232
    v_fma_f32 v145, v145, v232, v232
    v_rcp_f32 v144, v144
    v_mul_f32 v148, v148, v60
    v_mfma_f32_32x32x16_bf16 v[112:127], a[160:163], a[184:187], v[112:127]
    s_add_u32 m0, s78, 12288
    v_mul_f32 v149, v149, v61
    v_mul_f32 v150, v150, v62
    v_rcp_f32 v145, v145
    v_mul_f32 v151, v151, v63
    v_fma_f32 v146, v146, v232, v232
    v_fma_f32 v147, v147, v232, v232
    v_rcp_f32 v146, v146
    v_mfma_f32_32x32x16_bf16 v[128:143], a[160:163], a[188:191], v[128:143]
    s_waitcnt vmcnt(14) lgkmcnt(0)
    ds_read_b128 a[200:203], v173 offset:16384
    ds_read_b128 a[204:207], v177 offset:16384
    buffer_load_dwordx4 v3, s[12:15], s49 offen offset:1024 lds
    buffer_store_dwordx4 v[24:27], v240, s[20:23], 0 offen offset:2048 sc1
    v_mul_f32 v144, v144, v56
    v_rcp_f32 v147, v147
    v_mul_f32 v145, v145, v57
    v_mfma_f32_32x32x16_bf16 v[80:95], a[164:167], a[192:195], v[80:95]
    s_add_u32 m0, s78, 32768
    ds_read_b64_tr_b16 a[168:169], v188 offset:6144
    ds_read_b64_tr_b16 a[170:171], v188 offset:6400
    buffer_load_dwordx4 v185, s[8:11], s73 offen offset:1024 lds
    v_exp_f32 v148, v148
    v_cvt_pk_bf16_f32 v56, v144, v145
    v_exp_f32 v149, v149
    v_mfma_f32_32x32x16_bf16 v[96:111], a[164:167], a[196:199], v[96:111]
    s_waitcnt lgkmcnt(2)
    ds_read_b128 a[176:179], v166 offset:16384
    ds_read_b128 a[180:183], v170 offset:16384
    v_exp_f32 v150, v150
    v_mul_f32 v146, v146, v58
    v_exp_f32 v151, v151
    v_mul_f32 v147, v147, v59
    v_cvt_pk_bf16_f32 v57, v146, v147
    v_mfma_f32_32x32x16_bf16 v[112:127], a[164:167], a[200:203], v[112:127]
    s_add_u32 m0, s78, 12288
    buffer_store_dwordx4 v[32:35], v241, s[20:23], 0 offen offset:0 sc1
    v_fma_f32 v148, v148, v232, v232
    v_fma_f32 v149, v149, v232, v232
    v_rcp_f32 v148, v148
    v_fma_f32 v150, v150, v232, v232
    v_rcp_f32 v149, v149
    v_fma_f32 v151, v151, v232, v232
    v_mfma_f32_32x32x16_bf16 v[128:143], a[164:167], a[204:207], v[128:143]
    s_waitcnt vmcnt(15) lgkmcnt(0)
    ds_read_b128 a[184:187], v174 offset:16384
    ds_read_b128 a[188:191], v178 offset:16384
    buffer_load_dwordx4 v4, s[12:15], s49 offen offset:2048 lds
    v_rcp_f32 v150, v150
    v_rcp_f32 v151, v151
    v_mul_f32 v148, v148, v60
    v_mfma_f32_32x32x16_bf16 v[80:95], a[168:171], a[176:179], v[80:95]
    s_add_u32 m0, s78, 32768
    ds_read_b64_tr_b16 a[172:173], v188 offset:7168
    ds_read_b64_tr_b16 a[174:175], v188 offset:7424
    buffer_load_dwordx4 v186, s[8:11], s73 offen offset:2048 lds
    buffer_store_dwordx4 v[40:43], v241, s[20:23], 0 offen offset:2048 sc1
    v_mul_f32 v149, v149, v61
    v_mul_f32 v150, v150, v62
    v_mul_f32 v151, v151, v63
    v_cvt_pk_bf16_f32 v58, v148, v149
    v_cvt_pk_bf16_f32 v59, v150, v151
    v_mfma_f32_32x32x16_bf16 v[96:111], a[168:171], a[180:183], v[96:111]
    s_waitcnt lgkmcnt(2)
    ds_read_b128 a[192:195], v167 offset:16384
    ds_read_b128 a[196:199], v171 offset:16384
    v_mul_f32 v144, v64, v64
    v_mul_f32 v145, v65, v65
    v_mul_f32 v146, v66, v66
    v_mul_f32 v147, v67, v67
    v_fma_f32 v144, v144, v238, v237
    v_fma_f32 v145, v145, v238, v237
    v_mfma_f32_32x32x16_bf16 v[112:127], a[168:171], a[184:187], v[112:127]
    s_add_u32 m0, s78, 12288
    v_fma_f32 v146, v146, v238, v237
    v_fma_f32 v147, v147, v238, v237
    v_mul_f32 v144, v144, v64
    v_mul_f32 v145, v145, v65
    v_mul_f32 v146, v146, v66
    v_mul_f32 v147, v147, v67
    v_exp_f32 v144, v144
    v_mul_f32 v148, v68, v68
    v_mfma_f32_32x32x16_bf16 v[128:143], a[168:171], a[188:191], v[128:143]
    s_waitcnt vmcnt(16) lgkmcnt(0)
    ds_read_b128 a[200:203], v175 offset:16384
    ds_read_b128 a[204:207], v179 offset:16384
    buffer_load_dwordx4 v5, s[12:15], s49 offen offset:3072 lds
    buffer_store_dwordx4 v[48:51], v242, s[20:23], 0 offen offset:0 sc1
    v_mul_f32 v149, v69, v69
    v_exp_f32 v145, v145
    v_mul_f32 v150, v70, v70
    v_mfma_f32_16x16x32_bf16 v[200:203], v[212:215], a[160:163], v[200:203]
    v_mul_f32 v151, v71, v71
    v_exp_f32 v146, v146
    v_fma_f32 v148, v148, v238, v237
    v_fma_f32 v149, v149, v238, v237
    v_mfma_f32_16x16x32_bf16 v[192:195], v[212:215], a[164:167], v[192:195]
    v_exp_f32 v147, v147
    v_fma_f32 v150, v150, v238, v237
    v_fma_f32 v151, v151, v238, v237
    v_fma_f32 v144, v144, v236, v236
    v_mfma_f32_16x16x32_bf16 v[200:203], v[212:215], a[168:171], v[200:203]
    v_fma_f32 v145, v145, v236, v236
    v_rcp_f32 v144, v144
    v_mul_f32 v148, v148, v68
    v_mfma_f32_16x16x32_bf16 v[192:195], v[212:215], a[172:175], v[192:195]
    v_mul_f32 v149, v149, v69
    v_mul_f32 v150, v150, v70
    v_rcp_f32 v145, v145
    v_mul_f32 v151, v151, v71
    v_mfma_f32_32x32x16_bf16 v[80:95], a[172:175], a[192:195], v[80:95]
    s_add_u32 m0, s78, 32768
    ds_read_b64_tr_b16 a[160:161], v188 offset:0
    ds_read_b64_tr_b16 a[162:163], v188 offset:256
    buffer_load_dwordx4 v187, s[8:11], s73 offen offset:3072 lds
    buffer_store_dwordx4 v[56:59], v242, s[20:23], 0 offen offset:2048 sc1
    v_fma_f32 v146, v146, v236, v236
    v_fma_f32 v147, v147, v236, v236
    v_rcp_f32 v146, v146
    v_mul_f32 v144, v144, v64
    v_mfma_f32_32x32x16_bf16 v[96:111], a[172:175], a[196:199], v[96:111]
    s_waitcnt lgkmcnt(2)
    s_barrier
    ds_read_b128 a[176:179], v164 offset:20480
    ds_read_b128 a[180:183], v168 offset:20480
    v_rcp_f32 v147, v147
    v_mul_f32 v145, v145, v65
    v_exp_f32 v148, v148
    v_mfma_f32_32x32x16_bf16 v[112:127], a[172:175], a[200:203], v[112:127]
    s_add_u32 m0, s78, 16384
    s_mul_i32 s73, s59, 7
    s_mul_i32 s49, s56, 7
    v_cvt_pk_bf16_f32 v64, v144, v145
    v_exp_f32 v149, v149
    v_exp_f32 v150, v150
    v_mul_f32 v146, v146, v66
    v_mfma_f32_32x32x16_bf16 v[128:143], a[172:175], a[204:207], v[128:143]
    s_waitcnt vmcnt(18) lgkmcnt(0)
    ds_read_b128 a[184:187], v172 offset:20480
    ds_read_b128 a[188:191], v176 offset:20480
    buffer_load_dwordx4 v2, s[12:15], s49 offen offset:0 lds
    v_exp_f32 v151, v151
    v_mul_f32 v147, v147, v67
    v_cvt_pk_bf16_f32 v65, v146, v147
    v_fma_f32 v148, v148, v236, v236
    v_mfma_f32_32x32x16_bf16 v[80:95], a[160:163], a[176:179], v[80:95]
    s_add_u32 m0, s78, 28672
    ds_read_b64_tr_b16 a[164:165], v188 offset:1024
    ds_read_b64_tr_b16 a[166:167], v188 offset:1280
    buffer_load_dwordx4 v2, s[12:15], s73 offen offset:0 lds
    v_fma_f32 v149, v149, v236, v236
    v_rcp_f32 v148, v148
    v_fma_f32 v150, v150, v236, v236
    v_mfma_f32_32x32x16_bf16 v[96:111], a[160:163], a[180:183], v[96:111]
    s_waitcnt lgkmcnt(2)
    ds_read_b128 a[192:195], v165 offset:20480
    ds_read_b128 a[196:199], v169 offset:20480
    v_rcp_f32 v149, v149
    v_fma_f32 v151, v151, v236, v236
    v_rcp_f32 v150, v150
    v_rcp_f32 v151, v151
    v_mul_f32 v148, v148, v68
    v_mfma_f32_32x32x16_bf16 v[112:127], a[160:163], a[184:187], v[112:127]
    s_add_u32 m0, s78, 16384
    v_mul_f32 v149, v149, v69
    v_mul_f32 v150, v150, v70
    v_mul_f32 v151, v151, v71
    v_cvt_pk_bf16_f32 v66, v148, v149
    v_cvt_pk_bf16_f32 v67, v150, v151
    v_mul_f32 v144, v72, v72
    v_mul_f32 v145, v73, v73
    v_mul_f32 v146, v74, v74
    v_mfma_f32_32x32x16_bf16 v[128:143], a[160:163], a[188:191], v[128:143]
    s_waitcnt vmcnt(18) lgkmcnt(0)
    ds_read_b128 a[200:203], v173 offset:20480
    ds_read_b128 a[204:207], v177 offset:20480
    buffer_load_dwordx4 v3, s[12:15], s49 offen offset:1024 lds
    buffer_store_dwordx4 v[64:67], v243, s[20:23], 0 offen offset:0 sc1
    v_mul_f32 v147, v75, v75
    v_fma_f32 v144, v144, v238, v237
    v_fma_f32 v145, v145, v238, v237
    v_fma_f32 v146, v146, v238, v237
    v_fma_f32 v147, v147, v238, v237
    v_mfma_f32_32x32x16_bf16 v[80:95], a[164:167], a[192:195], v[80:95]
    s_add_u32 m0, s78, 28672
    ds_read_b64_tr_b16 a[168:169], v188 offset:2048
    ds_read_b64_tr_b16 a[170:171], v188 offset:2304
    buffer_load_dwordx4 v3, s[12:15], s73 offen offset:1024 lds
    v_mul_f32 v144, v144, v72
    v_mul_f32 v145, v145, v73
    v_mul_f32 v146, v146, v74
    v_mul_f32 v147, v147, v75
    v_mfma_f32_32x32x16_bf16 v[96:111], a[164:167], a[196:199], v[96:111]
    s_waitcnt lgkmcnt(2)
    ds_read_b128 a[176:179], v166 offset:20480
    ds_read_b128 a[180:183], v170 offset:20480
    v_exp_f32 v144, v144
    v_mul_f32 v148, v76, v76
    v_mul_f32 v149, v77, v77
    v_exp_f32 v145, v145
    v_mul_f32 v150, v78, v78
    v_mfma_f32_32x32x16_bf16 v[112:127], a[164:167], a[200:203], v[112:127]
    s_add_u32 m0, s78, 16384
    v_mul_f32 v151, v79, v79
    v_exp_f32 v146, v146
    v_fma_f32 v148, v148, v238, v237
    v_fma_f32 v149, v149, v238, v237
    v_exp_f32 v147, v147
    v_fma_f32 v150, v150, v238, v237
    v_fma_f32 v151, v151, v238, v237
    v_mfma_f32_32x32x16_bf16 v[128:143], a[164:167], a[204:207], v[128:143]
    s_waitcnt vmcnt(19) lgkmcnt(0)
    ds_read_b128 a[184:187], v174 offset:20480
    ds_read_b128 a[188:191], v178 offset:20480
    buffer_load_dwordx4 v4, s[12:15], s49 offen offset:2048 lds
    v_fma_f32 v144, v144, v236, v236
    v_fma_f32 v145, v145, v236, v236
    v_rcp_f32 v144, v144
    v_mfma_f32_32x32x16_bf16 v[80:95], a[168:171], a[176:179], v[80:95]
    s_add_u32 m0, s78, 28672
    ds_read_b64_tr_b16 a[172:173], v188 offset:3072
    ds_read_b64_tr_b16 a[174:175], v188 offset:3328
    buffer_load_dwordx4 v4, s[12:15], s73 offen offset:2048 lds
    v_mul_f32 v148, v148, v76
    v_mul_f32 v149, v149, v77
    v_mul_f32 v150, v150, v78
    v_rcp_f32 v145, v145
    v_mfma_f32_32x32x16_bf16 v[96:111], a[168:171], a[180:183], v[96:111]
    s_waitcnt lgkmcnt(2)
    ds_read_b128 a[192:195], v167 offset:20480
    ds_read_b128 a[196:199], v171 offset:20480
    v_mul_f32 v151, v151, v79
    v_fma_f32 v146, v146, v236, v236
    v_fma_f32 v147, v147, v236, v236
    v_rcp_f32 v146, v146
    v_mul_f32 v144, v144, v72
    v_mfma_f32_32x32x16_bf16 v[112:127], a[168:171], a[184:187], v[112:127]
    s_add_u32 m0, s78, 16384
    v_rcp_f32 v147, v147
    v_mul_f32 v145, v145, v73
    v_exp_f32 v148, v148
    v_cvt_pk_bf16_f32 v72, v144, v145
    v_exp_f32 v149, v149
    v_mfma_f32_32x32x16_bf16 v[128:143], a[168:171], a[188:191], v[128:143]
    s_waitcnt vmcnt(19) lgkmcnt(0)
    ds_read_b128 a[200:203], v175 offset:20480
    ds_read_b128 a[204:207], v179 offset:20480
    buffer_load_dwordx4 v5, s[12:15], s49 offen offset:3072 lds
    v_exp_f32 v150, v150
    v_mul_f32 v146, v146, v74
    v_exp_f32 v151, v151
    v_mul_f32 v147, v147, v75
    v_mfma_f32_16x16x32_bf16 v[200:203], v[212:215], a[160:163], v[200:203]
    v_cvt_pk_bf16_f32 v73, v146, v147
    v_fma_f32 v148, v148, v236, v236
    v_fma_f32 v149, v149, v236, v236
    v_rcp_f32 v148, v148
    v_mfma_f32_16x16x32_bf16 v[192:195], v[212:215], a[164:167], v[192:195]
    v_fma_f32 v150, v150, v236, v236
    v_rcp_f32 v149, v149
    v_fma_f32 v151, v151, v236, v236
    v_mfma_f32_16x16x32_bf16 v[200:203], v[212:215], a[168:171], v[200:203]
    v_rcp_f32 v150, v150
    v_rcp_f32 v151, v151
    v_mul_f32 v148, v148, v76
    v_mfma_f32_16x16x32_bf16 v[192:195], v[212:215], a[172:175], v[192:195]
    v_mul_f32 v149, v149, v77
    v_mul_f32 v150, v150, v78
    v_mul_f32 v151, v151, v79
    v_cvt_pk_bf16_f32 v74, v148, v149
    v_cvt_pk_bf16_f32 v75, v150, v151
    v_mfma_f32_32x32x16_bf16 v[80:95], a[172:175], a[192:195], v[80:95]
    s_add_u32 m0, s78, 28672
    ds_read_b64_tr_b16 a[160:161], v188 offset:4096
    ds_read_b64_tr_b16 a[162:163], v188 offset:4352
    buffer_load_dwordx4 v5, s[12:15], s73 offen offset:3072 lds
    buffer_store_dwordx4 v[72:75], v243, s[20:23], 0 offen offset:2048 sc1
    v_mfma_f32_32x32x16_bf16 v[96:111], a[172:175], a[196:199], v[96:111]
    s_waitcnt lgkmcnt(2)
    s_barrier
    ds_read_b128 a[176:179], v164 offset:24576
    ds_read_b128 a[180:183], v168 offset:24576
    s_cmp_ge_u32 s44, 2
    s_cselect_b64 vcc, -1, 0
    v_cndmask_b32 v160, v16, v48, vcc
    v_mfma_f32_32x32x16_bf16 v[112:127], a[172:175], a[200:203], v[112:127]
    s_add_u32 m0, s78, 20480
    s_mul_i32 s73, s62, 25088
    s_add_u32 s73, s73, s61
    s_mul_i32 s49, s57, 7
    v_cndmask_b32 v161, v17, v49, vcc
    v_cndmask_b32 v162, v18, v50, vcc
    v_cndmask_b32 v163, v19, v51, vcc
    v_mfma_f32_32x32x16_bf16 v[128:143], a[172:175], a[204:207], v[128:143]
    s_waitcnt vmcnt(18) lgkmcnt(0)
    ds_read_b128 a[184:187], v172 offset:24576
    ds_read_b128 a[188:191], v176 offset:24576
    buffer_load_dwordx4 v2, s[12:15], s49 offen offset:0 lds
    v_cndmask_b32 v184, v24, v56, vcc
    v_cndmask_b32 v185, v25, v57, vcc
    v_mfma_f32_32x32x16_bf16 v[80:95], a[160:163], a[176:179], v[80:95]
    s_add_u32 m0, s78, 32768
    ds_read_b64_tr_b16 a[164:165], v188 offset:5120
    ds_read_b64_tr_b16 a[166:167], v188 offset:5376
    buffer_load_dwordx4 v2, s[16:19], s73 offen offset:0 lds
    v_cndmask_b32 v186, v26, v58, vcc
    v_cndmask_b32 v187, v27, v59, vcc
    v_mfma_f32_32x32x16_bf16 v[96:111], a[160:163], a[180:183], v[96:111]
    s_waitcnt lgkmcnt(2)
    ds_read_b128 a[192:195], v165 offset:24576
    ds_read_b128 a[196:199], v169 offset:24576
    v_cndmask_b32 v180, v32, v64, vcc
    v_cndmask_b32 v181, v33, v65, vcc
    v_cndmask_b32 v182, v34, v66, vcc
    v_cndmask_b32 v183, v35, v67, vcc
    v_mfma_f32_32x32x16_bf16 v[112:127], a[160:163], a[184:187], v[112:127]
    s_add_u32 m0, s78, 20480
    v_cndmask_b32 v196, v40, v72, vcc
    v_cndmask_b32 v197, v41, v73, vcc
    v_cndmask_b32 v198, v42, v74, vcc
    v_cndmask_b32 v199, v43, v75, vcc
    s_mul_i32 s51, s47, 294912
    s_lshl_b32 s52, s44, 12
    v_mfma_f32_32x32x16_bf16 v[128:143], a[160:163], a[188:191], v[128:143]
    s_waitcnt vmcnt(17) lgkmcnt(0)
    ds_read_b128 a[200:203], v173 offset:24576
    ds_read_b128 a[204:207], v177 offset:24576
    buffer_load_dwordx4 v3, s[12:15], s49 offen offset:1024 lds
    s_add_u32 s51, s51, s52
    s_and_b32 s52, s44, 1
    v_mfma_f32_32x32x16_bf16 v[80:95], a[164:167], a[192:195], v[80:95]
    s_add_u32 m0, s78, 32768
    ds_read_b64_tr_b16 a[168:169], v188 offset:6144
    ds_read_b64_tr_b16 a[170:171], v188 offset:6400
    buffer_load_dwordx4 v3, s[16:19], s73 offen offset:1024 lds
    s_lshl_b32 s52, s52, 10
    s_add_u32 s51, s51, s52
    v_mfma_f32_32x32x16_bf16 v[96:111], a[164:167], a[196:199], v[96:111]
    s_waitcnt lgkmcnt(2)
    ds_read_b128 a[176:179], v166 offset:24576
    ds_read_b128 a[180:183], v170 offset:24576
    v_lshl_add_u32 v8, v1, 4, s51
    v_xor_b32 v9, 1024, v8
    s_lshr_b32 s51, s47, 1
    s_lshl2_add_u32 s51, s51, s44
    v_mfma_f32_32x32x16_bf16 v[112:127], a[164:167], a[200:203], v[112:127]
    s_add_u32 m0, s78, 20480
    s_lshl_b32 s51, s51, 8
    v_and_b32 v10, 31, v1
    s_add_u32 s51, s51, 12582912
    v_lshl_add_u32 v10, v10, 2, s51
    v_lshrrev_b32 v6, 5, v1
    v_lshlrev_b32 v6, 2, v6
    v_mfma_f32_32x32x16_bf16 v[128:143], a[164:167], a[204:207], v[128:143]
    s_waitcnt vmcnt(15) lgkmcnt(0)
    ds_read_b128 a[184:187], v174 offset:24576
    ds_read_b128 a[188:191], v178 offset:24576
    buffer_load_dwordx4 v4, s[12:15], s49 offen offset:2048 lds
    v_bfe_u32 v14, v1, 2, 2
    v_add_u32 v6, v6, v14
    v_mfma_f32_32x32x16_bf16 v[80:95], a[168:171], a[176:179], v[80:95]
    s_add_u32 m0, s78, 32768
    ds_read_b64_tr_b16 a[172:173], v188 offset:7168
    ds_read_b64_tr_b16 a[174:175], v188 offset:7424
    buffer_load_dwordx4 v4, s[16:19], s73 offen offset:2048 lds
    v_lshlrev_b32 v6, 7, v6
    v_bfe_u32 v14, v1, 3, 1
    v_mfma_f32_32x32x16_bf16 v[96:111], a[168:171], a[180:183], v[96:111]
    s_waitcnt lgkmcnt(2)
    ds_read_b128 a[192:195], v167 offset:24576
    ds_read_b128 a[196:199], v171 offset:24576
    v_lshl_add_u32 v6, v14, 6, v6
    v_bfe_u32 v14, v1, 4, 1
    v_lshl_add_u32 v6, v14, 5, v6
    v_and_b32 v14, 1, v1
    v_mfma_f32_32x32x16_bf16 v[112:127], a[168:171], a[184:187], v[112:127]
    s_add_u32 m0, s78, 20480
    v_lshl_add_u32 v6, v14, 4, v6
    v_bfe_u32 v14, v1, 1, 1
    v_lshl_add_u32 v6, v14, 3, v6
    s_lshr_b32 s51, s44, 1
    s_lshl_b32 s51, s51, 6
    v_xor_b32 v6, s51, v6
    v_mfma_f32_32x32x16_bf16 v[128:143], a[168:171], a[188:191], v[128:143]
    s_waitcnt lgkmcnt(0)
    ds_read_b128 a[200:203], v175 offset:24576
    ds_read_b128 a[204:207], v179 offset:24576
    buffer_load_dwordx4 v5, s[12:15], s49 offen offset:3072 lds
    v_add_u32 v6, s78, v6
    v_xor_b32 v7, 64, v6
    v_mfma_f32_16x16x32_bf16 v[200:203], v[212:215], a[160:163], v[200:203]
    v_lshrrev_b32 v244, 5, v1
    v_mul_u32_u24 v244, 2272, v244
    v_mfma_f32_16x16x32_bf16 v[192:195], v[212:215], a[164:167], v[192:195]
    v_add_u32 v244, v244, v1
    v_lshl_add_u32 v244, v244, 7, s42
    v_mfma_f32_16x16x32_bf16 v[200:203], v[212:215], a[168:171], v[200:203]
    v_mfma_f32_16x16x32_bf16 v[192:195], v[212:215], a[172:175], v[192:195]
    v_mfma_f32_32x32x16_bf16 v[80:95], a[172:175], a[192:195], v[80:95]
    s_add_u32 m0, s78, 32768
    s_nop 0
    buffer_load_dwordx4 v5, s[16:19], s73 offen offset:3072 lds
    v_mfma_f32_32x32x16_bf16 v[96:111], a[172:175], a[196:199], v[96:111]
    s_waitcnt lgkmcnt(0)
    s_barrier
    s_nop 0
    v_add_f32 v206, v200, v192
    v_cndmask_b32 v206, 0, v206, s[74:75]
    v_lshlrev_b32 v208, 16, v222
    v_cvt_pk_bf16_f32 v221, v206, v208
    v_mov_b32 v223, 0
    v_mfma_f32_32x32x16_bf16 v[112:127], a[172:175], a[200:203], v[112:127]
    s_add_u32 m0, s78, 24576
    s_waitcnt vmcnt(8)
    buffer_store_dword v13, v11, s[20:23], 0 offen
    s_mul_i32 s49, s58, 7
    v_lshlrev_b32 v207, 16, v221
    v_sub_f32 v207, v206, v207
    v_cvt_pk_bf16_f32 v220, v206, v207
    v_mfma_f32_32x32x16_bf16 v[128:143], a[172:175], a[204:207], v[128:143]
    buffer_load_dwordx4 v2, s[12:15], s49 offen offset:0 lds
    v_mfma_f32_32x32x16_bf16 v[80:95], v[220:223], v[248:251], v[80:95]
    buffer_load_dwordx4 v3, s[12:15], s49 offen offset:1024 lds
    v_mfma_f32_32x32x16_bf16 v[96:111], v[220:223], a[208:211], v[96:111]
    buffer_load_dwordx4 v4, s[12:15], s49 offen offset:2048 lds
    v_mfma_f32_32x32x16_bf16 v[112:127], v[220:223], a[212:215], v[112:127]
    buffer_load_dwordx4 v5, s[12:15], s49 offen offset:3072 lds
    v_mfma_f32_32x32x16_bf16 v[128:143], v[220:223], a[216:219], v[128:143]
    s_nop 5
    v_pk_mul_f32 v[144:145], v[80:81], v[80:81]
    s_mul_i32 s49, s57, 7
    s_add_u32 s49, s49, 114688
    buffer_load_dwordx4 a[96:99], v2, s[12:15], s49 offen offset:0
    v_pk_mul_f32 v[146:147], v[82:83], v[82:83]
    v_pk_mul_f32 v[148:149], v[84:85], v[84:85]
    v_pk_mul_f32 v[150:151], v[86:87], v[86:87]
    v_pk_fma_f32 v[144:145], v[144:145], v[226:227], v[224:225] op_sel:[0,0,1] op_sel_hi:[1,0,1]
    v_pk_fma_f32 v[146:147], v[146:147], v[226:227], v[224:225] op_sel:[0,0,1] op_sel_hi:[1,0,1]
    v_pk_fma_f32 v[148:149], v[148:149], v[226:227], v[224:225] op_sel:[0,0,1] op_sel_hi:[1,0,1]
    v_pk_fma_f32 v[150:151], v[150:151], v[226:227], v[224:225] op_sel:[0,0,1] op_sel_hi:[1,0,1]
    v_pk_mul_f32 v[144:145], v[144:145], v[80:81]
    v_pk_mul_f32 v[146:147], v[146:147], v[82:83]
    v_pk_mul_f32 v[148:149], v[148:149], v[84:85]
    v_pk_mul_f32 v[150:151], v[150:151], v[86:87]
    v_exp_f32 v144, v144
    v_exp_f32 v145, v145
    v_exp_f32 v146, v146
    v_exp_f32 v147, v147
    v_exp_f32 v148, v148
    v_exp_f32 v149, v149
    v_exp_f32 v150, v150
    v_exp_f32 v151, v151
    v_pk_fma_f32 v[144:145], v[144:145], v[224:225], v[224:225] op_sel:[0,0,0] op_sel_hi:[1,0,0]
    buffer_load_dwordx4 a[100:103], v3, s[12:15], s49 offen offset:1024
    v_pk_fma_f32 v[146:147], v[146:147], v[224:225], v[224:225] op_sel:[0,0,0] op_sel_hi:[1,0,0]
    v_pk_fma_f32 v[148:149], v[148:149], v[224:225], v[224:225] op_sel:[0,0,0] op_sel_hi:[1,0,0]
    v_pk_fma_f32 v[150:151], v[150:151], v[224:225], v[224:225] op_sel:[0,0,0] op_sel_hi:[1,0,0]
    v_rcp_f32 v144, v144
    v_pk_mul_f32 v[32:33], v[88:89], v[88:89]
    v_rcp_f32 v145, v145
    v_pk_mul_f32 v[34:35], v[90:91], v[90:91]
    v_pk_mul_f32 v[36:37], v[92:93], v[92:93]
    v_rcp_f32 v146, v146
    v_pk_mul_f32 v[38:39], v[94:95], v[94:95]
    v_rcp_f32 v147, v147
    v_pk_fma_f32 v[32:33], v[32:33], v[226:227], v[224:225] op_sel:[0,0,1] op_sel_hi:[1,0,1]
    v_pk_fma_f32 v[34:35], v[34:35], v[226:227], v[224:225] op_sel:[0,0,1] op_sel_hi:[1,0,1]
    v_rcp_f32 v148, v148
    v_pk_fma_f32 v[36:37], v[36:37], v[226:227], v[224:225] op_sel:[0,0,1] op_sel_hi:[1,0,1]
    v_rcp_f32 v149, v149
    v_pk_fma_f32 v[38:39], v[38:39], v[226:227], v[224:225] op_sel:[0,0,1] op_sel_hi:[1,0,1]
    v_pk_mul_f32 v[32:33], v[32:33], v[88:89]
    v_rcp_f32 v150, v150
    v_pk_mul_f32 v[34:35], v[34:35], v[90:91]
    buffer_load_dwordx4 a[104:107], v4, s[12:15], s49 offen offset:2048
    v_rcp_f32 v151, v151
    v_pk_mul_f32 v[36:37], v[36:37], v[92:93]
    v_pk_mul_f32 v[38:39], v[38:39], v[94:95]
    v_exp_f32 v32, v32
    v_pk_mul_f32 v[144:145], v[144:145], v[80:81]
    v_exp_f32 v33, v33
    v_pk_mul_f32 v[146:147], v[146:147], v[82:83]
    v_exp_f32 v34, v34
    v_pk_mul_f32 v[148:149], v[148:149], v[84:85]
    v_exp_f32 v35, v35
    v_pk_mul_f32 v[150:151], v[150:151], v[86:87]
    v_exp_f32 v36, v36
    v_cvt_pk_bf16_f32 v164, v144, v145
    v_exp_f32 v37, v37
    v_cvt_pk_bf16_f32 v165, v146, v147
    v_exp_f32 v38, v38
    v_cvt_pk_bf16_f32 v166, v148, v149
    v_exp_f32 v39, v39
    v_cvt_pk_bf16_f32 v167, v150, v151
    buffer_store_dwordx4 v[164:167], v240, s[20:23], s3 offen offset:0 sc1
    v_pk_fma_f32 v[32:33], v[32:33], v[224:225], v[224:225] op_sel:[0,0,0] op_sel_hi:[1,0,0]
    buffer_load_dwordx4 a[108:111], v5, s[12:15], s49 offen offset:3072
    v_pk_fma_f32 v[34:35], v[34:35], v[224:225], v[224:225] op_sel:[0,0,0] op_sel_hi:[1,0,0]
    v_pk_fma_f32 v[36:37], v[36:37], v[224:225], v[224:225] op_sel:[0,0,0] op_sel_hi:[1,0,0]
    v_pk_fma_f32 v[38:39], v[38:39], v[224:225], v[224:225] op_sel:[0,0,0] op_sel_hi:[1,0,0]
    v_rcp_f32 v32, v32
    v_pk_mul_f32 v[144:145], v[96:97], v[96:97]
    v_rcp_f32 v33, v33
    v_pk_mul_f32 v[146:147], v[98:99], v[98:99]
    v_pk_mul_f32 v[148:149], v[100:101], v[100:101]
    v_rcp_f32 v34, v34
    v_pk_mul_f32 v[150:151], v[102:103], v[102:103]
    v_rcp_f32 v35, v35
    v_pk_fma_f32 v[144:145], v[144:145], v[230:231], v[228:229] op_sel:[0,0,1] op_sel_hi:[1,0,1]
    v_pk_fma_f32 v[146:147], v[146:147], v[230:231], v[228:229] op_sel:[0,0,1] op_sel_hi:[1,0,1]
    s_mul_i32 s49, s58, 7
    s_add_u32 s49, s49, 114688
    buffer_load_dwordx4 a[112:115], v2, s[12:15], s49 offen offset:0
    v_rcp_f32 v36, v36
    v_pk_fma_f32 v[148:149], v[148:149], v[230:231], v[228:229] op_sel:[0,0,1] op_sel_hi:[1,0,1]
    v_rcp_f32 v37, v37
    v_pk_fma_f32 v[150:151], v[150:151], v[230:231], v[228:229] op_sel:[0,0,1] op_sel_hi:[1,0,1]
    v_pk_mul_f32 v[144:145], v[144:145], v[96:97]
    v_rcp_f32 v38, v38
    v_pk_mul_f32 v[146:147], v[146:147], v[98:99]
    v_rcp_f32 v39, v39
    v_pk_mul_f32 v[148:149], v[148:149], v[100:101]
    v_pk_mul_f32 v[150:151], v[150:151], v[102:103]
    v_exp_f32 v144, v144
    v_pk_mul_f32 v[32:33], v[32:33], v[88:89]
    v_exp_f32 v145, v145
    buffer_load_dwordx4 a[116:119], v3, s[12:15], s49 offen offset:1024
    v_pk_mul_f32 v[34:35], v[34:35], v[90:91]
    v_exp_f32 v146, v146
    v_pk_mul_f32 v[36:37], v[36:37], v[92:93]
    v_exp_f32 v147, v147
    v_pk_mul_f32 v[38:39], v[38:39], v[94:95]
    v_exp_f32 v148, v148
    v_cvt_pk_bf16_f32 v172, v32, v33
    v_exp_f32 v149, v149
    v_cvt_pk_bf16_f32 v173, v34, v35
    v_exp_f32 v150, v150
    v_cvt_pk_bf16_f32 v174, v36, v37
    v_exp_f32 v151, v151
    v_cvt_pk_bf16_f32 v175, v38, v39
    buffer_store_dwordx4 v[172:175], v240, s[20:23], s3 offen offset:2048 sc1
    v_pk_fma_f32 v[144:145], v[144:145], v[228:229], v[228:229] op_sel:[0,0,0] op_sel_hi:[1,0,0]
    buffer_load_dwordx4 a[120:123], v4, s[12:15], s49 offen offset:2048
    v_pk_fma_f32 v[146:147], v[146:147], v[228:229], v[228:229] op_sel:[0,0,0] op_sel_hi:[1,0,0]
    v_pk_fma_f32 v[148:149], v[148:149], v[228:229], v[228:229] op_sel:[0,0,0] op_sel_hi:[1,0,0]
    v_pk_fma_f32 v[150:151], v[150:151], v[228:229], v[228:229] op_sel:[0,0,0] op_sel_hi:[1,0,0]
    v_rcp_f32 v144, v144
    v_pk_mul_f32 v[32:33], v[104:105], v[104:105]
    v_rcp_f32 v145, v145
    v_pk_mul_f32 v[34:35], v[106:107], v[106:107]
    v_pk_mul_f32 v[36:37], v[108:109], v[108:109]
    v_rcp_f32 v146, v146
    v_pk_mul_f32 v[38:39], v[110:111], v[110:111]
    v_rcp_f32 v147, v147
    v_pk_fma_f32 v[32:33], v[32:33], v[230:231], v[228:229] op_sel:[0,0,1] op_sel_hi:[1,0,1]
    v_pk_fma_f32 v[34:35], v[34:35], v[230:231], v[228:229] op_sel:[0,0,1] op_sel_hi:[1,0,1]
    v_rcp_f32 v148, v148
    v_pk_fma_f32 v[36:37], v[36:37], v[230:231], v[228:229] op_sel:[0,0,1] op_sel_hi:[1,0,1]
    v_rcp_f32 v149, v149
    v_pk_fma_f32 v[38:39], v[38:39], v[230:231], v[228:229] op_sel:[0,0,1] op_sel_hi:[1,0,1]
    v_pk_mul_f32 v[32:33], v[32:33], v[104:105]
    v_rcp_f32 v150, v150
    v_pk_mul_f32 v[34:35], v[34:35], v[106:107]
    buffer_load_dwordx4 a[124:127], v5, s[12:15], s49 offen offset:3072
    v_rcp_f32 v151, v151
    v_pk_mul_f32 v[36:37], v[36:37], v[108:109]
    v_pk_mul_f32 v[38:39], v[38:39], v[110:111]
    v_exp_f32 v32, v32
    v_pk_mul_f32 v[144:145], v[144:145], v[96:97]
    v_exp_f32 v33, v33
    v_pk_mul_f32 v[146:147], v[146:147], v[98:99]
    v_exp_f32 v34, v34
    v_pk_mul_f32 v[148:149], v[148:149], v[100:101]
    v_exp_f32 v35, v35
    v_pk_mul_f32 v[150:151], v[150:151], v[102:103]
    v_exp_f32 v36, v36
    v_cvt_pk_bf16_f32 v168, v144, v145
    v_exp_f32 v37, v37
    v_cvt_pk_bf16_f32 v169, v146, v147
    v_exp_f32 v38, v38
    v_cvt_pk_bf16_f32 v170, v148, v149
    v_exp_f32 v39, v39
    v_cvt_pk_bf16_f32 v171, v150, v151
    buffer_store_dwordx4 v[168:171], v241, s[20:23], s3 offen offset:0 sc1
    v_pk_fma_f32 v[32:33], v[32:33], v[228:229], v[228:229] op_sel:[0,0,0] op_sel_hi:[1,0,0]
    s_mul_i32 s49, s59, 7
    s_add_u32 s49, s49, 114688
    buffer_load_dwordx4 a[128:131], v2, s[12:15], s49 offen offset:0
    v_pk_fma_f32 v[34:35], v[34:35], v[228:229], v[228:229] op_sel:[0,0,0] op_sel_hi:[1,0,0]
    v_pk_fma_f32 v[36:37], v[36:37], v[228:229], v[228:229] op_sel:[0,0,0] op_sel_hi:[1,0,0]
    v_pk_fma_f32 v[38:39], v[38:39], v[228:229], v[228:229] op_sel:[0,0,0] op_sel_hi:[1,0,0]
    v_rcp_f32 v32, v32
    v_pk_mul_f32 v[144:145], v[112:113], v[112:113]
    v_rcp_f32 v33, v33
    v_pk_mul_f32 v[146:147], v[114:115], v[114:115]
    v_pk_mul_f32 v[148:149], v[116:117], v[116:117]
    v_rcp_f32 v34, v34
    s_mov_b32 s66, s76
    s_mov_b32 s67, s76
    s_buffer_load_dwordx8 s[68:75], s[20:23], s43
    v_pk_mul_f32 v[150:151], v[118:119], v[118:119]
    v_rcp_f32 v35, v35
    v_pk_fma_f32 v[144:145], v[144:145], v[234:235], v[232:233] op_sel:[0,0,1] op_sel_hi:[1,0,1]
    v_pk_fma_f32 v[146:147], v[146:147], v[234:235], v[232:233] op_sel:[0,0,1] op_sel_hi:[1,0,1]
    v_rcp_f32 v36, v36
    v_pk_fma_f32 v[148:149], v[148:149], v[234:235], v[232:233] op_sel:[0,0,1] op_sel_hi:[1,0,1]
    v_rcp_f32 v37, v37
    v_pk_fma_f32 v[150:151], v[150:151], v[234:235], v[232:233] op_sel:[0,0,1] op_sel_hi:[1,0,1]
    v_pk_mul_f32 v[144:145], v[144:145], v[112:113]
    v_rcp_f32 v38, v38
    buffer_load_dwordx4 a[132:135], v3, s[12:15], s49 offen offset:1024
    v_pk_mul_f32 v[146:147], v[146:147], v[114:115]
    v_rcp_f32 v39, v39
    v_pk_mul_f32 v[148:149], v[148:149], v[116:117]
    v_pk_mul_f32 v[150:151], v[150:151], v[118:119]
    v_exp_f32 v144, v144
    v_pk_mul_f32 v[32:33], v[32:33], v[104:105]
    v_exp_f32 v145, v145
    v_pk_mul_f32 v[34:35], v[34:35], v[106:107]
    v_exp_f32 v146, v146
    v_pk_mul_f32 v[36:37], v[36:37], v[108:109]
    v_exp_f32 v147, v147
    v_pk_mul_f32 v[38:39], v[38:39], v[110:111]
    v_exp_f32 v148, v148
    v_cvt_pk_bf16_f32 v176, v32, v33
    v_exp_f32 v149, v149
    v_cvt_pk_bf16_f32 v177, v34, v35
    v_exp_f32 v150, v150
    v_cvt_pk_bf16_f32 v178, v36, v37
    v_exp_f32 v151, v151
    v_cvt_pk_bf16_f32 v179, v38, v39
    buffer_store_dwordx4 v[176:179], v241, s[20:23], s3 offen offset:2048 sc1
    s_waitcnt lgkmcnt(0)
    s_xor_b64 s[68:69], s[68:69], s[66:67]
    s_xor_b64 s[70:71], s[70:71], s[66:67]
    s_xor_b64 s[72:73], s[72:73], s[66:67]
    s_xor_b32 s74, s74, s66
    s_or_b64 s[68:69], s[68:69], s[70:71]
    s_or_b32 s72, s72, s74
    s_or_b64 s[68:69], s[68:69], s[72:73]
    s_cbranch_scc1 Lcm0_p
Lcm0_k:
    v_pk_fma_f32 v[144:145], v[144:145], v[232:233], v[232:233] op_sel:[0,0,0] op_sel_hi:[1,0,0]
    buffer_load_dwordx4 a[136:139], v4, s[12:15], s49 offen offset:2048
    v_pk_fma_f32 v[146:147], v[146:147], v[232:233], v[232:233] op_sel:[0,0,0] op_sel_hi:[1,0,0]
    v_pk_fma_f32 v[148:149], v[148:149], v[232:233], v[232:233] op_sel:[0,0,0] op_sel_hi:[1,0,0]
    v_pk_fma_f32 v[150:151], v[150:151], v[232:233], v[232:233] op_sel:[0,0,0] op_sel_hi:[1,0,0]
    v_rcp_f32 v144, v144
    v_pk_mul_f32 v[32:33], v[120:121], v[120:121]
    v_rcp_f32 v145, v145
    v_pk_mul_f32 v[34:35], v[122:123], v[122:123]
    v_pk_mul_f32 v[36:37], v[124:125], v[124:125]
    v_rcp_f32 v146, v146
    v_pk_mul_f32 v[38:39], v[126:127], v[126:127]
    v_rcp_f32 v147, v147
    v_pk_fma_f32 v[32:33], v[32:33], v[234:235], v[232:233] op_sel:[0,0,1] op_sel_hi:[1,0,1]
    v_pk_fma_f32 v[34:35], v[34:35], v[234:235], v[232:233] op_sel:[0,0,1] op_sel_hi:[1,0,1]
    buffer_load_dwordx4 a[140:143], v5, s[12:15], s49 offen offset:3072
    v_rcp_f32 v148, v148
    v_pk_fma_f32 v[36:37], v[36:37], v[234:235], v[232:233] op_sel:[0,0,1] op_sel_hi:[1,0,1]
    v_rcp_f32 v149, v149
    v_pk_fma_f32 v[38:39], v[38:39], v[234:235], v[232:233] op_sel:[0,0,1] op_sel_hi:[1,0,1]
    v_pk_mul_f32 v[32:33], v[32:33], v[120:121]
    v_rcp_f32 v150, v150
    v_pk_mul_f32 v[34:35], v[34:35], v[122:123]
    v_rcp_f32 v151, v151
    v_pk_mul_f32 v[36:37], v[36:37], v[124:125]
    v_pk_mul_f32 v[38:39], v[38:39], v[126:127]
    v_exp_f32 v32, v32
    v_pk_mul_f32 v[144:145], v[144:145], v[112:113]
    v_exp_f32 v33, v33
    buffer_load_dwordx4 a[144:147], v8, s[20:23], s54 offen offset:0 sc1
    v_pk_mul_f32 v[146:147], v[146:147], v[114:115]
    v_exp_f32 v34, v34
    v_pk_mul_f32 v[148:149], v[148:149], v[116:117]
    v_exp_f32 v35, v35
    v_pk_mul_f32 v[150:151], v[150:151], v[118:119]
    v_exp_f32 v36, v36
    v_cvt_pk_bf16_f32 v152, v144, v145
    v_exp_f32 v37, v37
    v_cvt_pk_bf16_f32 v153, v146, v147
    v_exp_f32 v38, v38
    v_cvt_pk_bf16_f32 v154, v148, v149
    v_exp_f32 v39, v39
    v_cvt_pk_bf16_f32 v155, v150, v151
    s_cmp_ge_u32 s44, 2
    s_cselect_b64 vcc, -1, 0
    buffer_store_dwordx4 v[152:155], v242, s[20:23], s3 offen offset:0 sc1
    v_cndmask_b32 v164, v164, v152, vcc
    v_cndmask_b32 v165, v165, v153, vcc
    v_cndmask_b32 v166, v166, v154, vcc
    v_cndmask_b32 v167, v167, v155, vcc
    v_pk_fma_f32 v[32:33], v[32:33], v[232:233], v[232:233] op_sel:[0,0,0] op_sel_hi:[1,0,0]
    buffer_load_dwordx4 a[148:151], v9, s[20:23], s54 offen offset:0 sc1
    v_pk_fma_f32 v[34:35], v[34:35], v[232:233], v[232:233] op_sel:[0,0,0] op_sel_hi:[1,0,0]
    v_pk_fma_f32 v[36:37], v[36:37], v[232:233], v[232:233] op_sel:[0,0,0] op_sel_hi:[1,0,0]
    v_pk_fma_f32 v[38:39], v[38:39], v[232:233], v[232:233] op_sel:[0,0,0] op_sel_hi:[1,0,0]
    v_rcp_f32 v32, v32
    v_pk_mul_f32 v[144:145], v[128:129], v[128:129]
    v_rcp_f32 v33, v33
    v_pk_mul_f32 v[146:147], v[130:131], v[130:131]
    v_pk_mul_f32 v[148:149], v[132:133], v[132:133]
    v_rcp_f32 v34, v34
    v_pk_mul_f32 v[150:151], v[134:135], v[134:135]
    v_rcp_f32 v35, v35
    v_pk_fma_f32 v[144:145], v[144:145], v[238:239], v[236:237] op_sel:[0,0,1] op_sel_hi:[1,0,1]
    v_pk_fma_f32 v[146:147], v[146:147], v[238:239], v[236:237] op_sel:[0,0,1] op_sel_hi:[1,0,1]
    v_rcp_f32 v36, v36
    v_pk_fma_f32 v[148:149], v[148:149], v[238:239], v[236:237] op_sel:[0,0,1] op_sel_hi:[1,0,1]
    v_rcp_f32 v37, v37
    v_pk_fma_f32 v[150:151], v[150:151], v[238:239], v[236:237] op_sel:[0,0,1] op_sel_hi:[1,0,1]
    v_pk_mul_f32 v[144:145], v[144:145], v[128:129]
    v_rcp_f32 v38, v38
    v_pk_mul_f32 v[146:147], v[146:147], v[130:131]
    v_rcp_f32 v39, v39
    v_pk_mul_f32 v[148:149], v[148:149], v[132:133]
    v_pk_mul_f32 v[150:151], v[150:151], v[134:135]
    v_exp_f32 v144, v144
    v_pk_mul_f32 v[32:33], v[32:33], v[120:121]
    v_exp_f32 v145, v145
    v_pk_mul_f32 v[34:35], v[34:35], v[122:123]
    v_exp_f32 v146, v146
    v_pk_mul_f32 v[36:37], v[36:37], v[124:125]
    v_exp_f32 v147, v147
    v_pk_mul_f32 v[38:39], v[38:39], v[126:127]
    v_exp_f32 v148, v148
    v_cvt_pk_bf16_f32 v156, v32, v33
    v_exp_f32 v149, v149
    v_cvt_pk_bf16_f32 v157, v34, v35
    v_exp_f32 v150, v150
    v_cvt_pk_bf16_f32 v158, v36, v37
    v_exp_f32 v151, v151
    v_cvt_pk_bf16_f32 v159, v38, v39
    s_cmp_ge_u32 s44, 2
    s_cselect_b64 vcc, -1, 0
    buffer_store_dwordx4 v[156:159], v242, s[20:23], s3 offen offset:2048 sc1
    v_cndmask_b32 v172, v172, v156, vcc
    v_cndmask_b32 v173, v173, v157, vcc
    v_cndmask_b32 v174, v174, v158, vcc
    v_cndmask_b32 v175, v175, v159, vcc
    v_pk_fma_f32 v[144:145], v[144:145], v[236:237], v[236:237] op_sel:[0,0,0] op_sel_hi:[1,0,0]
    buffer_load_dwordx4 a[152:155], v8, s[20:23], s54 offen offset:2048 sc1
    v_pk_fma_f32 v[146:147], v[146:147], v[236:237], v[236:237] op_sel:[0,0,0] op_sel_hi:[1,0,0]
    v_pk_fma_f32 v[148:149], v[148:149], v[236:237], v[236:237] op_sel:[0,0,0] op_sel_hi:[1,0,0]
    v_pk_fma_f32 v[150:151], v[150:151], v[236:237], v[236:237] op_sel:[0,0,0] op_sel_hi:[1,0,0]
    v_rcp_f32 v144, v144
    v_pk_mul_f32 v[32:33], v[136:137], v[136:137]
    v_rcp_f32 v145, v145
    v_pk_mul_f32 v[34:35], v[138:139], v[138:139]
    v_pk_mul_f32 v[36:37], v[140:141], v[140:141]
    v_rcp_f32 v146, v146
    v_pk_mul_f32 v[38:39], v[142:143], v[142:143]
    v_rcp_f32 v147, v147
    v_pk_fma_f32 v[32:33], v[32:33], v[238:239], v[236:237] op_sel:[0,0,1] op_sel_hi:[1,0,1]
    v_pk_fma_f32 v[34:35], v[34:35], v[238:239], v[236:237] op_sel:[0,0,1] op_sel_hi:[1,0,1]
    v_rcp_f32 v148, v148
    v_pk_fma_f32 v[36:37], v[36:37], v[238:239], v[236:237] op_sel:[0,0,1] op_sel_hi:[1,0,1]
    v_rcp_f32 v149, v149
    v_pk_fma_f32 v[38:39], v[38:39], v[238:239], v[236:237] op_sel:[0,0,1] op_sel_hi:[1,0,1]
    v_pk_mul_f32 v[32:33], v[32:33], v[136:137]
    v_rcp_f32 v150, v150
    v_pk_mul_f32 v[34:35], v[34:35], v[138:139]
    v_rcp_f32 v151, v151
    v_pk_mul_f32 v[36:37], v[36:37], v[140:141]
    v_pk_mul_f32 v[38:39], v[38:39], v[142:143]
    v_exp_f32 v32, v32
    v_pk_mul_f32 v[144:145], v[144:145], v[128:129]
    v_exp_f32 v33, v33
    v_pk_mul_f32 v[146:147], v[146:147], v[130:131]
    v_exp_f32 v34, v34
    v_pk_mul_f32 v[148:149], v[148:149], v[132:133]
    v_exp_f32 v35, v35
    v_pk_mul_f32 v[150:151], v[150:151], v[134:135]
    v_exp_f32 v36, v36
    v_cvt_pk_bf16_f32 v152, v144, v145
    v_exp_f32 v37, v37
    v_cvt_pk_bf16_f32 v153, v146, v147
    v_exp_f32 v38, v38
    v_cvt_pk_bf16_f32 v154, v148, v149
    v_exp_f32 v39, v39
    v_cvt_pk_bf16_f32 v155, v150, v151
    s_cmp_ge_u32 s44, 2
    s_cselect_b64 vcc, -1, 0
    buffer_store_dwordx4 v[152:155], v243, s[20:23], s3 offen offset:0 sc1
    v_cndmask_b32 v168, v168, v152, vcc
    v_cndmask_b32 v169, v169, v153, vcc
    v_cndmask_b32 v170, v170, v154, vcc
    v_cndmask_b32 v171, v171, v155, vcc
    v_pk_fma_f32 v[32:33], v[32:33], v[236:237], v[236:237] op_sel:[0,0,0] op_sel_hi:[1,0,0]
    buffer_load_dwordx4 a[156:159], v9, s[20:23], s54 offen offset:2048 sc1
    v_pk_fma_f32 v[34:35], v[34:35], v[236:237], v[236:237] op_sel:[0,0,0] op_sel_hi:[1,0,0]
    v_pk_fma_f32 v[36:37], v[36:37], v[236:237], v[236:237] op_sel:[0,0,0] op_sel_hi:[1,0,0]
    v_pk_fma_f32 v[38:39], v[38:39], v[236:237], v[236:237] op_sel:[0,0,0] op_sel_hi:[1,0,0]
    v_rcp_f32 v32, v32
    v_rcp_f32 v33, v33
    v_rcp_f32 v34, v34
    v_rcp_f32 v35, v35
    v_rcp_f32 v36, v36
    v_rcp_f32 v37, v37
    v_rcp_f32 v38, v38
    v_rcp_f32 v39, v39
    v_pk_mul_f32 v[32:33], v[32:33], v[136:137]
    v_pk_mul_f32 v[34:35], v[34:35], v[138:139]
    v_pk_mul_f32 v[36:37], v[36:37], v[140:141]
    v_pk_mul_f32 v[38:39], v[38:39], v[142:143]
    v_cvt_pk_bf16_f32 v156, v32, v33
    v_cvt_pk_bf16_f32 v157, v34, v35
    v_cvt_pk_bf16_f32 v158, v36, v37
    v_cvt_pk_bf16_f32 v159, v38, v39
    s_cmp_ge_u32 s44, 2
    s_cselect_b64 vcc, -1, 0
    buffer_store_dwordx4 v[156:159], v243, s[20:23], s3 offen offset:2048 sc1
    v_cndmask_b32 v176, v176, v156, vcc
    v_cndmask_b32 v177, v177, v157, vcc
    v_cndmask_b32 v178, v178, v158, vcc
    v_cndmask_b32 v179, v179, v159, vcc
    v_lshl_add_u32 v18, v1, 4, s78
    ds_read_b64_tr_b16 v[36:37], v6 offset:0
    ds_read_b64_tr_b16 v[38:39], v6 offset:1024
    ds_read_b64_tr_b16 v[40:41], v7 offset:0
    ds_read_b64_tr_b16 v[42:43], v7 offset:1024
    ds_read_b64_tr_b16 v[44:45], v6 offset:2048
    ds_read_b64_tr_b16 v[46:47], v6 offset:3072
    ds_read_b64_tr_b16 v[48:49], v7 offset:2048
    ds_read_b64_tr_b16 v[50:51], v7 offset:3072
    s_waitcnt lgkmcnt(6)
    v_mfma_f32_32x32x16_bf16 v[20:35], v[36:39], v[160:163], 0
    ds_read_b64_tr_b16 v[52:53], v6 offset:4096
    v_accvgpr_read_b32 v68, a240
    v_accvgpr_read_b32 v69, a241
    v_accvgpr_read_b32 v70, a242
    v_accvgpr_read_b32 v71, a243
    v_accvgpr_read_b32 v72, a244
    s_waitcnt lgkmcnt(5)
    v_mfma_f32_32x32x16_bf16 v[112:127], v[40:43], v[160:163], 0
    ds_read_b64_tr_b16 v[54:55], v6 offset:5120
    ds_write_b128 v18, a[0:3] offset:0
    buffer_load_dwordx4 a[160:163], v8, s[20:23], s55 offen offset:0 sc1
    v_accvgpr_read_b32 v73, a245
    v_accvgpr_read_b32 v74, a246
    v_mfma_f32_32x32x16_bf16 v[128:143], v[36:39], v[180:183], 0
    ds_read_b64_tr_b16 v[56:57], v7 offset:4096
    v_accvgpr_read_b32 v75, a247
    v_accvgpr_read_b32 v76, a248
    v_accvgpr_read_b32 v77, a249
    v_accvgpr_read_b32 v78, a250
    v_accvgpr_read_b32 v79, a251
    v_mfma_f32_32x32x16_bf16 v[144:159], v[40:43], v[180:183], 0
    ds_read_b64_tr_b16 v[58:59], v7 offset:5120
    ds_write_b128 v18, a[4:7] offset:1024
    buffer_load_dwordx4 a[164:167], v9, s[20:23], s55 offen offset:0 sc1
    v_accvgpr_read_b32 v80, a252
    v_accvgpr_read_b32 v81, a253
    s_waitcnt lgkmcnt(8)
    v_mfma_f32_32x32x16_bf16 v[20:35], v[44:47], v[184:187], v[20:35]
    ds_read_b64_tr_b16 v[60:61], v6 offset:6144
    v_accvgpr_read_b32 v82, a254
    v_accvgpr_read_b32 v83, a255
    s_waitcnt lgkmcnt(7)
    v_mfma_f32_32x32x16_bf16 v[112:127], v[48:51], v[184:187], v[112:127]
    ds_read_b64_tr_b16 v[62:63], v6 offset:7168
    buffer_load_dwordx4 a[168:171], v8, s[20:23], s55 offen offset:2048 sc1
    v_mfma_f32_32x32x16_bf16 v[128:143], v[44:47], v[196:199], v[128:143]
    ds_read_b64_tr_b16 v[64:65], v7 offset:6144
    ds_write_b128 v18, a[8:11] offset:2048
    v_mfma_f32_32x32x16_bf16 v[144:159], v[48:51], v[196:199], v[144:159]
    ds_read_b64_tr_b16 v[66:67], v7 offset:7168
    buffer_load_dwordx4 a[172:175], v9, s[20:23], s55 offen offset:2048 sc1
    s_waitcnt lgkmcnt(9)
    v_mfma_f32_32x32x16_bf16 v[20:35], v[52:55], v[164:167], v[20:35]
    ds_read_b64_tr_b16 v[36:37], v6 offset:8192
    s_waitcnt lgkmcnt(7)
    v_mfma_f32_32x32x16_bf16 v[112:127], v[56:59], v[164:167], v[112:127]
    ds_read_b64_tr_b16 v[38:39], v6 offset:9216
    ds_write_b128 v18, a[12:15] offset:3072
    buffer_load_dwordx4 a[176:179], v8, s[20:23], s56 offen offset:0 sc1
    v_mfma_f32_32x32x16_bf16 v[128:143], v[52:55], v[168:171], v[128:143]
    ds_read_b64_tr_b16 v[40:41], v7 offset:8192
    v_mfma_f32_32x32x16_bf16 v[144:159], v[56:59], v[168:171], v[144:159]
    ds_read_b64_tr_b16 v[42:43], v7 offset:9216
    buffer_load_dwordx4 a[180:183], v9, s[20:23], s56 offen offset:0 sc1
    s_waitcnt lgkmcnt(8)
    v_mfma_f32_32x32x16_bf16 v[20:35], v[60:63], v[172:175], v[20:35]
    ds_read_b64_tr_b16 v[44:45], v6 offset:10240
    ds_write_b128 v18, a[16:19] offset:4096
    s_waitcnt lgkmcnt(7)
    v_mfma_f32_32x32x16_bf16 v[112:127], v[64:67], v[172:175], v[112:127]
    ds_read_b64_tr_b16 v[46:47], v6 offset:11264
    buffer_load_dwordx4 a[184:187], v8, s[20:23], s56 offen offset:2048 sc1
    v_mfma_f32_32x32x16_bf16 v[128:143], v[60:63], v[176:179], v[128:143]
    ds_read_b64_tr_b16 v[48:49], v7 offset:10240
    v_mfma_f32_32x32x16_bf16 v[144:159], v[64:67], v[176:179], v[144:159]
    ds_read_b64_tr_b16 v[50:51], v7 offset:11264
    ds_write_b128 v18, a[20:23] offset:5120
    buffer_load_dwordx4 a[188:191], v9, s[20:23], s56 offen offset:2048 sc1
    s_waitcnt vmcnt(15) lgkmcnt(9)
    v_mfma_f32_32x32x16_bf16 v[20:35], v[36:39], a[144:147], v[20:35]
    ds_read_b64_tr_b16 v[52:53], v6 offset:12288
    v_lshlrev_b32 v84, 16, v68
    v_and_b32 v85, 0xffff0000, v68
    v_lshlrev_b32 v19, 16, v76
    v_add_f32 v84, v84, v19
    v_and_b32 v19, 0xffff0000, v76
    s_waitcnt lgkmcnt(7)
    v_mfma_f32_32x32x16_bf16 v[112:127], v[40:43], a[144:147], v[112:127]
    ds_read_b64_tr_b16 v[54:55], v6 offset:13312
    ds_write_b128 v18, a[24:27] offset:6144
    buffer_load_dwordx4 a[192:195], v8, s[20:23], s57 offen offset:0 sc1
    v_add_f32 v85, v85, v19
    v_lshlrev_b32 v86, 16, v69
    s_waitcnt vmcnt(14)
    v_mfma_f32_32x32x16_bf16 v[128:143], v[36:39], a[148:151], v[128:143]
    ds_read_b64_tr_b16 v[56:57], v7 offset:12288
    v_and_b32 v87, 0xffff0000, v69
    v_lshlrev_b32 v19, 16, v77
    v_add_f32 v86, v86, v19
    v_and_b32 v19, 0xffff0000, v77
    v_add_f32 v87, v87, v19
    v_mfma_f32_32x32x16_bf16 v[144:159], v[40:43], a[148:151], v[144:159]
    ds_read_b64_tr_b16 v[58:59], v7 offset:13312
    buffer_load_dwordx4 a[196:199], v9, s[20:23], s57 offen offset:0 sc1
    v_lshlrev_b32 v88, 16, v70
    v_and_b32 v89, 0xffff0000, v70
    v_lshlrev_b32 v19, 16, v78
    s_waitcnt vmcnt(13) lgkmcnt(8)
    v_mfma_f32_32x32x16_bf16 v[20:35], v[44:47], a[152:155], v[20:35]
    s_waitcnt vmcnt(10)
    ds_read_b64_tr_b16 v[60:61], v6 offset:14336
    ds_write_b128 v18, a[28:31] offset:7168
    buffer_store_dword v13, v0, s[20:23], 0 offen offset:28
    v_add_f32 v88, v88, v19
    v_and_b32 v19, 0xffff0000, v78
    s_waitcnt lgkmcnt(8)
    v_mfma_f32_32x32x16_bf16 v[112:127], v[48:51], a[152:155], v[112:127]
    ds_read_b64_tr_b16 v[62:63], v6 offset:15360
    buffer_load_dwordx4 a[200:203], v8, s[20:23], s57 offen offset:2048 sc1
    v_add_f32 v89, v89, v19
    v_lshlrev_b32 v90, 16, v71
    v_and_b32 v91, 0xffff0000, v71
    v_mfma_f32_32x32x16_bf16 v[128:143], v[44:47], a[156:159], v[128:143]
    ds_read_b64_tr_b16 v[64:65], v7 offset:14336
    v_lshlrev_b32 v19, 16, v79
    v_add_f32 v90, v90, v19
    v_and_b32 v19, 0xffff0000, v79
    v_add_f32 v91, v91, v19
    v_lshlrev_b32 v92, 16, v72
    v_mfma_f32_32x32x16_bf16 v[144:159], v[48:51], a[156:159], v[144:159]
    ds_read_b64_tr_b16 v[66:67], v7 offset:15360
    ds_write_b128 v18, a[32:35] offset:8192
    buffer_load_dwordx4 a[204:207], v9, s[20:23], s57 offen offset:2048 sc1
    v_and_b32 v93, 0xffff0000, v72
    v_lshlrev_b32 v19, 16, v80
    s_waitcnt vmcnt(12) lgkmcnt(9)
    v_mfma_f32_32x32x16_bf16 v[20:35], v[52:55], a[160:163], v[20:35]
    ds_read_b64_tr_b16 v[36:37], v6 offset:16384
    v_add_f32 v92, v92, v19
    v_and_b32 v19, 0xffff0000, v80
    v_add_f32 v93, v93, v19
    v_lshlrev_b32 v94, 16, v73
    v_and_b32 v95, 0xffff0000, v73
    s_waitcnt lgkmcnt(7)
    v_mfma_f32_32x32x16_bf16 v[112:127], v[56:59], a[160:163], v[112:127]
    ds_read_b64_tr_b16 v[38:39], v6 offset:17408
    buffer_load_dword v12, v10, s[20:23], 0 offen sc1
    v_lshlrev_b32 v19, 16, v81
    v_add_f32 v94, v94, v19
    v_and_b32 v19, 0xffff0000, v81
    s_waitcnt vmcnt(12)
    v_mfma_f32_32x32x16_bf16 v[128:143], v[52:55], a[164:167], v[128:143]
    ds_read_b64_tr_b16 v[40:41], v7 offset:16384
    ds_write_b128 v18, a[36:39] offset:9216
    buffer_load_dwordx4 a[208:211], v8, s[20:23], s58 offen offset:0 sc1
    v_add_f32 v95, v95, v19
    v_lshlrev_b32 v96, 16, v74
    v_mfma_f32_32x32x16_bf16 v[144:159], v[56:59], a[164:167], v[144:159]
    ds_read_b64_tr_b16 v[42:43], v7 offset:17408
    v_and_b32 v97, 0xffff0000, v74
    v_lshlrev_b32 v19, 16, v82
    v_add_f32 v96, v96, v19
    v_and_b32 v19, 0xffff0000, v82
    v_add_f32 v97, v97, v19
    s_waitcnt vmcnt(12) lgkmcnt(8)
    v_mfma_f32_32x32x16_bf16 v[20:35], v[60:63], a[168:171], v[20:35]
    ds_read_b64_tr_b16 v[44:45], v6 offset:18432
    buffer_load_dwordx4 a[212:215], v9, s[20:23], s58 offen offset:0 sc1
    v_lshlrev_b32 v98, 16, v75
    v_and_b32 v99, 0xffff0000, v75
    v_lshlrev_b32 v19, 16, v83
    s_waitcnt lgkmcnt(7)
    v_mfma_f32_32x32x16_bf16 v[112:127], v[64:67], a[168:171], v[112:127]
    ds_read_b64_tr_b16 v[46:47], v6 offset:19456
    ds_write_b128 v18, a[40:43] offset:10240
    v_add_f32 v98, v98, v19
    v_and_b32 v19, 0xffff0000, v83
    v_add_f32 v99, v99, v19
    s_lshl_b32 s51, s47, 6
    s_waitcnt vmcnt(12)
    v_mfma_f32_32x32x16_bf16 v[128:143], v[60:63], a[172:175], v[128:143]
    s_and_b32 s52, s44, 1
    ds_read_b64_tr_b16 v[48:49], v7 offset:18432
    buffer_load_dwordx4 a[216:219], v8, s[20:23], s58 offen offset:2048 sc1
    s_add_u32 s51, s51, s52
    s_mul_i32 s51, s51, 896
    v_and_b32 v14, 31, v1
    v_mfma_f32_32x32x16_bf16 v[144:159], v[64:67], a[172:175], v[144:159]
    ds_read_b64_tr_b16 v[50:51], v7 offset:19456
    ds_write_b128 v18, a[44:47] offset:11264
    v_mul_u32_u24 v14, 1792, v14
    v_add_u32 v14, s51, v14
    s_lshr_b32 s51, s44, 1
    s_lshl_b32 s51, s51, 6
    s_waitcnt vmcnt(12) lgkmcnt(9)
    v_mfma_f32_32x32x16_bf16 v[20:35], v[36:39], a[176:179], v[20:35]
    ds_read_b64_tr_b16 v[52:53], v6 offset:20480
    buffer_load_dwordx4 a[220:223], v9, s[20:23], s58 offen offset:2048 sc1
    s_lshl_b32 s52, s48, 7
    s_add_u32 s51, s51, s52
    v_lshrrev_b32 v19, 5, v1
    s_waitcnt lgkmcnt(7)
    v_mfma_f32_32x32x16_bf16 v[112:127], v[40:43], a[176:179], v[112:127]
    ds_read_b64_tr_b16 v[54:55], v6 offset:21504
    v_lshl_add_u32 v19, v19, 4, s51
    v_add_u32 v14, v14, v19
    s_xor_b32 s51, s44, 2
    s_mul_i32 s51, s51, 40960
    s_add_u32 s51, s51, 0
    s_waitcnt vmcnt(12)
    v_mfma_f32_32x32x16_bf16 v[128:143], v[36:39], a[180:183], v[128:143]
    ds_read_b64_tr_b16 v[56:57], v7 offset:20480
    ds_write_b128 v18, a[48:51] offset:12288
    buffer_load_dwordx4 a[224:227], v8, s[20:23], s59 offen offset:0 sc1
    v_lshl_add_u32 v15, v1, 4, s51
    s_xor_b32 s51, s44, 1
    v_mfma_f32_32x32x16_bf16 v[144:159], v[40:43], a[180:183], v[144:159]
    s_mul_i32 s51, s51, 40960
    ds_read_b64_tr_b16 v[58:59], v7 offset:21504
    s_add_u32 s51, s51, 4096
    v_lshl_add_u32 v16, v1, 4, s51
    s_xor_b32 s51, s44, 3
    s_mul_i32 s51, s51, 40960
    s_add_u32 s51, s51, 8192
    s_waitcnt vmcnt(12) lgkmcnt(9)
    v_mfma_f32_32x32x16_bf16 v[20:35], v[44:47], a[184:187], v[20:35]
    ds_read_b64_tr_b16 v[60:61], v6 offset:22528
    buffer_load_dwordx4 a[228:231], v9, s[20:23], s59 offen offset:0 sc1
    v_lshl_add_u32 v17, v1, 4, s51
    s_waitcnt lgkmcnt(7)
    v_mfma_f32_32x32x16_bf16 v[112:127], v[48:51], a[184:187], v[112:127]
    ds_read_b64_tr_b16 v[62:63], v6 offset:23552
    ds_write_b128 v18, a[52:55] offset:13312
    s_waitcnt vmcnt(12)
    v_mfma_f32_32x32x16_bf16 v[128:143], v[44:47], a[188:191], v[128:143]
    ds_read_b64_tr_b16 v[64:65], v7 offset:22528
    buffer_load_dwordx4 a[232:235], v8, s[20:23], s59 offen offset:2048 sc1
    v_mfma_f32_32x32x16_bf16 v[144:159], v[48:51], a[188:191], v[144:159]
    ds_read_b64_tr_b16 v[66:67], v7 offset:23552
    s_waitcnt vmcnt(12) lgkmcnt(8)
    v_mfma_f32_32x32x16_bf16 v[20:35], v[52:55], a[192:195], v[20:35]
    ds_read_b64_tr_b16 v[36:37], v6 offset:24576
    ds_write_b128 v18, a[56:59] offset:14336
    buffer_load_dwordx4 a[236:239], v9, s[20:23], s59 offen offset:2048 sc1
    s_waitcnt lgkmcnt(7)
    v_mfma_f32_32x32x16_bf16 v[112:127], v[56:59], a[192:195], v[112:127]
    ds_read_b64_tr_b16 v[38:39], v6 offset:25600
    s_waitcnt vmcnt(8)
    v_cmp_eq_u32 vcc, s76, v12
    s_nop 0
    s_and_b32 s79, vcc_lo, 4177920
    s_cmp_eq_u32 s79, 4177920
    s_cbranch_scc0 Lco_m_p
Lco_m_k:
    v_mfma_f32_32x32x16_bf16 v[128:143], v[52:55], a[196:199], v[128:143]
    ds_read_b64_tr_b16 v[40:41], v7 offset:24576
    s_lshl_b32 s50, s62, 12
    s_add_u32 s50, s50, s60
    v_mfma_f32_32x32x16_bf16 v[144:159], v[56:59], a[196:199], v[144:159]
    ds_read_b64_tr_b16 v[42:43], v7 offset:25600
    ds_write_b128 v18, a[60:63] offset:15360
    buffer_load_dwordx4 v[160:163], v8, s[20:23], s50 offen offset:0 sc1
    s_waitcnt lgkmcnt(9)
    v_mfma_f32_32x32x16_bf16 v[20:35], v[60:63], a[200:203], v[20:35]
    ds_read_b64_tr_b16 v[44:45], v6 offset:26624
    s_waitcnt lgkmcnt(7)
    v_mfma_f32_32x32x16_bf16 v[112:127], v[64:67], a[200:203], v[112:127]
    ds_read_b64_tr_b16 v[46:47], v6 offset:27648
    ds_write_b128 v18, a[64:67] offset:16384
    buffer_load_dwordx4 v[164:167], v9, s[20:23], s50 offen offset:0 sc1
    v_mfma_f32_32x32x16_bf16 v[128:143], v[60:63], a[204:207], v[128:143]
    ds_read_b64_tr_b16 v[48:49], v7 offset:26624
    v_mfma_f32_32x32x16_bf16 v[144:159], v[64:67], a[204:207], v[144:159]
    ds_read_b64_tr_b16 v[50:51], v7 offset:27648
    buffer_load_dwordx4 v[168:171], v8, s[20:23], s50 offen offset:2048 sc1
    s_waitcnt vmcnt(10) lgkmcnt(8)
    v_mfma_f32_32x32x16_bf16 v[20:35], v[36:39], a[208:211], v[20:35]
    ds_read_b64_tr_b16 v[52:53], v6 offset:28672
    ds_write_b128 v18, a[68:71] offset:17408
    s_waitcnt lgkmcnt(8)
    v_mfma_f32_32x32x16_bf16 v[112:127], v[40:43], a[208:211], v[112:127]
    ds_read_b64_tr_b16 v[54:55], v6 offset:29696
    buffer_load_dwordx4 v[172:175], v9, s[20:23], s50 offen offset:2048 sc1
    s_waitcnt vmcnt(10)
    v_mfma_f32_32x32x16_bf16 v[128:143], v[36:39], a[212:215], v[128:143]
    ds_read_b64_tr_b16 v[56:57], v7 offset:28672
    s_lshl_b32 s50, s63, 12
    s_add_u32 s50, s50, s60
    v_mfma_f32_32x32x16_bf16 v[144:159], v[40:43], a[212:215], v[144:159]
    ds_read_b64_tr_b16 v[58:59], v7 offset:29696
    ds_write_b128 v18, a[72:75] offset:18432
    buffer_load_dwordx4 v[176:179], v8, s[20:23], s50 offen offset:0 sc1
    s_waitcnt vmcnt(10) lgkmcnt(9)
    v_mfma_f32_32x32x16_bf16 v[20:35], v[44:47], a[216:219], v[20:35]
    ds_read_b64_tr_b16 v[60:61], v6 offset:30720
    s_waitcnt lgkmcnt(7)
    v_mfma_f32_32x32x16_bf16 v[112:127], v[48:51], a[216:219], v[112:127]
    ds_read_b64_tr_b16 v[62:63], v6 offset:31744
    buffer_load_dwordx4 v[180:183], v9, s[20:23], s50 offen offset:0 sc1
    s_waitcnt vmcnt(10)
    v_mfma_f32_32x32x16_bf16 v[128:143], v[44:47], a[220:223], v[128:143]
    ds_read_b64_tr_b16 v[64:65], v7 offset:30720
    ds_write_b128 v18, a[76:79] offset:19456
    v_mfma_f32_32x32x16_bf16 v[144:159], v[48:51], a[220:223], v[144:159]
    ds_read_b64_tr_b16 v[66:67], v7 offset:31744
    buffer_load_dwordx4 v[184:187], v8, s[20:23], s50 offen offset:2048 sc1
    s_waitcnt vmcnt(10) lgkmcnt(8)
    v_mfma_f32_32x32x16_bf16 v[20:35], v[52:55], a[224:227], v[20:35]
    ds_read_b64_tr_b16 v[36:37], v6 offset:32768
    s_waitcnt lgkmcnt(7)
    v_mfma_f32_32x32x16_bf16 v[112:127], v[56:59], a[224:227], v[112:127]
    ds_read_b64_tr_b16 v[38:39], v6 offset:33792
    ds_write_b128 v18, a[80:83] offset:20480
    buffer_load_dwordx4 v[188:191], v9, s[20:23], s50 offen offset:2048 sc1
    s_waitcnt vmcnt(10)
    v_mfma_f32_32x32x16_bf16 v[128:143], v[52:55], a[228:231], v[128:143]
    ds_read_b64_tr_b16 v[40:41], v7 offset:32768
    v_mfma_f32_32x32x16_bf16 v[144:159], v[56:59], a[228:231], v[144:159]
    ds_read_b64_tr_b16 v[42:43], v7 offset:33792
    ds_write_b128 v18, a[84:87] offset:21504
    buffer_load_dword v12, v10, s[20:23], 0 offen sc1
    s_lshl_b32 s50, s64, 12
    s_add_u32 s50, s50, s60
    s_waitcnt vmcnt(10) lgkmcnt(9)
    v_mfma_f32_32x32x16_bf16 v[20:35], v[60:63], a[232:235], v[20:35]
    ds_read_b64_tr_b16 v[44:45], v6 offset:34816
    buffer_load_dwordx4 v[192:195], v8, s[20:23], s50 offen offset:0 sc1
    s_waitcnt lgkmcnt(7)
    v_mfma_f32_32x32x16_bf16 v[112:127], v[64:67], a[232:235], v[112:127]
    ds_read_b64_tr_b16 v[46:47], v6 offset:35840
    s_waitcnt vmcnt(10)
    v_mfma_f32_32x32x16_bf16 v[128:143], v[60:63], a[236:239], v[128:143]
    ds_read_b64_tr_b16 v[48:49], v7 offset:34816
    ds_write_b128 v18, a[88:91] offset:22528
    buffer_load_dwordx4 v[196:199], v9, s[20:23], s50 offen offset:0 sc1
    v_mfma_f32_32x32x16_bf16 v[144:159], v[64:67], a[236:239], v[144:159]
    ds_read_b64_tr_b16 v[50:51], v7 offset:35840
    s_waitcnt vmcnt(10) lgkmcnt(9)
    v_mfma_f32_32x32x16_bf16 v[20:35], v[36:39], v[160:163], v[20:35]
    ds_read_b64_tr_b16 v[52:53], v6 offset:0
    buffer_load_dwordx4 v[200:203], v8, s[20:23], s50 offen offset:2048 sc1
    s_waitcnt lgkmcnt(7)
    v_mfma_f32_32x32x16_bf16 v[112:127], v[40:43], v[160:163], v[112:127]
    ds_read_b64_tr_b16 v[54:55], v6 offset:1024
    ds_write_b128 v18, a[92:95] offset:23552
    s_waitcnt vmcnt(10)
    v_mfma_f32_32x32x16_bf16 v[128:143], v[36:39], v[164:167], v[128:143]
    ds_read_b64_tr_b16 v[56:57], v7 offset:0
    buffer_load_dwordx4 v[204:207], v9, s[20:23], s50 offen offset:2048 sc1
    v_mfma_f32_32x32x16_bf16 v[144:159], v[40:43], v[164:167], v[144:159]
    ds_read_b64_tr_b16 v[58:59], v7 offset:1024
    s_lshl_b32 s50, s65, 12
    s_add_u32 s50, s50, s60
    s_waitcnt vmcnt(10) lgkmcnt(8)
    v_mfma_f32_32x32x16_bf16 v[20:35], v[44:47], v[168:171], v[20:35]
    ds_read_b64_tr_b16 v[60:61], v6 offset:2048
    ds_write_b128 v18, a[96:99] offset:24576
    buffer_load_dwordx4 v[208:211], v8, s[20:23], s50 offen offset:0 sc1
    s_waitcnt lgkmcnt(7)
    v_mfma_f32_32x32x16_bf16 v[112:127], v[48:51], v[168:171], v[112:127]
    ds_read_b64_tr_b16 v[62:63], v6 offset:3072
    s_waitcnt vmcnt(10)
    v_mfma_f32_32x32x16_bf16 v[128:143], v[44:47], v[172:175], v[128:143]
    ds_read_b64_tr_b16 v[64:65], v7 offset:2048
    buffer_load_dwordx4 v[212:215], v9, s[20:23], s50 offen offset:0 sc1
    v_mfma_f32_32x32x16_bf16 v[144:159], v[48:51], v[172:175], v[144:159]
    ds_read_b64_tr_b16 v[66:67], v7 offset:3072
    ds_write_b128 v18, a[100:103] offset:25600
    s_waitcnt vmcnt(10) lgkmcnt(9)
    v_mfma_f32_32x32x16_bf16 v[20:35], v[52:55], v[176:179], v[20:35]
    ds_read_b64_tr_b16 v[36:37], v6 offset:4096
    buffer_load_dwordx4 v[216:219], v8, s[20:23], s50 offen offset:2048 sc1
    s_waitcnt lgkmcnt(7)
    v_mfma_f32_32x32x16_bf16 v[112:127], v[56:59], v[176:179], v[112:127]
    ds_read_b64_tr_b16 v[38:39], v6 offset:5120
    ds_write_b128 v18, a[104:107] offset:26624
    s_waitcnt vmcnt(10)
    v_mfma_f32_32x32x16_bf16 v[128:143], v[52:55], v[180:183], v[128:143]
    ds_read_b64_tr_b16 v[40:41], v7 offset:4096
    buffer_load_dwordx4 v[220:223], v9, s[20:23], s50 offen offset:2048 sc1
    v_mfma_f32_32x32x16_bf16 v[144:159], v[56:59], v[180:183], v[144:159]
    ds_read_b64_tr_b16 v[42:43], v7 offset:5120
    s_waitcnt vmcnt(8)
    v_cmp_eq_u32 vcc, s76, v12
    s_nop 0
    s_and_b32 s79, vcc_lo, 16256
    s_cmp_eq_u32 s79, 16256
    s_cbranch_scc0 Lch1_m_p
Lch1_m_k:
    s_waitcnt lgkmcnt(8)
    v_mfma_f32_32x32x16_bf16 v[20:35], v[60:63], v[184:187], v[20:35]
    ds_read_b64_tr_b16 v[44:45], v6 offset:6144
    ds_write_b128 v18, a[108:111] offset:27648
    s_add_u32 s50, s54, 16384
    s_waitcnt lgkmcnt(8)
    v_mfma_f32_32x32x16_bf16 v[112:127], v[64:67], v[184:187], v[112:127]
    ds_read_b64_tr_b16 v[46:47], v6 offset:7168
    buffer_load_dwordx4 a[144:147], v8, s[20:23], s50 offen offset:0 sc1
    v_mfma_f32_32x32x16_bf16 v[128:143], v[60:63], v[188:191], v[128:143]
    ds_read_b64_tr_b16 v[48:49], v7 offset:6144
    buffer_load_dwordx4 a[148:151], v9, s[20:23], s50 offen offset:0 sc1
    v_mfma_f32_32x32x16_bf16 v[144:159], v[64:67], v[188:191], v[144:159]
    ds_read_b64_tr_b16 v[50:51], v7 offset:7168
    ds_write_b128 v18, a[112:115] offset:28672
    s_waitcnt vmcnt(9) lgkmcnt(9)
    v_mfma_f32_32x32x16_bf16 v[20:35], v[36:39], v[192:195], v[20:35]
    ds_read_b64_tr_b16 v[160:161], v6 offset:22528
    ds_read_b64_tr_b16 v[52:53], v6 offset:8192
    buffer_load_dwordx4 a[152:155], v8, s[20:23], s50 offen offset:2048 sc1
    s_waitcnt lgkmcnt(8)
    v_mfma_f32_32x32x16_bf16 v[112:127], v[40:43], v[192:195], v[112:127]
    ds_read_b64_tr_b16 v[162:163], v6 offset:23552
    ds_read_b64_tr_b16 v[54:55], v6 offset:9216
    buffer_load_dwordx4 a[156:159], v9, s[20:23], s50 offen offset:2048 sc1
    s_waitcnt vmcnt(10)
    v_mfma_f32_32x32x16_bf16 v[128:143], v[36:39], v[196:199], v[128:143]
    ds_read_b64_tr_b16 v[164:165], v7 offset:22528
    ds_read_b64_tr_b16 v[56:57], v7 offset:8192
    ds_write_b128 v18, a[116:119] offset:29696
    s_add_u32 s50, s55, 16384
    v_mfma_f32_32x32x16_bf16 v[144:159], v[40:43], v[196:199], v[144:159]
    ds_read_b64_tr_b16 v[166:167], v7 offset:23552
    ds_read_b64_tr_b16 v[58:59], v7 offset:9216
    buffer_load_dwordx4 a[160:163], v8, s[20:23], s50 offen offset:0 sc1
    s_waitcnt vmcnt(10) lgkmcnt(12)
    v_mfma_f32_32x32x16_bf16 v[20:35], v[44:47], v[200:203], v[20:35]
    ds_read_b64_tr_b16 v[168:169], v6 offset:24576
    ds_read_b64_tr_b16 v[60:61], v6 offset:10240
    buffer_load_dwordx4 a[164:167], v9, s[20:23], s50 offen offset:0 sc1
    s_waitcnt lgkmcnt(12)
    v_mfma_f32_32x32x16_bf16 v[112:127], v[48:51], v[200:203], v[112:127]
    ds_read_b64_tr_b16 v[170:171], v6 offset:25600
    ds_read_b64_tr_b16 v[62:63], v6 offset:11264
    ds_write_b128 v18, a[120:123] offset:30720
    s_waitcnt vmcnt(10)
    v_mfma_f32_32x32x16_bf16 v[128:143], v[44:47], v[204:207], v[128:143]
    ds_read_b64_tr_b16 v[172:173], v7 offset:24576
    ds_read_b64_tr_b16 v[64:65], v7 offset:10240
    buffer_load_dwordx4 a[168:171], v8, s[20:23], s50 offen offset:2048 sc1
    v_mfma_f32_32x32x16_bf16 v[144:159], v[48:51], v[204:207], v[144:159]
    ds_read_b64_tr_b16 v[174:175], v7 offset:25600
    ds_read_b64_tr_b16 v[66:67], v7 offset:11264
    ds_write_b128 v18, a[124:127] offset:31744
    buffer_load_dwordx4 a[172:175], v9, s[20:23], s50 offen offset:2048 sc1
    s_waitcnt vmcnt(11) lgkmcnt(15)
    v_mfma_f32_32x32x16_bf16 v[20:35], v[52:55], v[208:211], v[20:35]
    ds_read_b64_tr_b16 v[176:177], v6 offset:26624
    ds_read_b64_tr_b16 v[36:37], v6 offset:12288
    s_add_u32 s50, s56, 16384
    s_waitcnt lgkmcnt(12)
    v_mfma_f32_32x32x16_bf16 v[112:127], v[56:59], v[208:211], v[112:127]
    ds_read_b64_tr_b16 v[178:179], v6 offset:27648
    ds_read_b64_tr_b16 v[38:39], v6 offset:13312
    buffer_load_dwordx4 a[176:179], v8, s[20:23], s50 offen offset:0 sc1
    s_waitcnt vmcnt(11)
    v_mfma_f32_32x32x16_bf16 v[128:143], v[52:55], v[212:215], v[128:143]
    ds_read_b64_tr_b16 v[180:181], v7 offset:26624
    ds_read_b64_tr_b16 v[40:41], v7 offset:12288
    ds_write_b128 v18, a[128:131] offset:32768
    buffer_load_dwordx4 a[184:187], v8, s[20:23], s50 offen offset:2048 sc1
    v_mfma_f32_32x32x16_bf16 v[144:159], v[56:59], v[212:215], v[144:159]
    ds_read_b64_tr_b16 v[182:183], v7 offset:27648
    ds_read_b64_tr_b16 v[42:43], v7 offset:13312
    s_add_u32 s50, s57, 16384
    s_waitcnt vmcnt(11) lgkmcnt(15)
    v_mfma_f32_32x32x16_bf16 v[20:35], v[60:63], v[216:219], v[20:35]
    ds_read_b64_tr_b16 v[184:185], v6 offset:28672
    ds_read_b64_tr_b16 v[44:45], v6 offset:14336
    buffer_load_dwordx4 a[192:195], v8, s[20:23], s50 offen offset:0 sc1
    s_waitcnt lgkmcnt(12)
    v_mfma_f32_32x32x16_bf16 v[112:127], v[64:67], v[216:219], v[112:127]
    ds_read_b64_tr_b16 v[186:187], v6 offset:29696
    ds_read_b64_tr_b16 v[46:47], v6 offset:15360
    ds_write_b128 v18, a[132:135] offset:33792
    buffer_load_dwordx4 a[200:203], v8, s[20:23], s50 offen offset:2048 sc1
    s_waitcnt vmcnt(12)
    v_mfma_f32_32x32x16_bf16 v[128:143], v[60:63], v[220:223], v[128:143]
    ds_read_b64_tr_b16 v[188:189], v7 offset:28672
    ds_read_b64_tr_b16 v[48:49], v7 offset:14336
    s_add_u32 s50, s58, 16384
    v_mfma_f32_32x32x16_bf16 v[144:159], v[64:67], v[220:223], v[144:159]
    ds_read_b64_tr_b16 v[190:191], v7 offset:29696
    ds_read_b64_tr_b16 v[50:51], v7 offset:15360
    buffer_load_dwordx4 a[208:211], v8, s[20:23], s50 offen offset:0 sc1
    s_waitcnt vmcnt(12) lgkmcnt(14)
    v_mfma_f32_32x32x16_bf16 v[20:35], v[36:39], a[144:147], v[20:35]
    ds_read_b64_tr_b16 v[192:193], v6 offset:30720
    ds_read_b64_tr_b16 v[52:53], v6 offset:16384
    ds_write_b128 v18, a[136:139] offset:34816
    buffer_load_dwordx4 a[216:219], v8, s[20:23], s50 offen offset:2048 sc1
    s_waitcnt lgkmcnt(12)
    v_mfma_f32_32x32x16_bf16 v[112:127], v[40:43], a[144:147], v[112:127]
    ds_read_b64_tr_b16 v[194:195], v6 offset:31744
    ds_read_b64_tr_b16 v[54:55], v6 offset:17408
    s_add_u32 s50, s59, 16384
    s_waitcnt vmcnt(12)
    v_mfma_f32_32x32x16_bf16 v[128:143], v[36:39], a[148:151], v[128:143]
    ds_read_b64_tr_b16 v[196:197], v7 offset:30720
    ds_read_b64_tr_b16 v[56:57], v7 offset:16384
    buffer_load_dwordx4 a[224:227], v8, s[20:23], s50 offen offset:0 sc1
    v_mfma_f32_32x32x16_bf16 v[144:159], v[40:43], a[148:151], v[144:159]
    ds_read_b64_tr_b16 v[198:199], v7 offset:31744
    ds_read_b64_tr_b16 v[58:59], v7 offset:17408
    ds_write_b128 v18, a[140:143] offset:35840
    buffer_load_dwordx4 a[232:235], v8, s[20:23], s50 offen offset:2048 sc1
    s_waitcnt vmcnt(13) lgkmcnt(15)
    v_mfma_f32_32x32x16_bf16 v[20:35], v[44:47], a[152:155], v[20:35]
    ds_read_b64_tr_b16 v[200:201], v6 offset:32768
    ds_read_b64_tr_b16 v[60:61], v6 offset:18432
    s_add_u32 s50, s56, 16384
    s_waitcnt lgkmcnt(12)
    v_mfma_f32_32x32x16_bf16 v[112:127], v[48:51], a[152:155], v[112:127]
    s_barrier
    ds_read_b64_tr_b16 v[202:203], v6 offset:33792
    ds_read_b64_tr_b16 v[62:63], v6 offset:19456
    buffer_load_dwordx4 a[180:183], v9, s[20:23], s50 offen offset:0 sc1
    s_waitcnt vmcnt(13)
    v_mfma_f32_32x32x16_bf16 v[128:143], v[44:47], a[156:159], v[128:143]
    ds_read_b64_tr_b16 v[204:205], v7 offset:32768
    ds_read_b64_tr_b16 v[64:65], v7 offset:18432
    buffer_load_dwordx4 a[188:191], v9, s[20:23], s50 offen offset:2048 sc1
    v_mfma_f32_32x32x16_bf16 v[144:159], v[48:51], a[156:159], v[144:159]
    ds_read_b64_tr_b16 v[206:207], v7 offset:33792
    ds_read_b64_tr_b16 v[66:67], v7 offset:19456
    s_add_u32 s50, s57, 16384
    s_waitcnt vmcnt(13) lgkmcnt(13)
    v_mfma_f32_32x32x16_bf16 v[20:35], v[52:55], a[160:163], v[20:35]
    ds_read_b64_tr_b16 v[208:209], v6 offset:34816
    ds_read_b64_tr_b16 v[36:37], v6 offset:20480
    buffer_load_dwordx4 a[196:199], v9, s[20:23], s50 offen offset:0 sc1
    s_waitcnt lgkmcnt(11)
    v_mfma_f32_32x32x16_bf16 v[112:127], v[56:59], a[160:163], v[112:127]
    ds_read_b64_tr_b16 v[210:211], v6 offset:35840
    ds_read_b64_tr_b16 v[38:39], v6 offset:21504
    buffer_load_dwordx4 a[204:207], v9, s[20:23], s50 offen offset:2048 sc1
    s_waitcnt vmcnt(14)
    v_mfma_f32_32x32x16_bf16 v[128:143], v[52:55], a[164:167], v[128:143]
    ds_read_b64_tr_b16 v[212:213], v7 offset:34816
    ds_read_b64_tr_b16 v[40:41], v7 offset:20480
    s_add_u32 s50, s58, 16384
    v_mfma_f32_32x32x16_bf16 v[144:159], v[56:59], a[164:167], v[144:159]
    ds_read_b64_tr_b16 v[214:215], v7 offset:35840
    ds_read_b64_tr_b16 v[42:43], v7 offset:21504
    buffer_load_dwordx4 a[212:215], v9, s[20:23], s50 offen offset:0 sc1
    s_waitcnt vmcnt(14) lgkmcnt(12)
    v_mfma_f32_32x32x16_bf16 v[20:35], v[60:63], a[168:171], v[20:35]
    buffer_load_dwordx4 a[220:223], v9, s[20:23], s50 offen offset:2048 sc1
    s_waitcnt lgkmcnt(8)
    v_mfma_f32_32x32x16_bf16 v[112:127], v[64:67], a[168:171], v[112:127]
    s_add_u32 s50, s59, 16384
    s_waitcnt vmcnt(14)
    v_mfma_f32_32x32x16_bf16 v[128:143], v[60:63], a[172:175], v[128:143]
    buffer_load_dwordx4 a[228:231], v9, s[20:23], s50 offen offset:0 sc1
    v_mfma_f32_32x32x16_bf16 v[144:159], v[64:67], a[172:175], v[144:159]
    buffer_load_dwordx4 a[236:239], v9, s[20:23], s50 offen offset:2048 sc1
    s_waitcnt vmcnt(15) lgkmcnt(0)
    v_mfma_f32_32x32x16_bf16 v[112:127], v[40:43], a[176:179], v[112:127]
    s_waitcnt vmcnt(14)
    v_mfma_f32_32x32x16_bf16 v[112:127], v[164:167], a[184:187], v[112:127]
    buffer_store_dword v13, v0, s[20:23], 0 offen offset:156 sc1
    s_waitcnt vmcnt(14)
    v_mfma_f32_32x32x16_bf16 v[112:127], v[172:175], a[192:195], v[112:127]
    s_waitcnt vmcnt(13)
    v_mfma_f32_32x32x16_bf16 v[112:127], v[180:183], a[200:203], v[112:127]
    s_waitcnt vmcnt(12)
    v_mfma_f32_32x32x16_bf16 v[112:127], v[188:191], a[208:211], v[112:127]
    s_waitcnt vmcnt(11)
    v_mfma_f32_32x32x16_bf16 v[112:127], v[196:199], a[216:219], v[112:127]
    s_waitcnt vmcnt(10)
    v_mfma_f32_32x32x16_bf16 v[112:127], v[204:207], a[224:227], v[112:127]
    s_waitcnt vmcnt(9)
    v_mfma_f32_32x32x16_bf16 v[112:127], v[212:215], a[232:235], v[112:127]
    v_add_f32 v20, v20, v84
    v_add_f32 v21, v21, v85
    v_add_f32 v22, v22, v86
    v_add_f32 v23, v23, v87
    v_add_f32 v24, v24, v88
    s_waitcnt vmcnt(8)
    v_mfma_f32_32x32x16_bf16 v[128:143], v[36:39], a[180:183], v[128:143]
    v_add_f32 v25, v25, v89
    v_add_f32 v26, v26, v90
    v_add_f32 v27, v27, v91
    v_add_f32 v28, v28, v92
    v_add_f32 v29, v29, v93
    s_waitcnt vmcnt(7)
    v_mfma_f32_32x32x16_bf16 v[128:143], v[160:163], a[188:191], v[128:143]
    ds_write_b128 v15, v[112:115] offset:0
    s_waitcnt vmcnt(6)
    v_mfma_f32_32x32x16_bf16 v[128:143], v[168:171], a[196:199], v[128:143]
    ds_write_b128 v15, v[116:119] offset:1024
    s_waitcnt vmcnt(5)
    v_mfma_f32_32x32x16_bf16 v[128:143], v[176:179], a[204:207], v[128:143]
    s_waitcnt vmcnt(4)
    v_mfma_f32_32x32x16_bf16 v[128:143], v[184:187], a[212:215], v[128:143]
    ds_write_b128 v15, v[120:123] offset:2048
    s_waitcnt vmcnt(3)
    v_mfma_f32_32x32x16_bf16 v[128:143], v[192:195], a[220:223], v[128:143]
    ds_write_b128 v15, v[124:127] offset:3072
    s_waitcnt vmcnt(2)
    v_mfma_f32_32x32x16_bf16 v[128:143], v[200:203], a[228:231], v[128:143]
    s_waitcnt vmcnt(1)
    v_mfma_f32_32x32x16_bf16 v[128:143], v[208:211], a[236:239], v[128:143]
    v_add_f32 v30, v30, v94
    v_add_f32 v31, v31, v95
    v_add_f32 v32, v32, v96
    v_add_f32 v33, v33, v97
    v_add_f32 v34, v34, v98
    v_mfma_f32_32x32x16_bf16 v[144:159], v[40:43], a[180:183], v[144:159]
    v_add_f32 v35, v35, v99
    s_nop 3
    v_mfma_f32_32x32x16_bf16 v[144:159], v[164:167], a[188:191], v[144:159]
    ds_write_b128 v16, v[128:131] offset:0
    v_mfma_f32_32x32x16_bf16 v[144:159], v[172:175], a[196:199], v[144:159]
    ds_write_b128 v16, v[132:135] offset:1024
    v_mfma_f32_32x32x16_bf16 v[144:159], v[180:183], a[204:207], v[144:159]
    v_mfma_f32_32x32x16_bf16 v[144:159], v[188:191], a[212:215], v[144:159]
    ds_write_b128 v16, v[136:139] offset:2048
    v_mfma_f32_32x32x16_bf16 v[144:159], v[196:199], a[220:223], v[144:159]
    ds_write_b128 v16, v[140:143] offset:3072
    v_mfma_f32_32x32x16_bf16 v[144:159], v[204:207], a[228:231], v[144:159]
    v_mfma_f32_32x32x16_bf16 v[144:159], v[212:215], a[236:239], v[144:159]
    s_nop 4
    v_mfma_f32_32x32x16_bf16 v[20:35], v[36:39], a[176:179], v[20:35]
    s_nop 4
    v_mfma_f32_32x32x16_bf16 v[20:35], v[160:163], a[184:187], v[20:35]
    ds_write_b128 v17, v[144:147] offset:0
    v_mfma_f32_32x32x16_bf16 v[20:35], v[168:171], a[192:195], v[20:35]
    ds_write_b128 v17, v[148:151] offset:1024
    v_mfma_f32_32x32x16_bf16 v[20:35], v[176:179], a[200:203], v[20:35]
    v_mfma_f32_32x32x16_bf16 v[20:35], v[184:187], a[208:211], v[20:35]
    ds_write_b128 v17, v[152:155] offset:2048
    v_mfma_f32_32x32x16_bf16 v[20:35], v[192:195], a[216:219], v[20:35]
    ds_write_b128 v17, v[156:159] offset:3072
    v_mfma_f32_32x32x16_bf16 v[20:35], v[200:203], a[224:227], v[20:35]
    v_mfma_f32_32x32x16_bf16 v[20:35], v[208:211], a[232:235], v[20:35]
    s_waitcnt lgkmcnt(0)
    s_barrier
    ds_read_b128 v[112:115], v18 offset:0
    ds_read_b128 v[116:119], v18 offset:1024
    ds_read_b128 v[128:131], v18 offset:4096
    ds_read_b128 v[132:135], v18 offset:5120
    ds_read_b128 v[144:147], v18 offset:8192
    ds_read_b128 v[148:151], v18 offset:9216
    ds_read_b128 v[120:123], v18 offset:2048
    ds_read_b128 v[124:127], v18 offset:3072
    ds_read_b128 v[136:139], v18 offset:6144
    ds_read_b128 v[140:143], v18 offset:7168
    ds_read_b128 v[152:155], v18 offset:10240
    ds_read_b128 v[156:159], v18 offset:11264
    s_waitcnt lgkmcnt(11)
    v_pk_add_f32 v[20:21], v[20:21], v[112:113]
    v_pk_add_f32 v[22:23], v[22:23], v[114:115]
    s_waitcnt lgkmcnt(10)
    v_pk_add_f32 v[24:25], v[24:25], v[116:117]
    v_pk_add_f32 v[26:27], v[26:27], v[118:119]
    s_waitcnt lgkmcnt(9)
    v_pk_add_f32 v[20:21], v[20:21], v[128:129]
    v_pk_add_f32 v[22:23], v[22:23], v[130:131]
    s_waitcnt lgkmcnt(8)
    v_pk_add_f32 v[24:25], v[24:25], v[132:133]
    v_pk_add_f32 v[26:27], v[26:27], v[134:135]
    s_waitcnt lgkmcnt(7)
    v_pk_add_f32 v[20:21], v[20:21], v[144:145]
    v_pk_add_f32 v[22:23], v[22:23], v[146:147]
    s_waitcnt lgkmcnt(6)
    v_pk_add_f32 v[24:25], v[24:25], v[148:149]
    v_pk_add_f32 v[26:27], v[26:27], v[150:151]
    v_cvt_pk_bf16_f32 v84, v20, v21
    v_cvt_pk_bf16_f32 v85, v22, v23
    v_cvt_pk_bf16_f32 v86, v24, v25
    v_cvt_pk_bf16_f32 v87, v26, v27
    buffer_store_dwordx4 v[84:87], v14, s[24:27], 0 offen offset:0
    s_waitcnt lgkmcnt(5)
    v_pk_add_f32 v[28:29], v[28:29], v[120:121]
    v_pk_add_f32 v[30:31], v[30:31], v[122:123]
    s_waitcnt lgkmcnt(4)
    v_pk_add_f32 v[32:33], v[32:33], v[124:125]
    v_pk_add_f32 v[34:35], v[34:35], v[126:127]
    s_waitcnt lgkmcnt(3)
    v_pk_add_f32 v[28:29], v[28:29], v[136:137]
    v_pk_add_f32 v[30:31], v[30:31], v[138:139]
    s_waitcnt lgkmcnt(2)
    v_pk_add_f32 v[32:33], v[32:33], v[140:141]
    v_pk_add_f32 v[34:35], v[34:35], v[142:143]
    s_waitcnt lgkmcnt(1)
    v_pk_add_f32 v[28:29], v[28:29], v[152:153]
    v_pk_add_f32 v[30:31], v[30:31], v[154:155]
    s_waitcnt lgkmcnt(0)
    v_pk_add_f32 v[32:33], v[32:33], v[156:157]
    v_pk_add_f32 v[34:35], v[34:35], v[158:159]
    v_cvt_pk_bf16_f32 v88, v28, v29
    v_cvt_pk_bf16_f32 v89, v30, v31
    v_cvt_pk_bf16_f32 v90, v32, v33
    v_cvt_pk_bf16_f32 v91, v34, v35
    buffer_store_dwordx4 v[88:91], v14, s[24:27], 0 offen offset:32
    s_waitcnt vmcnt(0)
    s_endpgm
Lk1_qkv:
    s_sub_u32 s46, s46, 7
    s_and_b32 s49, s45, 1
    s_mul_i32 s49, s49, 3
    s_add_u32 s49, s49, s46
    s_cmp_ge_u32 s49, 7
    s_cselect_b32 s50, 7, 0
    s_sub_u32 s49, s49, s50
    s_lshl_b32 s66, s49, 7
    s_and_b32 s51, s44, 1
    s_lshr_b32 s52, s44, 1
    s_lshl_b32 s49, s45, 7
    s_add_u32 s49, s49, s52
    s_mul_i32 s49, s49, 896
    s_mul_i32 s50, s51, 57344
    s_add_u32 s50, s49, s50
    v_lshrrev_b32 v28, 3, v1
    v_lshrrev_b32 v29, 4, v1
    v_and_b32 v30, 7, v1
    v_xor_b32 v31, v30, v29
    v_mul_u32_u24 v32, 1792, v28
    v_lshl_add_u32 v32, v31, 4, v32
    s_mul_i32 s97, s52, 40960
    s_lshl_b32 s96, s51, 12
    s_add_u32 s96, s96, s97
    s_add_u32 s96, s96, 2048
    v_add_u32 v248, s50, v32
    v_xor_b32 v32, 64, v32
    v_xor_b32 v249, 64, v248
    s_add_u32 m0, s96, 24576
    v_add_u32 v249, 13312, v249
    v_add_u32 v250, 26624, v248
    v_add_u32 v251, 26624, v249
    s_waitcnt lgkmcnt(0)
    buffer_load_dwordx4 v248, s[4:7], s66 offen offset:0 lds
    s_cmp_eq_u32 s45, 0
    s_cselect_b32 s50, 0, 14336
    s_sub_u32 s50, s49, s50
    v_add_u32 v252, s50, v32
    s_mov_b64 s[8:9], s[100:101]
    s_mov_b32 s10, 1204224
    s_lshl_b32 s3, s51, 11
    buffer_load_dwordx4 v249, s[4:7], s66 offen offset:1024 lds
    s_add_u32 s3, s3, s97
    s_add_u32 s3, s3, 81920
    s_add_u32 s97, s97, 1024
    s_sub_u32 s98, s51, 1
    s_not_b32 s99, s98
    s_mul_i32 s49, s44, 43008
    buffer_load_dwordx4 v250, s[4:7], s66 offen offset:2048 lds
    s_mul_i32 s50, s46, 112
    s_add_u32 s49, s49, s50
    v_mul_u32_u24 v28, 2688, v28
    v_and_b32 v31, 1, v29
    v_lshlrev_b32 v31, 1, v31
    v_xor_b32 v30, v30, v31
    v_xor_b32 v31, 4, v30
    buffer_load_dwordx4 v251, s[4:7], s66 offen offset:3072 lds
    v_min_u32 v30, 6, v30
    v_min_u32 v31, 6, v31
    v_add_u32 v28, s49, v28
    v_lshl_add_u32 v253, v30, 4, v28
    v_lshl_add_u32 v254, v31, 4, v28
    v_add_u32 v254, 20480, v254
    s_mul_i32 s73, s66, 1344
    s_add_u32 s74, s73, 896
    s_add_u32 s75, s73, 1792
    s_add_u32 m0, s97, 24576
    s_mov_b64 exec, s[98:99]
    buffer_load_dwordx4 v252, s[4:7], s66 offen lds
    s_mov_b64 exec, -1
    s_add_u32 s67, s66, 128
    s_cmp_eq_u32 s67, 896
    s_cselect_b32 s67, 0, s67
    s_add_u32 m0, s3, 28672
    s_nop 0
    buffer_load_dwordx4 v253, s[8:11], s74 offen offset:0 lds
    s_add_u32 s68, s67, 128
    s_cmp_eq_u32 s68, 896
    s_cselect_b32 s68, 0, s68
    buffer_load_dwordx4 v254, s[8:11], s74 offen offset:1024 lds
    s_add_u32 s69, s68, 128
    s_cmp_eq_u32 s69, 896
    s_cselect_b32 s69, 0, s69
    s_add_u32 m0, s3, 32768
    s_nop 0
    buffer_load_dwordx4 v253, s[8:11], s75 offen offset:0 lds
    s_add_u32 s70, s69, 128
    buffer_load_dwordx4 v254, s[8:11], s75 offen offset:1024 lds
    s_cmp_eq_u32 s70, 896
    s_cselect_b32 s70, 0, s70
    s_add_u32 s71, s70, 128
    s_add_u32 m0, s3, 24576
    s_nop 0
    buffer_load_dwordx4 v253, s[8:11], s73 offen offset:0 lds
    s_cmp_eq_u32 s71, 896
    s_cselect_b32 s71, 0, s71
    s_add_u32 s72, s71, 128
    buffer_load_dwordx4 v254, s[8:11], s73 offen offset:1024 lds
    s_cmp_eq_u32 s72, 896
    s_cselect_b32 s72, 0, s72
    s_load_dwordx2 s[28:29], s[0:1], 40
    s_mov_b32 s30, 3584
    s_mov_b32 s31, 0x00020000
    s_load_dwordx2 s[20:21], s[0:1], 80
    s_mov_b32 s22, 268435456
    s_mov_b32 s23, 0x00020000
    s_load_dwordx2 s[16:17], s[0:1], 16
    s_mov_b32 s18, 401408
    s_mov_b32 s19, 0x00020000
    s_load_dwordx2 s[12:13], s[0:1], 48
    s_mov_b32 s14, 1605632
    s_mov_b32 s15, 0x00020000
    s_load_dwordx2 s[32:33], s[0:1], 56
    s_mov_b32 s34, 896
    s_mov_b32 s35, 0x00020000
    s_load_dwordx2 s[24:25], s[0:1], 64
    s_mov_b32 s26, 1835008
    s_mov_b32 s27, 0x00020000
    s_load_dwordx2 s[36:37], s[0:1], 72
    s_mov_b32 s38, 256
    s_mov_b32 s39, 0x00020000
    s_mov_b32 s77, 0x8000
    s_mov_b32 m0, s96
    s_nop 0
    buffer_load_dwordx4 v248, s[4:7], s67 offen offset:0 lds
    v_and_b32 v28, 15, v1
    s_mul_i32 s49, s52, 40960
    v_lshl_add_u32 v30, v28, 7, s49
    v_lshrrev_b32 v31, 1, v28
    s_mul_i32 s73, s67, 1344
    buffer_load_dwordx4 v249, s[4:7], s67 offen offset:1024 lds
    v_xor_b32 v31, v31, v29
    s_lshl_b32 s50, s51, 2
    v_xor_b32 v31, s50, v31
    v_lshl_add_u32 v19, v31, 4, v30
    s_add_u32 s74, s73, 896
    buffer_load_dwordx4 v250, s[4:7], s67 offen offset:2048 lds
    v_xor_b32 v20, 64, v19
    s_lshl_b32 s50, s51, 9
    s_add_u32 s49, s49, s50
    s_add_u32 s75, s73, 1792
    buffer_load_dwordx4 v251, s[4:7], s67 offen offset:3072 lds
    v_lshl_add_u32 v34, v1, 3, s49
    v_mov_b32 v36, 0x3f803f80
    v_mov_b32 v37, 0x3f803f80
    ds_write_b64 v34, v[36:37]
    s_mov_b32 m0, s97
    s_mov_b64 exec, s[98:99]
    buffer_load_dwordx4 v252, s[4:7], s67 offen lds
    s_mov_b64 exec, -1
    ds_write_b64 v34, v[36:37] offset:12288
    ds_write_b64 v34, v[36:37] offset:24576
    v_bfe_u32 v30, v1, 2, 2
    v_lshl_add_u32 v30, v29, 3, v30
    s_add_u32 m0, s3, 4096
    s_nop 0
    buffer_load_dwordx4 v253, s[8:11], s74 offen offset:0 lds
    v_lshlrev_b32 v30, 7, v30
    v_bfe_u32 v31, v1, 3, 2
    v_lshlrev_b32 v31, 5, v31
    buffer_load_dwordx4 v254, s[8:11], s74 offen offset:1024 lds
    s_mul_i32 s49, s51, 56
    v_and_b32 v35, 3, v1
    v_lshl_add_u32 v32, v35, 3, s49
    v_add_u32 v33, 32, v32
    s_add_u32 m0, s3, 8192
    s_nop 0
    buffer_load_dwordx4 v253, s[8:11], s75 offen offset:0 lds
    v_xor_b32 v32, v32, v31
    v_xor_b32 v33, v33, v31
    s_mul_i32 s49, s51, 40960
    s_sub_u32 s50, 122880, s49
    buffer_load_dwordx4 v254, s[8:11], s75 offen offset:1024 lds
    s_add_u32 s49, s49, 81920
    v_add3_u32 v21, v30, v32, s49
    v_add3_u32 v22, v30, v33, s49
    s_mov_b32 m0, s3
    s_nop 0
    buffer_load_dwordx4 v253, s[8:11], s73 offen offset:0 lds
    v_add3_u32 v23, v30, v32, s50
    v_add3_u32 v24, v30, v33, s50
    v_and_b32 v30, 511, v22
    v_cmp_eq_u32 vcc, 3, v35
    buffer_load_dwordx4 v254, s[8:11], s73 offen offset:1024 lds
    v_add_u32 v30, 36864, v30
    v_cndmask_b32 v25, v22, v30, vcc
    v_cndmask_b32 v26, v24, v30, vcc
    s_waitcnt vmcnt(11)
    s_waitcnt lgkmcnt(0)
    s_barrier
    ds_read_b64_tr_b16 a[192:193], v21 offset:28672
    ds_read_b64_tr_b16 a[194:195], v21 offset:29184
    ds_read_b128 a[144:147], v19 offset:24576
    ds_read_b128 a[148:151], v19 offset:26624
    ds_read_b128 a[152:155], v19 offset:28672
    ds_read_b128 a[156:159], v19 offset:30720
    ds_read_b128 a[160:163], v19 offset:32768
    ds_read_b64_tr_b16 a[196:197], v25 offset:28672
    ds_read_b64_tr_b16 a[198:199], v25 offset:29184
    ds_read_b64_tr_b16 a[200:201], v21 offset:32768
    ds_read_b64_tr_b16 a[202:203], v21 offset:33280
    ds_read_b64_tr_b16 a[204:205], v22 offset:32768
    ds_read_b64_tr_b16 a[206:207], v22 offset:33280
    ds_read_b64_tr_b16 a[184:185], v21 offset:24576
    ds_read_b64_tr_b16 a[186:187], v21 offset:25088
    ds_read_b64_tr_b16 a[188:189], v22 offset:24576
    ds_read_b64_tr_b16 a[190:191], v22 offset:25088
    s_waitcnt lgkmcnt(14)
    v_mfma_f32_16x16x32_bf16 v[68:71], a[192:195], a[144:147], 0
    s_add_u32 m0, s96, 12288
    ds_read_b64_tr_b16 a[216:217], v23 offset:28672
    s_waitcnt lgkmcnt(14)
    v_mfma_f32_16x16x32_bf16 v[72:75], a[192:195], a[148:151], 0
    buffer_load_dwordx4 v248, s[4:7], s68 offen offset:0 lds
    s_waitcnt lgkmcnt(13)
    v_mfma_f32_16x16x32_bf16 v[76:79], a[192:195], a[152:155], 0
    s_and_b32 s49, s47, 3
    ds_read_b64_tr_b16 a[218:219], v23 offset:29184
    s_lshl1_add_u32 s53, s49, s48
    s_waitcnt lgkmcnt(13)
    v_mfma_f32_16x16x32_bf16 v[80:83], a[192:195], a[156:159], 0
    s_cmp_ge_u32 s53, 7
    s_cselect_b32 s50, 7, 0
    ds_read_b128 a[164:167], v20 offset:24576
    s_waitcnt lgkmcnt(13)
    v_mfma_f32_16x16x32_bf16 v[84:87], a[192:195], a[160:163], 0
    s_mul_i32 s73, s68, 1344
    s_sub_u32 s53, s53, s50
    s_lshl_b32 s53, s53, 15
    s_waitcnt lgkmcnt(11)
    v_mfma_f32_16x16x32_bf16 v[88:91], a[196:199], a[144:147], 0
    s_add_u32 s49, s49, s48
    buffer_load_dwordx4 v249, s[4:7], s68 offen offset:1024 lds
    v_mfma_f32_16x16x32_bf16 v[92:95], a[196:199], a[148:151], 0
    s_add_u32 s62, s49, 0
    ds_read_b128 a[168:171], v20 offset:26624
    s_and_b32 s62, s62, 3
    v_mfma_f32_16x16x32_bf16 v[96:99], a[196:199], a[152:155], 0
    s_add_u32 s63, s49, 1
    ds_read_b128 a[172:175], v20 offset:28672
    s_and_b32 s63, s63, 3
    v_mfma_f32_16x16x32_bf16 v[100:103], a[196:199], a[156:159], 0
    s_add_u32 s74, s73, 896
    ds_read_b128 a[176:179], v20 offset:30720
    s_add_u32 s64, s49, 2
    v_mfma_f32_16x16x32_bf16 v[104:107], a[196:199], a[160:163], 0
    s_and_b32 s64, s64, 3
    buffer_load_dwordx4 v250, s[4:7], s68 offen offset:2048 lds
    s_waitcnt lgkmcnt(12)
    v_mfma_f32_16x16x32_bf16 v[108:111], a[144:147], a[200:203], 0
    s_add_u32 s65, s49, 3
    s_and_b32 s65, s65, 3
    s_add_u32 s54, s53, 32768
    v_mfma_f32_16x16x32_bf16 v[112:115], a[148:151], a[200:203], 0
    s_cmp_eq_u32 s54, 229376
    s_cselect_b32 s54, 0, s54
    ds_read_b128 a[180:183], v20 offset:32768
    v_mfma_f32_16x16x32_bf16 v[116:119], a[152:155], a[200:203], 0
    s_add_u32 s75, s73, 1792
    ds_read_b64_tr_b16 a[220:221], v26 offset:28672
    s_add_u32 s55, s54, 32768
    v_mfma_f32_16x16x32_bf16 v[120:123], a[156:159], a[200:203], 0
    buffer_load_dwordx4 v251, s[4:7], s68 offen offset:3072 lds
    v_mfma_f32_16x16x32_bf16 v[124:127], a[160:163], a[200:203], 0
    s_cmp_eq_u32 s55, 229376
    s_cselect_b32 s55, 0, s55
    ds_read_b64_tr_b16 a[222:223], v26 offset:29184
    s_waitcnt lgkmcnt(13)
    v_mfma_f32_16x16x32_bf16 v[128:131], a[144:147], a[204:207], 0
    s_add_u32 s56, s55, 32768
    s_cmp_eq_u32 s56, 229376
    s_cselect_b32 s56, 0, s56
    v_mfma_f32_16x16x32_bf16 v[132:135], a[148:151], a[204:207], 0
    s_add_u32 m0, s97, 12288
    ds_read_b64_tr_b16 a[224:225], v23 offset:32768
    s_add_u32 s57, s56, 32768
    v_mfma_f32_16x16x32_bf16 v[136:139], a[152:155], a[204:207], 0
    s_mov_b64 exec, s[98:99]
    buffer_load_dwordx4 v252, s[4:7], s68 offen lds
    s_mov_b64 exec, -1
    v_mfma_f32_16x16x32_bf16 v[140:143], a[156:159], a[204:207], 0
    s_cmp_eq_u32 s57, 229376
    s_cselect_b32 s57, 0, s57
    ds_read_b64_tr_b16 a[226:227], v23 offset:33280
    v_mfma_f32_16x16x32_bf16 v[144:147], a[160:163], a[204:207], 0
    s_add_u32 s58, s57, 32768
    ds_read_b64_tr_b16 a[228:229], v24 offset:32768
    s_waitcnt lgkmcnt(14)
    v_mfma_f32_16x16x32_bf16 v[28:31], a[184:187], a[144:147], 0
    s_add_u32 m0, s3, 16384
    s_cmp_eq_u32 s58, 229376
    s_cselect_b32 s58, 0, s58
    v_mfma_f32_16x16x32_bf16 v[32:35], a[184:187], a[148:151], 0
    s_add_u32 s59, s58, 32768
    buffer_load_dwordx4 v253, s[8:11], s74 offen offset:0 lds
    v_mfma_f32_16x16x32_bf16 v[36:39], a[184:187], a[152:155], 0
    s_cmp_eq_u32 s59, 229376
    s_cselect_b32 s59, 0, s59
    ds_read_b64_tr_b16 a[230:231], v24 offset:33280
    v_mfma_f32_16x16x32_bf16 v[40:43], a[184:187], a[156:159], 0
    s_mul_i32 s60, s44, 12288
    ds_read_b64_tr_b16 a[208:209], v23 offset:24576
    s_add_u32 s60, s60, 229376
    v_mfma_f32_16x16x32_bf16 v[44:47], a[184:187], a[160:163], 0
    s_mul_i32 s61, s44, 71680
    ds_read_b64_tr_b16 a[210:211], v23 offset:25088
    v_lshrrev_b32 v14, 3, v1
    s_waitcnt lgkmcnt(15)
    v_mfma_f32_16x16x32_bf16 v[48:51], a[188:191], a[144:147], 0
    buffer_load_dwordx4 v254, s[8:11], s74 offen offset:1024 lds
    v_mfma_f32_16x16x32_bf16 v[52:55], a[188:191], a[148:151], 0
    v_mul_u32_u24 v2, 896, v14
    v_lshrrev_b32 v14, 2, v1
    v_mfma_f32_16x16x32_bf16 v[56:59], a[188:191], a[152:155], 0
    ds_read_b64_tr_b16 a[212:213], v24 offset:24576
    v_and_b32 v14, 4, v14
    v_mfma_f32_16x16x32_bf16 v[60:63], a[188:191], a[156:159], 0
    s_add_u32 m0, s3, 20480
    ds_read_b64_tr_b16 a[214:215], v24 offset:25088
    v_and_b32 v3, 7, v1
    v_mfma_f32_16x16x32_bf16 v[64:67], a[188:191], a[160:163], 0
    buffer_load_dwordx4 v253, s[8:11], s75 offen offset:0 lds
    v_mfma_f32_16x16x32_bf16 v[148:151], a[144:147], a[144:147], 0
    v_xor_b32 v14, v14, v3
    v_lshl_add_u32 v2, v14, 4, v2
    v_mfma_f32_16x16x32_bf16 v[152:155], a[148:151], a[148:151], 0
    s_lshl_b32 s49, s48, 7
    s_mul_i32 s50, s44, 28672
    s_add_u32 s49, s49, s50
    v_mfma_f32_16x16x32_bf16 v[156:159], a[152:155], a[152:155], 0
    s_cmp_eq_u32 s48, 7
    s_cselect_b32 s49, 2146435072, s49
    v_add_u32 v2, s49, v2
    v_mfma_f32_16x16x32_bf16 v[160:163], a[156:159], a[156:159], 0
    v_add_u32 v3, 6144, v2
    v_add_u32 v4, 12288, v2
    v_mfma_f32_16x16x32_bf16 v[164:167], a[160:163], a[160:163], 0
    s_waitcnt vmcnt(8) lgkmcnt(0)
    s_barrier
    v_add_u32 v5, 18432, v2
    v_mfma_f32_16x16x32_bf16 v[68:71], a[216:219], a[164:167], v[68:71]
    s_mul_i32 s49, s47, 294912
    ds_read_b64_tr_b16 a[192:193], v21 offset:4096
    s_lshl_b32 s50, s44, 12
    v_mfma_f32_16x16x32_bf16 v[72:75], a[216:219], a[168:171], v[72:75]
    s_add_u32 s49, s49, s50
    buffer_load_dwordx4 v254, s[8:11], s75 offen offset:1024 lds
    v_mfma_f32_16x16x32_bf16 v[76:79], a[216:219], a[172:175], v[76:79]
    s_and_b32 s50, s44, 1
    ds_read_b64_tr_b16 a[194:195], v21 offset:4608
    s_lshl_b32 s50, s50, 10
    v_mfma_f32_16x16x32_bf16 v[80:83], a[216:219], a[176:179], v[80:83]
    s_add_u32 m0, s3, 12288
    ds_read_b128 a[144:147], v19 offset:0
    s_add_u32 s49, s49, s50
    v_mfma_f32_16x16x32_bf16 v[84:87], a[216:219], a[180:183], v[84:87]
    buffer_load_dwordx4 v253, s[8:11], s73 offen offset:0 lds
    v_mfma_f32_16x16x32_bf16 v[88:91], a[220:223], a[164:167], v[88:91]
    ds_read_b128 a[148:151], v19 offset:2048
    v_lshl_add_u32 v8, v1, 4, s49
    v_mfma_f32_16x16x32_bf16 v[92:95], a[220:223], a[168:171], v[92:95]
    ds_read_b128 a[152:155], v19 offset:4096
    v_xor_b32 v9, 1024, v8
    v_mfma_f32_16x16x32_bf16 v[96:99], a[220:223], a[172:175], v[96:99]
    s_lshr_b32 s49, s47, 1
    ds_read_b128 a[156:159], v19 offset:6144
    s_lshl2_add_u32 s49, s49, s44
    v_mfma_f32_16x16x32_bf16 v[100:103], a[220:223], a[176:179], v[100:103]
    s_lshl_b32 s49, s49, 8
    buffer_load_dwordx4 v254, s[8:11], s73 offen offset:1024 lds
    v_mfma_f32_16x16x32_bf16 v[104:107], a[220:223], a[180:183], v[104:107]
    ds_read_b128 a[160:163], v19 offset:8192
    v_and_b32 v10, 31, v1
    v_mfma_f32_16x16x32_bf16 v[108:111], a[164:167], a[224:227], v[108:111]
    s_add_u32 m0, s96, 24576
    ds_read_b64_tr_b16 a[196:197], v25 offset:4096
    s_add_u32 s49, s49, 12582912
    v_mfma_f32_16x16x32_bf16 v[112:115], a[168:171], a[224:227], v[112:115]
    buffer_load_dwordx4 v248, s[4:7], s69 offen offset:0 lds
    v_mfma_f32_16x16x32_bf16 v[116:119], a[172:175], a[224:227], v[116:119]
    ds_read_b64_tr_b16 a[198:199], v25 offset:4608
    v_lshl_add_u32 v10, v10, 2, s49
    v_mfma_f32_16x16x32_bf16 v[120:123], a[176:179], a[224:227], v[120:123]
    ds_read_b64_tr_b16 a[200:201], v21 offset:8192
    v_lshrrev_b32 v6, 5, v1
    v_mfma_f32_16x16x32_bf16 v[124:127], a[180:183], a[224:227], v[124:127]
    s_mul_i32 s73, s69, 1344
    ds_read_b64_tr_b16 a[202:203], v21 offset:8704
    v_lshlrev_b32 v6, 2, v6
    v_mfma_f32_16x16x32_bf16 v[128:131], a[164:167], a[228:231], v[128:131]
    buffer_load_dwordx4 v249, s[4:7], s69 offen offset:1024 lds
    v_mfma_f32_16x16x32_bf16 v[132:135], a[168:171], a[228:231], v[132:135]
    ds_read_b64_tr_b16 a[204:205], v22 offset:8192
    v_bfe_u32 v14, v1, 2, 2
    v_mfma_f32_16x16x32_bf16 v[136:139], a[172:175], a[228:231], v[136:139]
    s_add_u32 s74, s73, 896
    ds_read_b64_tr_b16 a[206:207], v22 offset:8704
    v_add_u32 v6, v6, v14
    v_mfma_f32_16x16x32_bf16 v[140:143], a[176:179], a[228:231], v[140:143]
    buffer_load_dwordx4 v250, s[4:7], s69 offen offset:2048 lds
    v_mfma_f32_16x16x32_bf16 v[144:147], a[180:183], a[228:231], v[144:147]
    ds_read_b64_tr_b16 a[184:185], v21 offset:0
    v_lshlrev_b32 v6, 7, v6
    v_mfma_f32_16x16x32_bf16 v[28:31], a[208:211], a[164:167], v[28:31]
    ds_read_b64_tr_b16 a[186:187], v21 offset:512
    v_bfe_u32 v14, v1, 3, 1
    v_mfma_f32_16x16x32_bf16 v[32:35], a[208:211], a[168:171], v[32:35]
    s_add_u32 s75, s73, 1792
    ds_read_b64_tr_b16 a[188:189], v22 offset:0
    v_lshl_add_u32 v6, v14, 6, v6
    v_mfma_f32_16x16x32_bf16 v[36:39], a[208:211], a[172:175], v[36:39]
    buffer_load_dwordx4 v251, s[4:7], s69 offen offset:3072 lds
    v_mfma_f32_16x16x32_bf16 v[40:43], a[208:211], a[176:179], v[40:43]
    ds_read_b64_tr_b16 a[190:191], v22 offset:512
    v_bfe_u32 v14, v1, 4, 1
    v_mfma_f32_16x16x32_bf16 v[44:47], a[208:211], a[180:183], v[44:47]
    s_add_u32 m0, s97, 24576
    v_lshl_add_u32 v6, v14, 5, v6
    v_and_b32 v14, 1, v1
    v_mfma_f32_16x16x32_bf16 v[48:51], a[212:215], a[164:167], v[48:51]
    s_mov_b64 exec, s[98:99]
    buffer_load_dwordx4 v252, s[4:7], s69 offen lds
    s_mov_b64 exec, -1
    v_mfma_f32_16x16x32_bf16 v[52:55], a[212:215], a[168:171], v[52:55]
    v_lshl_add_u32 v6, v14, 4, v6
    v_bfe_u32 v14, v1, 1, 1
    v_mfma_f32_16x16x32_bf16 v[56:59], a[212:215], a[172:175], v[56:59]
    v_lshl_add_u32 v6, v14, 3, v6
    s_lshr_b32 s49, s44, 1
    v_mfma_f32_16x16x32_bf16 v[60:63], a[212:215], a[176:179], v[60:63]
    s_lshl_b32 s49, s49, 6
    v_xor_b32 v6, s49, v6
    v_add_u32 v6, s78, v6
    v_mfma_f32_16x16x32_bf16 v[64:67], a[212:215], a[180:183], v[64:67]
    s_waitcnt lgkmcnt(0)
    v_xor_b32 v7, 64, v6
    v_and_b32 v233, 15, v1
    v_mfma_f32_16x16x32_bf16 v[68:71], a[192:195], a[144:147], v[68:71]
    s_add_u32 m0, s3, 28672
    ds_read_b64_tr_b16 a[216:217], v23 offset:4096
    v_lshrrev_b32 v255, 4, v1
    v_mfma_f32_16x16x32_bf16 v[72:75], a[192:195], a[148:151], v[72:75]
    s_mul_i32 s49, s45, 589824
    buffer_load_dwordx4 v253, s[8:11], s74 offen offset:0 lds
    v_mfma_f32_16x16x32_bf16 v[76:79], a[192:195], a[152:155], v[76:79]
    s_lshl_b32 s50, s46, 13
    ds_read_b64_tr_b16 a[218:219], v23 offset:4608
    s_add_u32 s49, s49, s50
    v_mfma_f32_16x16x32_bf16 v[80:83], a[192:195], a[156:159], v[80:83]
    s_and_b32 s50, s44, 1
    ds_read_b128 a[164:167], v20 offset:0
    s_lshl_b32 s50, s50, 12
    v_mfma_f32_16x16x32_bf16 v[84:87], a[192:195], a[160:163], v[84:87]
    s_add_u32 s49, s49, s50
    s_lshr_b32 s50, s44, 1
    s_lshl_b32 s50, s50, 10
    v_mfma_f32_16x16x32_bf16 v[88:91], a[196:199], a[144:147], v[88:91]
    s_add_u32 s49, s49, s50
    ds_read_b128 a[168:171], v20 offset:2048
    s_add_u32 s49, s49, 229376
    v_mfma_f32_16x16x32_bf16 v[92:95], a[196:199], a[148:151], v[92:95]
    buffer_load_dwordx4 v254, s[8:11], s74 offen offset:1024 lds
    v_mfma_f32_16x16x32_bf16 v[96:99], a[196:199], a[152:155], v[96:99]
    ds_read_b128 a[172:175], v20 offset:4096
    v_lshl_add_u32 v247, v233, 4, s49
    v_mfma_f32_16x16x32_bf16 v[100:103], a[196:199], a[156:159], v[100:103]
    v_lshrrev_b32 v14, 5, v1
    v_lshl_add_u32 v247, v14, 11, v247
    v_mfma_f32_16x16x32_bf16 v[104:107], a[196:199], a[160:163], v[104:107]
    ds_read_b128 a[176:179], v20 offset:6144
    v_and_b32 v14, 1, v255
    v_mfma_f32_16x16x32_bf16 v[108:111], a[144:147], a[200:203], v[108:111]
    ds_read_b128 a[180:183], v20 offset:8192
    v_lshl_add_u32 v247, v14, 9, v247
    v_mfma_f32_16x16x32_bf16 v[112:115], a[148:151], a[200:203], v[112:115]
    s_add_u32 m0, s3, 32768
    ds_read_b64_tr_b16 a[220:221], v26 offset:4096
    s_add_u32 s49, s78, 36864
    v_mfma_f32_16x16x32_bf16 v[116:119], a[152:155], a[200:203], v[116:119]
    buffer_load_dwordx4 v253, s[8:11], s75 offen offset:0 lds
    v_mfma_f32_16x16x32_bf16 v[120:123], a[156:159], a[200:203], v[120:123]
    v_lshl_add_u32 v16, v233, 6, s49
    s_add_u32 s49, s49, 1024
    v_mfma_f32_16x16x32_bf16 v[124:127], a[160:163], a[200:203], v[124:127]
    ds_read_b64_tr_b16 a[222:223], v26 offset:4608
    v_lshl_add_u32 v18, v233, 2, s49
    v_mfma_f32_16x16x32_bf16 v[128:131], a[144:147], a[204:207], v[128:131]
    ds_read_b64_tr_b16 a[224:225], v23 offset:8192
    v_lshl_add_u32 v246, v255, 4, s49
    v_mfma_f32_16x16x32_bf16 v[132:135], a[148:151], a[204:207], v[132:135]
    s_xor_b32 s49, s44, 1
    s_mul_i32 s49, s49, 40960
    s_add_u32 s49, s49, 36864
    v_mfma_f32_16x16x32_bf16 v[136:139], a[152:155], a[204:207], v[136:139]
    buffer_load_dwordx4 v254, s[8:11], s75 offen offset:1024 lds
    v_mfma_f32_16x16x32_bf16 v[140:143], a[156:159], a[204:207], v[140:143]
    ds_read_b64_tr_b16 a[226:227], v23 offset:8704
    v_lshl_add_u32 v17, v233, 6, s49
    v_mfma_f32_16x16x32_bf16 v[144:147], a[160:163], a[204:207], v[144:147]
    s_lshr_b32 s50, s46, 1
    ds_read_b64_tr_b16 a[228:229], v24 offset:8192
    s_lshl2_add_u32 s49, s45, s50
    v_mfma_f32_16x16x32_bf16 v[28:31], a[184:187], a[144:147], v[28:31]
    s_lshl_b32 s49, s49, 6
    ds_read_b64_tr_b16 a[230:231], v24 offset:8704
    s_and_b32 s50, s46, 1
    v_mfma_f32_16x16x32_bf16 v[32:35], a[184:187], a[148:151], v[32:35]
    s_lshl2_add_u32 s50, s50, s44
    s_add_u32 s49, s49, s50
    s_lshl_b32 s49, s49, 2
    v_mfma_f32_16x16x32_bf16 v[36:39], a[184:187], a[152:155], v[36:39]
    s_add_u32 m0, s3, 24576
    ds_read_b64_tr_b16 a[208:209], v23 offset:0
    s_add_u32 s49, s49, 12582940
    v_mfma_f32_16x16x32_bf16 v[40:43], a[184:187], a[156:159], v[40:43]
    buffer_load_dwordx4 v253, s[8:11], s73 offen offset:0 lds
    v_mfma_f32_16x16x32_bf16 v[44:47], a[184:187], a[160:163], v[44:47]
    ds_read_b64_tr_b16 a[210:211], v23 offset:512
    v_min_u32 v0, 1, v1
    v_mfma_f32_16x16x32_bf16 v[48:51], a[188:191], a[144:147], v[48:51]
    v_mul_u32_u24 v0, 0x7ff000, v0
    v_lshl_add_u32 v0, v0, 8, s49
    v_mfma_f32_16x16x32_bf16 v[52:55], a[188:191], a[148:151], v[52:55]
    ds_read_b64_tr_b16 a[212:213], v24 offset:0
    v_lshlrev_b32 v255, 2, v255
    v_mfma_f32_16x16x32_bf16 v[56:59], a[188:191], a[152:155], v[56:59]
    ds_read_b64_tr_b16 a[214:215], v24 offset:512
    v_sub_u32 v233, v233, v255
    v_mfma_f32_16x16x32_bf16 v[60:63], a[188:191], a[156:159], v[60:63]
    buffer_load_dwordx4 v254, s[8:11], s73 offen offset:1024 lds
    v_mfma_f32_16x16x32_bf16 v[64:67], a[188:191], a[160:163], v[64:67]
    v_mov_b32 v14, 0xf149f2ca
    v_mfma_f32_16x16x32_bf16 v[148:151], a[144:147], a[144:147], v[148:151]
    s_cmp_eq_u32 s45, 0
    s_cselect_b32 s49, 0xf149f2ca, 0
    v_subrev_u32 v255, 0, v233
    v_mfma_f32_16x16x32_bf16 v[152:155], a[148:151], a[148:151], v[152:155]
    v_cmp_gt_u32 vcc, 8, v255
    v_add_u32 v255, 16, v255
    v_mfma_f32_16x16x32_bf16 v[156:159], a[152:155], a[152:155], v[156:159]
    v_cndmask_b32 v234, v14, 0, vcc
    v_cmp_gt_u32 vcc, 8, v255
    v_mfma_f32_16x16x32_bf16 v[160:163], a[156:159], a[156:159], v[160:163]
    s_nop 0
    v_cndmask_b32 v238, v14, 0, vcc
    v_min_f32 v242, s49, v238
    v_mfma_f32_16x16x32_bf16 v[164:167], a[160:163], a[160:163], v[164:167]
    s_waitcnt vmcnt(11) lgkmcnt(0)
    s_barrier
    v_subrev_u32 v255, 1, v233
    v_mfma_f32_16x16x32_bf16 v[68:71], a[216:219], a[164:167], v[68:71]
    s_mov_b32 m0, s96
    ds_read_b64_tr_b16 a[192:193], v21 offset:16384
    v_cmp_gt_u32 vcc, 8, v255
    v_mfma_f32_16x16x32_bf16 v[72:75], a[216:219], a[168:171], v[72:75]
    buffer_load_dwordx4 v248, s[4:7], s70 offen offset:0 lds
    v_mfma_f32_16x16x32_bf16 v[76:79], a[216:219], a[172:175], v[76:79]
    ds_read_b64_tr_b16 a[194:195], v21 offset:16896
    buffer_load_dword v13, off, s[36:39], 0 sc1
    v_mfma_f32_16x16x32_bf16 v[80:83], a[216:219], a[176:179], v[80:83]
    ds_read_b128 a[144:147], v19 offset:12288
    v_add_u32 v255, 16, v255
    v_mfma_f32_16x16x32_bf16 v[84:87], a[216:219], a[180:183], v[84:87]
    ds_read_b128 a[148:151], v19 offset:14336
    v_cndmask_b32 v235, v14, 0, vcc
    v_mfma_f32_16x16x32_bf16 v[88:91], a[220:223], a[164:167], v[88:91]
    s_mul_i32 s73, s70, 1344
    ds_read_b128 a[152:155], v19 offset:16384
    v_cmp_gt_u32 vcc, 8, v255
    v_mfma_f32_16x16x32_bf16 v[92:95], a[220:223], a[168:171], v[92:95]
    buffer_load_dwordx4 v249, s[4:7], s70 offen offset:1024 lds
    v_mfma_f32_16x16x32_bf16 v[96:99], a[220:223], a[172:175], v[96:99]
    v_cndmask_b32 v239, v14, 0, vcc
    v_min_f32 v243, s49, v239
    v_mfma_f32_16x16x32_bf16 v[100:103], a[220:223], a[176:179], v[100:103]
    ds_read_b128 a[156:159], v19 offset:18432
    v_subrev_u32 v255, 2, v233
    v_mfma_f32_16x16x32_bf16 v[104:107], a[220:223], a[180:183], v[104:107]
    ds_read_b128 a[160:163], v19 offset:20480
    v_cmp_gt_u32 vcc, 8, v255
    v_mfma_f32_16x16x32_bf16 v[108:111], a[164:167], a[224:227], v[108:111]
    ds_read_b64_tr_b16 a[196:197], v25 offset:16384
    v_add_u32 v255, 16, v255
    v_mfma_f32_16x16x32_bf16 v[112:115], a[168:171], a[224:227], v[112:115]
    s_add_u32 s74, s73, 896
    ds_read_b64_tr_b16 a[198:199], v25 offset:16896
    v_cndmask_b32 v236, v14, 0, vcc
    v_mfma_f32_16x16x32_bf16 v[116:119], a[172:175], a[224:227], v[116:119]
    buffer_load_dwordx4 v250, s[4:7], s70 offen offset:2048 lds
    v_mfma_f32_16x16x32_bf16 v[120:123], a[176:179], a[224:227], v[120:123]
    v_cmp_gt_u32 vcc, 8, v255
    s_nop 1
    v_cndmask_b32 v240, v14, 0, vcc
    v_mfma_f32_16x16x32_bf16 v[124:127], a[180:183], a[224:227], v[124:127]
    ds_read_b64_tr_b16 a[200:201], v21 offset:20480
    v_min_f32 v244, s49, v240
    v_mfma_f32_16x16x32_bf16 v[128:131], a[164:167], a[228:231], v[128:131]
    ds_read_b64_tr_b16 a[202:203], v21 offset:20992
    v_subrev_u32 v255, 3, v233
    v_mfma_f32_16x16x32_bf16 v[132:135], a[168:171], a[228:231], v[132:135]
    s_add_u32 s75, s73, 1792
    ds_read_b64_tr_b16 a[204:205], v22 offset:20480
    v_cmp_gt_u32 vcc, 8, v255
    v_mfma_f32_16x16x32_bf16 v[136:139], a[172:175], a[228:231], v[136:139]
    buffer_load_dwordx4 v251, s[4:7], s70 offen offset:3072 lds
    v_mfma_f32_16x16x32_bf16 v[140:143], a[176:179], a[228:231], v[140:143]
    ds_read_b64_tr_b16 a[206:207], v22 offset:20992
    v_add_u32 v255, 16, v255
    v_mfma_f32_16x16x32_bf16 v[144:147], a[180:183], a[228:231], v[144:147]
    v_cndmask_b32 v237, v14, 0, vcc
    v_cmp_gt_u32 vcc, 8, v255
    v_mfma_f32_16x16x32_bf16 v[28:31], a[208:211], a[164:167], v[28:31]
    ds_read_b64_tr_b16 a[184:185], v21 offset:12288
    v_cndmask_b32 v241, v14, 0, vcc
    v_mfma_f32_16x16x32_bf16 v[32:35], a[208:211], a[168:171], v[32:35]
    ds_read_b64_tr_b16 a[186:187], v21 offset:12800
    v_min_f32 v245, s49, v241
    v_mfma_f32_16x16x32_bf16 v[36:39], a[208:211], a[172:175], v[36:39]
    s_mov_b32 m0, s97
    ds_read_b64_tr_b16 a[188:189], v22 offset:12288
    v_mfma_f32_16x16x32_bf16 v[40:43], a[208:211], a[176:179], v[40:43]
    s_mov_b64 exec, s[98:99]
    buffer_load_dwordx4 v252, s[4:7], s70 offen lds
    s_mov_b64 exec, -1
    v_mfma_f32_16x16x32_bf16 v[44:47], a[208:211], a[180:183], v[44:47]
    ds_read_b64_tr_b16 a[190:191], v22 offset:12800
    v_mfma_f32_16x16x32_bf16 v[48:51], a[212:215], a[164:167], v[48:51]
    v_mfma_f32_16x16x32_bf16 v[52:55], a[212:215], a[168:171], v[52:55]
    v_mfma_f32_16x16x32_bf16 v[56:59], a[212:215], a[172:175], v[56:59]
    v_mfma_f32_16x16x32_bf16 v[60:63], a[212:215], a[176:179], v[60:63]
    v_mfma_f32_16x16x32_bf16 v[64:67], a[212:215], a[180:183], v[64:67]
    s_waitcnt lgkmcnt(0)
    v_mfma_f32_16x16x32_bf16 v[68:71], a[192:195], a[144:147], v[68:71]
    s_add_u32 m0, s3, 4096
    ds_read_b64_tr_b16 a[216:217], v23 offset:16384
    v_mfma_f32_16x16x32_bf16 v[72:75], a[192:195], a[148:151], v[72:75]
    buffer_load_dwordx4 v253, s[8:11], s74 offen offset:0 lds
    v_mfma_f32_16x16x32_bf16 v[76:79], a[192:195], a[152:155], v[76:79]
    ds_read_b64_tr_b16 a[218:219], v23 offset:16896
    v_mfma_f32_16x16x32_bf16 v[80:83], a[192:195], a[156:159], v[80:83]
    ds_read_b128 a[164:167], v20 offset:12288
    v_mfma_f32_16x16x32_bf16 v[84:87], a[192:195], a[160:163], v[84:87]
    v_mfma_f32_16x16x32_bf16 v[88:91], a[196:199], a[144:147], v[88:91]
    ds_read_b128 a[168:171], v20 offset:14336
    v_mfma_f32_16x16x32_bf16 v[92:95], a[196:199], a[148:151], v[92:95]
    buffer_load_dwordx4 v254, s[8:11], s74 offen offset:1024 lds
    v_mfma_f32_16x16x32_bf16 v[96:99], a[196:199], a[152:155], v[96:99]
    ds_read_b128 a[172:175], v20 offset:16384
    v_mfma_f32_16x16x32_bf16 v[100:103], a[196:199], a[156:159], v[100:103]
    v_mfma_f32_16x16x32_bf16 v[104:107], a[196:199], a[160:163], v[104:107]
    ds_read_b128 a[176:179], v20 offset:18432
    v_mfma_f32_16x16x32_bf16 v[108:111], a[144:147], a[200:203], v[108:111]
    ds_read_b128 a[180:183], v20 offset:20480
    v_mfma_f32_16x16x32_bf16 v[112:115], a[148:151], a[200:203], v[112:115]
    s_add_u32 m0, s3, 8192
    ds_read_b64_tr_b16 a[220:221], v26 offset:16384
    v_mfma_f32_16x16x32_bf16 v[116:119], a[152:155], a[200:203], v[116:119]
    buffer_load_dwordx4 v253, s[8:11], s75 offen offset:0 lds
    v_mfma_f32_16x16x32_bf16 v[120:123], a[156:159], a[200:203], v[120:123]
    v_mfma_f32_16x16x32_bf16 v[124:127], a[160:163], a[200:203], v[124:127]
    ds_read_b64_tr_b16 a[222:223], v26 offset:16896
    v_mfma_f32_16x16x32_bf16 v[128:131], a[144:147], a[204:207], v[128:131]
    ds_read_b64_tr_b16 a[224:225], v23 offset:20480
    v_mfma_f32_16x16x32_bf16 v[132:135], a[148:151], a[204:207], v[132:135]
    v_mfma_f32_16x16x32_bf16 v[136:139], a[152:155], a[204:207], v[136:139]
    buffer_load_dwordx4 v254, s[8:11], s75 offen offset:1024 lds
    v_mfma_f32_16x16x32_bf16 v[140:143], a[156:159], a[204:207], v[140:143]
    ds_read_b64_tr_b16 a[226:227], v23 offset:20992
    v_mfma_f32_16x16x32_bf16 v[144:147], a[160:163], a[204:207], v[144:147]
    ds_read_b64_tr_b16 a[228:229], v24 offset:20480
    v_mfma_f32_16x16x32_bf16 v[28:31], a[184:187], a[144:147], v[28:31]
    ds_read_b64_tr_b16 a[230:231], v24 offset:20992
    v_mfma_f32_16x16x32_bf16 v[32:35], a[184:187], a[148:151], v[32:35]
    v_mfma_f32_16x16x32_bf16 v[36:39], a[184:187], a[152:155], v[36:39]
    s_mov_b32 m0, s3
    ds_read_b64_tr_b16 a[208:209], v23 offset:12288
    v_mfma_f32_16x16x32_bf16 v[40:43], a[184:187], a[156:159], v[40:43]
    buffer_load_dwordx4 v253, s[8:11], s73 offen offset:0 lds
    v_mfma_f32_16x16x32_bf16 v[44:47], a[184:187], a[160:163], v[44:47]
    ds_read_b64_tr_b16 a[210:211], v23 offset:12800
    v_mfma_f32_16x16x32_bf16 v[48:51], a[188:191], a[144:147], v[48:51]
    v_mfma_f32_16x16x32_bf16 v[52:55], a[188:191], a[148:151], v[52:55]
    ds_read_b64_tr_b16 a[212:213], v24 offset:12288
    v_mfma_f32_16x16x32_bf16 v[56:59], a[188:191], a[152:155], v[56:59]
    ds_read_b64_tr_b16 a[214:215], v24 offset:12800
    v_mfma_f32_16x16x32_bf16 v[60:63], a[188:191], a[156:159], v[60:63]
    buffer_load_dwordx4 v254, s[8:11], s73 offen offset:1024 lds
    v_mfma_f32_16x16x32_bf16 v[64:67], a[188:191], a[160:163], v[64:67]
    v_mfma_f32_16x16x32_bf16 v[148:151], a[144:147], a[144:147], v[148:151]
    v_mfma_f32_16x16x32_bf16 v[152:155], a[148:151], a[148:151], v[152:155]
    v_mfma_f32_16x16x32_bf16 v[156:159], a[152:155], a[152:155], v[156:159]
    v_mfma_f32_16x16x32_bf16 v[160:163], a[156:159], a[156:159], v[160:163]
    v_mfma_f32_16x16x32_bf16 v[164:167], a[160:163], a[160:163], v[164:167]
    s_waitcnt vmcnt(12) lgkmcnt(0)
    s_barrier
    v_mfma_f32_16x16x32_bf16 v[68:71], a[216:219], a[164:167], v[68:71]
    s_add_u32 m0, s96, 12288
    ds_read_b64_tr_b16 a[192:193], v21 offset:28672
    v_mfma_f32_16x16x32_bf16 v[72:75], a[216:219], a[168:171], v[72:75]
    s_lshl_b32 s51, s47, 6
    buffer_load_dwordx4 v248, s[4:7], s71 offen offset:0 lds
    v_mfma_f32_16x16x32_bf16 v[76:79], a[216:219], a[172:175], v[76:79]
    s_and_b32 s52, s44, 1
    ds_read_b64_tr_b16 a[194:195], v21 offset:29184
    s_add_u32 s51, s51, s52
    v_mfma_f32_16x16x32_bf16 v[80:83], a[216:219], a[176:179], v[80:83]
    s_mul_i32 s51, s51, 896
    ds_read_b128 a[144:147], v19 offset:24576
    v_and_b32 v208, 31, v1
    v_mfma_f32_16x16x32_bf16 v[84:87], a[216:219], a[180:183], v[84:87]
    ds_read_b128 a[148:151], v19 offset:26624
    v_mul_u32_u24 v208, 1792, v208
    v_mfma_f32_16x16x32_bf16 v[88:91], a[220:223], a[164:167], v[88:91]
    s_mul_i32 s73, s71, 1344
    ds_read_b128 a[152:155], v19 offset:28672
    v_add_u32 v208, s51, v208
    v_mfma_f32_16x16x32_bf16 v[92:95], a[220:223], a[168:171], v[92:95]
    s_lshr_b32 s51, s44, 1
    buffer_load_dwordx4 v249, s[4:7], s71 offen offset:1024 lds
    v_mfma_f32_16x16x32_bf16 v[96:99], a[220:223], a[172:175], v[96:99]
    s_lshl_b32 s51, s51, 6
    s_lshl_b32 s52, s48, 7
    s_add_u32 s51, s51, s52
    v_mfma_f32_16x16x32_bf16 v[100:103], a[220:223], a[176:179], v[100:103]
    ds_read_b128 a[156:159], v19 offset:30720
    v_lshrrev_b32 v209, 5, v1
    v_mfma_f32_16x16x32_bf16 v[104:107], a[220:223], a[180:183], v[104:107]
    ds_read_b128 a[160:163], v19 offset:32768
    v_lshl_add_u32 v209, v209, 4, s51
    v_mfma_f32_16x16x32_bf16 v[108:111], a[164:167], a[224:227], v[108:111]
    ds_read_b64_tr_b16 a[196:197], v25 offset:28672
    v_add_u32 v208, v208, v209
    v_mfma_f32_16x16x32_bf16 v[112:115], a[168:171], a[224:227], v[112:115]
    s_add_u32 s74, s73, 896
    ds_read_b64_tr_b16 a[198:199], v25 offset:29184
    v_mfma_f32_16x16x32_bf16 v[116:119], a[172:175], a[224:227], v[116:119]
    buffer_load_dwordx4 v250, s[4:7], s71 offen offset:2048 lds
    v_mfma_f32_16x16x32_bf16 v[120:123], a[176:179], a[224:227], v[120:123]
    buffer_load_dwordx4 a[240:243], v208, s[4:7], 0 offen
    v_mfma_f32_16x16x32_bf16 v[124:127], a[180:183], a[224:227], v[124:127]
    ds_read_b64_tr_b16 a[200:201], v21 offset:32768
    v_mfma_f32_16x16x32_bf16 v[128:131], a[164:167], a[228:231], v[128:131]
    ds_read_b64_tr_b16 a[202:203], v21 offset:33280
    v_mfma_f32_16x16x32_bf16 v[132:135], a[168:171], a[228:231], v[132:135]
    s_add_u32 s75, s73, 1792
    ds_read_b64_tr_b16 a[204:205], v22 offset:32768
    v_mfma_f32_16x16x32_bf16 v[136:139], a[172:175], a[228:231], v[136:139]
    buffer_load_dwordx4 v251, s[4:7], s71 offen offset:3072 lds
    v_mfma_f32_16x16x32_bf16 v[140:143], a[176:179], a[228:231], v[140:143]
    ds_read_b64_tr_b16 a[206:207], v22 offset:33280
    v_mfma_f32_16x16x32_bf16 v[144:147], a[180:183], a[228:231], v[144:147]
    buffer_load_dwordx4 a[244:247], v208, s[4:7], 0 offen offset:32
    v_mfma_f32_16x16x32_bf16 v[28:31], a[208:211], a[164:167], v[28:31]
    ds_read_b64_tr_b16 a[184:185], v21 offset:24576
    v_mfma_f32_16x16x32_bf16 v[32:35], a[208:211], a[168:171], v[32:35]
    ds_read_b64_tr_b16 a[186:187], v21 offset:25088
    v_mfma_f32_16x16x32_bf16 v[36:39], a[208:211], a[172:175], v[36:39]
    s_add_u32 m0, s97, 12288
    ds_read_b64_tr_b16 a[188:189], v22 offset:24576
    v_mfma_f32_16x16x32_bf16 v[40:43], a[208:211], a[176:179], v[40:43]
    s_mov_b64 exec, s[98:99]
    buffer_load_dwordx4 v252, s[4:7], s71 offen lds
    s_mov_b64 exec, -1
    v_mfma_f32_16x16x32_bf16 v[44:47], a[208:211], a[180:183], v[44:47]
    ds_read_b64_tr_b16 a[190:191], v22 offset:25088
    v_mfma_f32_16x16x32_bf16 v[48:51], a[212:215], a[164:167], v[48:51]
    buffer_load_dwordx4 a[248:251], v209, s[32:35], 0 offen
    v_mfma_f32_16x16x32_bf16 v[52:55], a[212:215], a[168:171], v[52:55]
    buffer_load_dwordx4 a[252:255], v209, s[32:35], 0 offen offset:32
    v_mfma_f32_16x16x32_bf16 v[56:59], a[212:215], a[172:175], v[56:59]
    v_mfma_f32_16x16x32_bf16 v[60:63], a[212:215], a[176:179], v[60:63]
    v_mfma_f32_16x16x32_bf16 v[64:67], a[212:215], a[180:183], v[64:67]
    s_waitcnt lgkmcnt(0)
    v_mfma_f32_16x16x32_bf16 v[68:71], a[192:195], a[144:147], v[68:71]
    s_add_u32 m0, s3, 16384
    ds_read_b64_tr_b16 a[216:217], v23 offset:28672
    v_mfma_f32_16x16x32_bf16 v[72:75], a[192:195], a[148:151], v[72:75]
    buffer_load_dwordx4 v253, s[8:11], s74 offen offset:0 lds
    v_mfma_f32_16x16x32_bf16 v[76:79], a[192:195], a[152:155], v[76:79]
    ds_read_b64_tr_b16 a[218:219], v23 offset:29184
    v_mfma_f32_16x16x32_bf16 v[80:83], a[192:195], a[156:159], v[80:83]
    ds_read_b128 a[164:167], v20 offset:24576
    v_mfma_f32_16x16x32_bf16 v[84:87], a[192:195], a[160:163], v[84:87]
    v_mfma_f32_16x16x32_bf16 v[88:91], a[196:199], a[144:147], v[88:91]
    ds_read_b128 a[168:171], v20 offset:26624
    v_mfma_f32_16x16x32_bf16 v[92:95], a[196:199], a[148:151], v[92:95]
    buffer_load_dwordx4 v254, s[8:11], s74 offen offset:1024 lds
    v_mfma_f32_16x16x32_bf16 v[96:99], a[196:199], a[152:155], v[96:99]
    ds_read_b128 a[172:175], v20 offset:28672
    v_mfma_f32_16x16x32_bf16 v[100:103], a[196:199], a[156:159], v[100:103]
    v_mfma_f32_16x16x32_bf16 v[104:107], a[196:199], a[160:163], v[104:107]
    ds_read_b128 a[176:179], v20 offset:30720
    v_mfma_f32_16x16x32_bf16 v[108:111], a[144:147], a[200:203], v[108:111]
    ds_read_b128 a[180:183], v20 offset:32768
    v_mfma_f32_16x16x32_bf16 v[112:115], a[148:151], a[200:203], v[112:115]
    s_add_u32 m0, s3, 20480
    ds_read_b64_tr_b16 a[220:221], v26 offset:28672
    v_mfma_f32_16x16x32_bf16 v[116:119], a[152:155], a[200:203], v[116:119]
    buffer_load_dwordx4 v253, s[8:11], s75 offen offset:0 lds
    v_mfma_f32_16x16x32_bf16 v[120:123], a[156:159], a[200:203], v[120:123]
    v_mfma_f32_16x16x32_bf16 v[124:127], a[160:163], a[200:203], v[124:127]
    ds_read_b64_tr_b16 a[222:223], v26 offset:29184
    v_mfma_f32_16x16x32_bf16 v[128:131], a[144:147], a[204:207], v[128:131]
    ds_read_b64_tr_b16 a[224:225], v23 offset:32768
    v_mfma_f32_16x16x32_bf16 v[132:135], a[148:151], a[204:207], v[132:135]
    v_mfma_f32_16x16x32_bf16 v[136:139], a[152:155], a[204:207], v[136:139]
    buffer_load_dwordx4 v254, s[8:11], s75 offen offset:1024 lds
    v_mfma_f32_16x16x32_bf16 v[140:143], a[156:159], a[204:207], v[140:143]
    ds_read_b64_tr_b16 a[226:227], v23 offset:33280
    v_mfma_f32_16x16x32_bf16 v[144:147], a[160:163], a[204:207], v[144:147]
    ds_read_b64_tr_b16 a[228:229], v24 offset:32768
    v_mfma_f32_16x16x32_bf16 v[28:31], a[184:187], a[144:147], v[28:31]
    ds_read_b64_tr_b16 a[230:231], v24 offset:33280
    v_mfma_f32_16x16x32_bf16 v[32:35], a[184:187], a[148:151], v[32:35]
    v_mfma_f32_16x16x32_bf16 v[36:39], a[184:187], a[152:155], v[36:39]
    s_add_u32 m0, s3, 12288
    ds_read_b64_tr_b16 a[208:209], v23 offset:24576
    v_mfma_f32_16x16x32_bf16 v[40:43], a[184:187], a[156:159], v[40:43]
    buffer_load_dwordx4 v253, s[8:11], s73 offen offset:0 lds
    v_mfma_f32_16x16x32_bf16 v[44:47], a[184:187], a[160:163], v[44:47]
    ds_read_b64_tr_b16 a[210:211], v23 offset:25088
    v_mfma_f32_16x16x32_bf16 v[48:51], a[188:191], a[144:147], v[48:51]
    v_mfma_f32_16x16x32_bf16 v[52:55], a[188:191], a[148:151], v[52:55]
    ds_read_b64_tr_b16 a[212:213], v24 offset:24576
    v_mfma_f32_16x16x32_bf16 v[56:59], a[188:191], a[152:155], v[56:59]
    ds_read_b64_tr_b16 a[214:215], v24 offset:25088
    v_mfma_f32_16x16x32_bf16 v[60:63], a[188:191], a[156:159], v[60:63]
    buffer_load_dwordx4 v254, s[8:11], s73 offen offset:1024 lds
    v_mfma_f32_16x16x32_bf16 v[64:67], a[188:191], a[160:163], v[64:67]
    v_mfma_f32_16x16x32_bf16 v[148:151], a[144:147], a[144:147], v[148:151]
    v_mfma_f32_16x16x32_bf16 v[152:155], a[148:151], a[148:151], v[152:155]
    v_mfma_f32_16x16x32_bf16 v[156:159], a[152:155], a[152:155], v[156:159]
    v_mfma_f32_16x16x32_bf16 v[160:163], a[156:159], a[156:159], v[160:163]
    v_mfma_f32_16x16x32_bf16 v[164:167], a[160:163], a[160:163], v[164:167]
    s_waitcnt vmcnt(15) lgkmcnt(0)
    s_barrier
    v_mfma_f32_16x16x32_bf16 v[68:71], a[216:219], a[164:167], v[68:71]
    s_add_u32 m0, s96, 24576
    ds_read_b64_tr_b16 a[192:193], v21 offset:4096
    v_mfma_f32_16x16x32_bf16 v[72:75], a[216:219], a[168:171], v[72:75]
    buffer_load_dwordx4 v248, s[4:7], s72 offen offset:0 lds
    v_mfma_f32_16x16x32_bf16 v[76:79], a[216:219], a[172:175], v[76:79]
    ds_read_b64_tr_b16 a[194:195], v21 offset:4608
    v_mfma_f32_16x16x32_bf16 v[80:83], a[216:219], a[176:179], v[80:83]
    ds_read_b128 a[144:147], v19 offset:0
    v_mfma_f32_16x16x32_bf16 v[84:87], a[216:219], a[180:183], v[84:87]
    ds_read_b128 a[148:151], v19 offset:2048
    v_mfma_f32_16x16x32_bf16 v[88:91], a[220:223], a[164:167], v[88:91]
    s_mul_i32 s73, s72, 1344
    ds_read_b128 a[152:155], v19 offset:4096
    v_mfma_f32_16x16x32_bf16 v[92:95], a[220:223], a[168:171], v[92:95]
    buffer_load_dwordx4 v249, s[4:7], s72 offen offset:1024 lds
    v_mfma_f32_16x16x32_bf16 v[96:99], a[220:223], a[172:175], v[96:99]
    v_mfma_f32_16x16x32_bf16 v[100:103], a[220:223], a[176:179], v[100:103]
    ds_read_b128 a[156:159], v19 offset:6144
    v_mfma_f32_16x16x32_bf16 v[104:107], a[220:223], a[180:183], v[104:107]
    ds_read_b128 a[160:163], v19 offset:8192
    v_mfma_f32_16x16x32_bf16 v[108:111], a[164:167], a[224:227], v[108:111]
    ds_read_b64_tr_b16 a[196:197], v25 offset:4096
    v_mfma_f32_16x16x32_bf16 v[112:115], a[168:171], a[224:227], v[112:115]
    s_add_u32 s74, s73, 896
    ds_read_b64_tr_b16 a[198:199], v25 offset:4608
    v_mfma_f32_16x16x32_bf16 v[116:119], a[172:175], a[224:227], v[116:119]
    buffer_load_dwordx4 v250, s[4:7], s72 offen offset:2048 lds
    v_mfma_f32_16x16x32_bf16 v[120:123], a[176:179], a[224:227], v[120:123]
    v_mfma_f32_16x16x32_bf16 v[124:127], a[180:183], a[224:227], v[124:127]
    ds_read_b64_tr_b16 a[200:201], v21 offset:8192
    v_mfma_f32_16x16x32_bf16 v[128:131], a[164:167], a[228:231], v[128:131]
    ds_read_b64_tr_b16 a[202:203], v21 offset:8704
    v_mfma_f32_16x16x32_bf16 v[132:135], a[168:171], a[228:231], v[132:135]
    s_add_u32 s75, s73, 1792
    ds_read_b64_tr_b16 a[204:205], v22 offset:8192
    v_mfma_f32_16x16x32_bf16 v[136:139], a[172:175], a[228:231], v[136:139]
    buffer_load_dwordx4 v251, s[4:7], s72 offen offset:3072 lds
    v_mfma_f32_16x16x32_bf16 v[140:143], a[176:179], a[228:231], v[140:143]
    ds_read_b64_tr_b16 a[206:207], v22 offset:8704
    v_mfma_f32_16x16x32_bf16 v[144:147], a[180:183], a[228:231], v[144:147]
    v_mfma_f32_16x16x32_bf16 v[28:31], a[208:211], a[164:167], v[28:31]
    ds_read_b64_tr_b16 a[184:185], v21 offset:0
    v_mfma_f32_16x16x32_bf16 v[32:35], a[208:211], a[168:171], v[32:35]
    ds_read_b64_tr_b16 a[186:187], v21 offset:512
    v_mfma_f32_16x16x32_bf16 v[36:39], a[208:211], a[172:175], v[36:39]
    s_add_u32 m0, s97, 24576
    ds_read_b64_tr_b16 a[188:189], v22 offset:0
    v_mfma_f32_16x16x32_bf16 v[40:43], a[208:211], a[176:179], v[40:43]
    s_mov_b64 exec, s[98:99]
    buffer_load_dwordx4 v252, s[4:7], s72 offen lds
    s_mov_b64 exec, -1
    v_mfma_f32_16x16x32_bf16 v[44:47], a[208:211], a[180:183], v[44:47]
    ds_read_b64_tr_b16 a[190:191], v22 offset:512
    v_mfma_f32_16x16x32_bf16 v[48:51], a[212:215], a[164:167], v[48:51]
    v_mfma_f32_16x16x32_bf16 v[52:55], a[212:215], a[168:171], v[52:55]
    v_mfma_f32_16x16x32_bf16 v[56:59], a[212:215], a[172:175], v[56:59]
    v_mfma_f32_16x16x32_bf16 v[60:63], a[212:215], a[176:179], v[60:63]
    v_mfma_f32_16x16x32_bf16 v[64:67], a[212:215], a[180:183], v[64:67]
    s_waitcnt lgkmcnt(0)
    v_mfma_f32_16x16x32_bf16 v[68:71], a[192:195], a[144:147], v[68:71]
    s_add_u32 m0, s3, 28672
    ds_read_b64_tr_b16 a[216:217], v23 offset:4096
    v_mfma_f32_16x16x32_bf16 v[72:75], a[192:195], a[148:151], v[72:75]
    buffer_load_dwordx4 v253, s[8:11], s74 offen offset:0 lds
    v_mfma_f32_16x16x32_bf16 v[76:79], a[192:195], a[152:155], v[76:79]
    ds_read_b64_tr_b16 a[218:219], v23 offset:4608
    v_mfma_f32_16x16x32_bf16 v[80:83], a[192:195], a[156:159], v[80:83]
    ds_read_b128 a[164:167], v20 offset:0
    v_mfma_f32_16x16x32_bf16 v[84:87], a[192:195], a[160:163], v[84:87]
    v_mfma_f32_16x16x32_bf16 v[88:91], a[196:199], a[144:147], v[88:91]
    ds_read_b128 a[168:171], v20 offset:2048
    v_mfma_f32_16x16x32_bf16 v[92:95], a[196:199], a[148:151], v[92:95]
    buffer_load_dwordx4 v254, s[8:11], s74 offen offset:1024 lds
    v_mfma_f32_16x16x32_bf16 v[96:99], a[196:199], a[152:155], v[96:99]
    ds_read_b128 a[172:175], v20 offset:4096
    v_mfma_f32_16x16x32_bf16 v[100:103], a[196:199], a[156:159], v[100:103]
    v_mfma_f32_16x16x32_bf16 v[104:107], a[196:199], a[160:163], v[104:107]
    ds_read_b128 a[176:179], v20 offset:6144
    v_mfma_f32_16x16x32_bf16 v[108:111], a[144:147], a[200:203], v[108:111]
    ds_read_b128 a[180:183], v20 offset:8192
    v_mfma_f32_16x16x32_bf16 v[112:115], a[148:151], a[200:203], v[112:115]
    s_add_u32 m0, s3, 32768
    ds_read_b64_tr_b16 a[220:221], v26 offset:4096
    v_mfma_f32_16x16x32_bf16 v[116:119], a[152:155], a[200:203], v[116:119]
    buffer_load_dwordx4 v253, s[8:11], s75 offen offset:0 lds
    v_mfma_f32_16x16x32_bf16 v[120:123], a[156:159], a[200:203], v[120:123]
    v_mfma_f32_16x16x32_bf16 v[124:127], a[160:163], a[200:203], v[124:127]
    ds_read_b64_tr_b16 a[222:223], v26 offset:4608
    v_mfma_f32_16x16x32_bf16 v[128:131], a[144:147], a[204:207], v[128:131]
    ds_read_b64_tr_b16 a[224:225], v23 offset:8192
    v_mfma_f32_16x16x32_bf16 v[132:135], a[148:151], a[204:207], v[132:135]
    v_mfma_f32_16x16x32_bf16 v[136:139], a[152:155], a[204:207], v[136:139]
    buffer_load_dwordx4 v254, s[8:11], s75 offen offset:1024 lds
    v_mfma_f32_16x16x32_bf16 v[140:143], a[156:159], a[204:207], v[140:143]
    ds_read_b64_tr_b16 a[226:227], v23 offset:8704
    v_mfma_f32_16x16x32_bf16 v[144:147], a[160:163], a[204:207], v[144:147]
    ds_read_b64_tr_b16 a[228:229], v24 offset:8192
    v_mfma_f32_16x16x32_bf16 v[28:31], a[184:187], a[144:147], v[28:31]
    ds_read_b64_tr_b16 a[230:231], v24 offset:8704
    v_mfma_f32_16x16x32_bf16 v[32:35], a[184:187], a[148:151], v[32:35]
    v_mfma_f32_16x16x32_bf16 v[36:39], a[184:187], a[152:155], v[36:39]
    s_add_u32 m0, s3, 24576
    ds_read_b64_tr_b16 a[208:209], v23 offset:0
    v_mfma_f32_16x16x32_bf16 v[40:43], a[184:187], a[156:159], v[40:43]
    buffer_load_dwordx4 v253, s[8:11], s73 offen offset:0 lds
    v_mfma_f32_16x16x32_bf16 v[44:47], a[184:187], a[160:163], v[44:47]
    ds_read_b64_tr_b16 a[210:211], v23 offset:512
    v_mfma_f32_16x16x32_bf16 v[48:51], a[188:191], a[144:147], v[48:51]
    v_mfma_f32_16x16x32_bf16 v[52:55], a[188:191], a[148:151], v[52:55]
    ds_read_b64_tr_b16 a[212:213], v24 offset:0
    v_mfma_f32_16x16x32_bf16 v[56:59], a[188:191], a[152:155], v[56:59]
    ds_read_b64_tr_b16 a[214:215], v24 offset:512
    v_mfma_f32_16x16x32_bf16 v[60:63], a[188:191], a[156:159], v[60:63]
    buffer_load_dwordx4 v254, s[8:11], s73 offen offset:1024 lds
    v_mfma_f32_16x16x32_bf16 v[64:67], a[188:191], a[160:163], v[64:67]
    v_mfma_f32_16x16x32_bf16 v[148:151], a[144:147], a[144:147], v[148:151]
    v_mfma_f32_16x16x32_bf16 v[152:155], a[148:151], a[148:151], v[152:155]
    v_mfma_f32_16x16x32_bf16 v[156:159], a[152:155], a[152:155], v[156:159]
    v_mfma_f32_16x16x32_bf16 v[160:163], a[156:159], a[156:159], v[160:163]
    v_mfma_f32_16x16x32_bf16 v[164:167], a[160:163], a[160:163], v[164:167]
    s_waitcnt vmcnt(11) lgkmcnt(0)
    s_barrier
    v_mfma_f32_16x16x32_bf16 v[68:71], a[216:219], a[164:167], v[68:71]
    s_add_u32 m0, s78, 0
    s_mul_i32 s49, s53, 7
    ds_read_b64_tr_b16 a[192:193], v21 offset:16384
    v_mfma_f32_16x16x32_bf16 v[72:75], a[216:219], a[168:171], v[72:75]
    buffer_load_dwordx4 v2, s[12:15], s49 offen offset:0 lds
    v_mfma_f32_16x16x32_bf16 v[76:79], a[216:219], a[172:175], v[76:79]
    ds_read_b64_tr_b16 a[194:195], v21 offset:16896
    v_readfirstlane_b32 s76, v13
    s_nop 0
    s_cmp_eq_u32 s76, 0
    s_cbranch_scc1 Lnonq_s
Lnonq_k:
    v_mfma_f32_16x16x32_bf16 v[80:83], a[216:219], a[176:179], v[80:83]
    ds_read_b128 a[144:147], v19 offset:12288
    v_mfma_f32_16x16x32_bf16 v[84:87], a[216:219], a[180:183], v[84:87]
    s_and_b32 s42, s47, 1
    ds_read_b128 a[148:151], v19 offset:14336
    s_lshl3_add_u32 s43, s47, s48
    v_mfma_f32_16x16x32_bf16 v[88:91], a[220:223], a[164:167], v[88:91]
    s_sub_u32 s43, s43, s42
    buffer_load_dwordx4 v3, s[12:15], s49 offen offset:1024 lds
    v_mfma_f32_16x16x32_bf16 v[92:95], a[220:223], a[168:171], v[92:95]
    s_lshl2_add_u32 s43, s43, s44
    ds_read_b128 a[152:155], v19 offset:16384
    s_lshl_b32 s43, s43, 7
    v_mfma_f32_16x16x32_bf16 v[96:99], a[220:223], a[172:175], v[96:99]
    s_add_u32 s43, s43, 12615680
    ds_read_b128 a[156:159], v19 offset:18432
    s_mov_b32 s66, 0x22222222
    v_mfma_f32_16x16x32_bf16 v[100:103], a[220:223], a[176:179], v[100:103]
    s_mov_b32 s67, 0x22222222
    buffer_load_dword v15, off, s[20:23], s43
    v_mfma_f32_16x16x32_bf16 v[104:107], a[220:223], a[180:183], v[104:107]
    s_lshl_b64 s[68:69], s[66:67], 1
    ds_read_b128 a[160:163], v19 offset:20480
    s_lshl_b64 s[70:71], s[66:67], 2
    v_mfma_f32_16x16x32_bf16 v[108:111], a[164:167], a[224:227], v[108:111]
    s_mov_b32 s72, 0x00f0000f
    buffer_load_dwordx4 v4, s[12:15], s49 offen offset:2048 lds
    v_mfma_f32_16x16x32_bf16 v[112:115], a[168:171], a[224:227], v[112:115]
    s_mov_b32 s73, 0xf0000f00
    ds_read_b64_tr_b16 a[196:197], v25 offset:16384
    s_mov_b32 s3, 294912
    v_mfma_f32_16x16x32_bf16 v[116:119], a[172:175], a[224:227], v[116:119]
    ds_read_b64_tr_b16 a[198:199], v25 offset:16896
    v_mfma_f32_16x16x32_bf16 v[120:123], a[176:179], a[224:227], v[120:123]
    ds_read_b64_tr_b16 a[200:201], v21 offset:20480
    v_mfma_f32_16x16x32_bf16 v[124:127], a[180:183], a[224:227], v[124:127]
    ds_read_b64_tr_b16 a[202:203], v21 offset:20992
    v_mfma_f32_16x16x32_bf16 v[128:131], a[164:167], a[228:231], v[128:131]
    buffer_load_dwordx4 v5, s[12:15], s49 offen offset:3072 lds
    v_mfma_f32_16x16x32_bf16 v[132:135], a[168:171], a[228:231], v[132:135]
    ds_read_b64_tr_b16 a[204:205], v22 offset:20480
    v_mfma_f32_16x16x32_bf16 v[136:139], a[172:175], a[228:231], v[136:139]
    v_mfma_f32_16x16x32_bf16 v[140:143], a[176:179], a[228:231], v[140:143]
    s_add_u32 m0, s78, 4096
    s_mul_i32 s49, s54, 7
    ds_read_b64_tr_b16 a[206:207], v22 offset:20992
    v_mfma_f32_16x16x32_bf16 v[144:147], a[180:183], a[228:231], v[144:147]
    buffer_load_dwordx4 v2, s[12:15], s49 offen offset:0 lds
    v_mfma_f32_16x16x32_bf16 v[28:31], a[208:211], a[164:167], v[28:31]
    ds_read_b64_tr_b16 a[184:185], v21 offset:12288
    v_mfma_f32_16x16x32_bf16 v[32:35], a[208:211], a[168:171], v[32:35]
    ds_read_b64_tr_b16 a[186:187], v21 offset:12800
    v_mfma_f32_16x16x32_bf16 v[36:39], a[208:211], a[172:175], v[36:39]
    ds_read_b64_tr_b16 a[188:189], v22 offset:12288
    v_mfma_f32_16x16x32_bf16 v[40:43], a[208:211], a[176:179], v[40:43]
    ds_read_b64_tr_b16 a[190:191], v22 offset:12800
    v_mfma_f32_16x16x32_bf16 v[44:47], a[208:211], a[180:183], v[44:47]
    buffer_load_dwordx4 v3, s[12:15], s49 offen offset:1024 lds
    v_mfma_f32_16x16x32_bf16 v[48:51], a[212:215], a[164:167], v[48:51]
    v_mfma_f32_16x16x32_bf16 v[52:55], a[212:215], a[168:171], v[52:55]
    v_mfma_f32_16x16x32_bf16 v[56:59], a[212:215], a[172:175], v[56:59]
    v_mfma_f32_16x16x32_bf16 v[60:63], a[212:215], a[176:179], v[60:63]
    v_mfma_f32_16x16x32_bf16 v[64:67], a[212:215], a[180:183], v[64:67]
    s_waitcnt lgkmcnt(0)
    v_mfma_f32_16x16x32_bf16 v[68:71], a[192:195], a[144:147], v[68:71]
    ds_read_b64_tr_b16 a[216:217], v23 offset:16384
    v_mfma_f32_16x16x32_bf16 v[72:75], a[192:195], a[148:151], v[72:75]
    buffer_load_dwordx4 v4, s[12:15], s49 offen offset:2048 lds
    v_mfma_f32_16x16x32_bf16 v[76:79], a[192:195], a[152:155], v[76:79]
    ds_read_b64_tr_b16 a[218:219], v23 offset:16896
    v_mfma_f32_16x16x32_bf16 v[80:83], a[192:195], a[156:159], v[80:83]
    ds_read_b128 a[164:167], v20 offset:12288
    v_mfma_f32_16x16x32_bf16 v[84:87], a[192:195], a[160:163], v[84:87]
    v_mfma_f32_16x16x32_bf16 v[88:91], a[196:199], a[144:147], v[88:91]
    ds_read_b128 a[168:171], v20 offset:14336
    v_mfma_f32_16x16x32_bf16 v[92:95], a[196:199], a[148:151], v[92:95]
    buffer_load_dwordx4 v5, s[12:15], s49 offen offset:3072 lds
    v_mfma_f32_16x16x32_bf16 v[96:99], a[196:199], a[152:155], v[96:99]
    ds_read_b128 a[172:175], v20 offset:16384
    v_mfma_f32_16x16x32_bf16 v[100:103], a[196:199], a[156:159], v[100:103]
    v_mfma_f32_16x16x32_bf16 v[104:107], a[196:199], a[160:163], v[104:107]
    ds_read_b128 a[176:179], v20 offset:18432
    v_mfma_f32_16x16x32_bf16 v[108:111], a[144:147], a[200:203], v[108:111]
    ds_read_b128 a[180:183], v20 offset:20480
    v_mfma_f32_16x16x32_bf16 v[112:115], a[148:151], a[200:203], v[112:115]
    s_add_u32 m0, s78, 8192
    s_mul_i32 s49, s55, 7
    ds_read_b64_tr_b16 a[220:221], v26 offset:16384
    v_mfma_f32_16x16x32_bf16 v[116:119], a[152:155], a[200:203], v[116:119]
    buffer_load_dwordx4 v2, s[12:15], s49 offen offset:0 lds
    v_mfma_f32_16x16x32_bf16 v[120:123], a[156:159], a[200:203], v[120:123]
    v_mfma_f32_16x16x32_bf16 v[124:127], a[160:163], a[200:203], v[124:127]
    ds_read_b64_tr_b16 a[222:223], v26 offset:16896
    v_mfma_f32_16x16x32_bf16 v[128:131], a[144:147], a[204:207], v[128:131]
    ds_read_b64_tr_b16 a[224:225], v23 offset:20480
    v_mfma_f32_16x16x32_bf16 v[132:135], a[148:151], a[204:207], v[132:135]
    v_mfma_f32_16x16x32_bf16 v[136:139], a[152:155], a[204:207], v[136:139]
    buffer_load_dwordx4 v3, s[12:15], s49 offen offset:1024 lds
    v_mfma_f32_16x16x32_bf16 v[140:143], a[156:159], a[204:207], v[140:143]
    ds_read_b64_tr_b16 a[226:227], v23 offset:20992
    v_mfma_f32_16x16x32_bf16 v[144:147], a[160:163], a[204:207], v[144:147]
    ds_read_b64_tr_b16 a[228:229], v24 offset:20480
    v_mfma_f32_16x16x32_bf16 v[28:31], a[184:187], a[144:147], v[28:31]
    ds_read_b64_tr_b16 a[230:231], v24 offset:20992
    v_mfma_f32_16x16x32_bf16 v[32:35], a[184:187], a[148:151], v[32:35]
    v_mfma_f32_16x16x32_bf16 v[36:39], a[184:187], a[152:155], v[36:39]
    ds_read_b64_tr_b16 a[208:209], v23 offset:12288
    v_mfma_f32_16x16x32_bf16 v[40:43], a[184:187], a[156:159], v[40:43]
    buffer_load_dwordx4 v4, s[12:15], s49 offen offset:2048 lds
    v_mfma_f32_16x16x32_bf16 v[44:47], a[184:187], a[160:163], v[44:47]
    ds_read_b64_tr_b16 a[210:211], v23 offset:12800
    v_mfma_f32_16x16x32_bf16 v[48:51], a[188:191], a[144:147], v[48:51]
    v_mfma_f32_16x16x32_bf16 v[52:55], a[188:191], a[148:151], v[52:55]
    ds_read_b64_tr_b16 a[212:213], v24 offset:12288
    v_mfma_f32_16x16x32_bf16 v[56:59], a[188:191], a[152:155], v[56:59]
    ds_read_b64_tr_b16 a[214:215], v24 offset:12800
    v_mfma_f32_16x16x32_bf16 v[60:63], a[188:191], a[156:159], v[60:63]
    buffer_load_dwordx4 v5, s[12:15], s49 offen offset:3072 lds
    v_mfma_f32_16x16x32_bf16 v[64:67], a[188:191], a[160:163], v[64:67]
    v_mfma_f32_16x16x32_bf16 v[148:151], a[144:147], a[144:147], v[148:151]
    v_mfma_f32_16x16x32_bf16 v[152:155], a[148:151], a[148:151], v[152:155]
    v_mfma_f32_16x16x32_bf16 v[156:159], a[152:155], a[152:155], v[156:159]
    v_mfma_f32_16x16x32_bf16 v[160:163], a[156:159], a[156:159], v[160:163]
    v_mfma_f32_16x16x32_bf16 v[164:167], a[160:163], a[160:163], v[164:167]
    s_waitcnt vmcnt(13) lgkmcnt(0)
    s_barrier
    v_mfma_f32_16x16x32_bf16 v[68:71], a[216:219], a[164:167], v[68:71]
    s_add_u32 m0, s78, 12288
    s_mul_i32 s49, s56, 7
    ds_read_b64_tr_b16 a[192:193], v21 offset:28672
    v_mfma_f32_16x16x32_bf16 v[72:75], a[216:219], a[168:171], v[72:75]
    buffer_load_dwordx4 v2, s[12:15], s49 offen offset:0 lds
    v_mfma_f32_16x16x32_bf16 v[76:79], a[216:219], a[172:175], v[76:79]
    ds_read_b64_tr_b16 a[194:195], v21 offset:29184
    v_mfma_f32_16x16x32_bf16 v[80:83], a[216:219], a[176:179], v[80:83]
    ds_read_b128 a[144:147], v19 offset:24576
    v_mfma_f32_16x16x32_bf16 v[84:87], a[216:219], a[180:183], v[84:87]
    ds_read_b128 a[148:151], v19 offset:26624
    v_mfma_f32_16x16x32_bf16 v[88:91], a[220:223], a[164:167], v[88:91]
    buffer_load_dwordx4 v3, s[12:15], s49 offen offset:1024 lds
    v_mfma_f32_16x16x32_bf16 v[92:95], a[220:223], a[168:171], v[92:95]
    ds_read_b128 a[152:155], v19 offset:28672
    v_mfma_f32_16x16x32_bf16 v[96:99], a[220:223], a[172:175], v[96:99]
    ds_read_b128 a[156:159], v19 offset:30720
    v_mfma_f32_16x16x32_bf16 v[100:103], a[220:223], a[176:179], v[100:103]
    v_mfma_f32_16x16x32_bf16 v[104:107], a[220:223], a[180:183], v[104:107]
    ds_read_b128 a[160:163], v19 offset:32768
    v_mfma_f32_16x16x32_bf16 v[108:111], a[164:167], a[224:227], v[108:111]
    buffer_load_dwordx4 v4, s[12:15], s49 offen offset:2048 lds
    v_mfma_f32_16x16x32_bf16 v[112:115], a[168:171], a[224:227], v[112:115]
    ds_read_b64_tr_b16 a[196:197], v25 offset:28672
    v_mfma_f32_16x16x32_bf16 v[116:119], a[172:175], a[224:227], v[116:119]
    ds_read_b64_tr_b16 a[198:199], v25 offset:29184
    v_mfma_f32_16x16x32_bf16 v[120:123], a[176:179], a[224:227], v[120:123]
    ds_read_b64_tr_b16 a[200:201], v21 offset:32768
    v_mfma_f32_16x16x32_bf16 v[124:127], a[180:183], a[224:227], v[124:127]
    ds_read_b64_tr_b16 a[202:203], v21 offset:33280
    v_mfma_f32_16x16x32_bf16 v[128:131], a[164:167], a[228:231], v[128:131]
    buffer_load_dwordx4 v5, s[12:15], s49 offen offset:3072 lds
    v_mfma_f32_16x16x32_bf16 v[132:135], a[168:171], a[228:231], v[132:135]
    ds_read_b64_tr_b16 a[204:205], v22 offset:32768
    v_mfma_f32_16x16x32_bf16 v[136:139], a[172:175], a[228:231], v[136:139]
    v_mfma_f32_16x16x32_bf16 v[140:143], a[176:179], a[228:231], v[140:143]
    s_add_u32 m0, s78, 16384
    s_mul_i32 s49, s57, 7
    ds_read_b64_tr_b16 a[206:207], v22 offset:33280
    v_mfma_f32_16x16x32_bf16 v[144:147], a[180:183], a[228:231], v[144:147]
    buffer_load_dwordx4 v2, s[12:15], s49 offen offset:0 lds
    v_mfma_f32_16x16x32_bf16 v[28:31], a[208:211], a[164:167], v[28:31]
    ds_read_b64_tr_b16 a[184:185], v21 offset:24576
    v_mfma_f32_16x16x32_bf16 v[32:35], a[208:211], a[168:171], v[32:35]
    ds_read_b64_tr_b16 a[186:187], v21 offset:25088
    v_mfma_f32_16x16x32_bf16 v[36:39], a[208:211], a[172:175], v[36:39]
    ds_read_b64_tr_b16 a[188:189], v22 offset:24576
    v_mfma_f32_16x16x32_bf16 v[40:43], a[208:211], a[176:179], v[40:43]
    ds_read_b64_tr_b16 a[190:191], v22 offset:25088
    v_mfma_f32_16x16x32_bf16 v[44:47], a[208:211], a[180:183], v[44:47]
    buffer_load_dwordx4 v3, s[12:15], s49 offen offset:1024 lds
    v_mfma_f32_16x16x32_bf16 v[48:51], a[212:215], a[164:167], v[48:51]
    v_mfma_f32_16x16x32_bf16 v[52:55], a[212:215], a[168:171], v[52:55]
    v_mfma_f32_16x16x32_bf16 v[56:59], a[212:215], a[172:175], v[56:59]
    v_mfma_f32_16x16x32_bf16 v[60:63], a[212:215], a[176:179], v[60:63]
    v_mfma_f32_16x16x32_bf16 v[64:67], a[212:215], a[180:183], v[64:67]
    s_waitcnt lgkmcnt(0)
    v_mfma_f32_16x16x32_bf16 v[68:71], a[192:195], a[144:147], v[68:71]
    ds_read_b64_tr_b16 a[216:217], v23 offset:28672
    v_mfma_f32_16x16x32_bf16 v[72:75], a[192:195], a[148:151], v[72:75]
    buffer_load_dwordx4 v4, s[12:15], s49 offen offset:2048 lds
    v_mfma_f32_16x16x32_bf16 v[76:79], a[192:195], a[152:155], v[76:79]
    ds_read_b64_tr_b16 a[218:219], v23 offset:29184
    v_mfma_f32_16x16x32_bf16 v[80:83], a[192:195], a[156:159], v[80:83]
    ds_read_b128 a[164:167], v20 offset:24576
    v_mfma_f32_16x16x32_bf16 v[84:87], a[192:195], a[160:163], v[84:87]
    v_mfma_f32_16x16x32_bf16 v[88:91], a[196:199], a[144:147], v[88:91]
    ds_read_b128 a[168:171], v20 offset:26624
    v_mfma_f32_16x16x32_bf16 v[92:95], a[196:199], a[148:151], v[92:95]
    buffer_load_dwordx4 v5, s[12:15], s49 offen offset:3072 lds
    v_mfma_f32_16x16x32_bf16 v[96:99], a[196:199], a[152:155], v[96:99]
    ds_read_b128 a[172:175], v20 offset:28672
    v_mfma_f32_16x16x32_bf16 v[100:103], a[196:199], a[156:159], v[100:103]
    v_mfma_f32_16x16x32_bf16 v[104:107], a[196:199], a[160:163], v[104:107]
    ds_read_b128 a[176:179], v20 offset:30720
    v_mfma_f32_16x16x32_bf16 v[108:111], a[144:147], a[200:203], v[108:111]
    ds_read_b128 a[180:183], v20 offset:32768
    v_mfma_f32_16x16x32_bf16 v[112:115], a[148:151], a[200:203], v[112:115]
    s_add_u32 m0, s78, 20480
    s_mul_i32 s49, s58, 7
    ds_read_b64_tr_b16 a[220:221], v26 offset:28672
    v_mfma_f32_16x16x32_bf16 v[116:119], a[152:155], a[200:203], v[116:119]
    buffer_load_dwordx4 v2, s[12:15], s49 offen offset:0 lds
    v_mfma_f32_16x16x32_bf16 v[120:123], a[156:159], a[200:203], v[120:123]
    v_mfma_f32_16x16x32_bf16 v[124:127], a[160:163], a[200:203], v[124:127]
    ds_read_b64_tr_b16 a[222:223], v26 offset:29184
    v_mfma_f32_16x16x32_bf16 v[128:131], a[144:147], a[204:207], v[128:131]
    ds_read_b64_tr_b16 a[224:225], v23 offset:32768
    v_mfma_f32_16x16x32_bf16 v[132:135], a[148:151], a[204:207], v[132:135]
    v_mfma_f32_16x16x32_bf16 v[136:139], a[152:155], a[204:207], v[136:139]
    buffer_load_dwordx4 v3, s[12:15], s49 offen offset:1024 lds
    v_mfma_f32_16x16x32_bf16 v[140:143], a[156:159], a[204:207], v[140:143]
    ds_read_b64_tr_b16 a[226:227], v23 offset:33280
    v_mfma_f32_16x16x32_bf16 v[144:147], a[160:163], a[204:207], v[144:147]
    ds_read_b64_tr_b16 a[228:229], v24 offset:32768
    v_mfma_f32_16x16x32_bf16 v[28:31], a[184:187], a[144:147], v[28:31]
    ds_read_b64_tr_b16 a[230:231], v24 offset:33280
    v_mfma_f32_16x16x32_bf16 v[32:35], a[184:187], a[148:151], v[32:35]
    v_mfma_f32_16x16x32_bf16 v[36:39], a[184:187], a[152:155], v[36:39]
    ds_read_b64_tr_b16 a[208:209], v23 offset:24576
    v_mfma_f32_16x16x32_bf16 v[40:43], a[184:187], a[156:159], v[40:43]
    buffer_load_dwordx4 v4, s[12:15], s49 offen offset:2048 lds
    v_mfma_f32_16x16x32_bf16 v[44:47], a[184:187], a[160:163], v[44:47]
    ds_read_b64_tr_b16 a[210:211], v23 offset:25088
    v_mfma_f32_16x16x32_bf16 v[48:51], a[188:191], a[144:147], v[48:51]
    v_mfma_f32_16x16x32_bf16 v[52:55], a[188:191], a[148:151], v[52:55]
    ds_read_b64_tr_b16 a[212:213], v24 offset:24576
    v_mfma_f32_16x16x32_bf16 v[56:59], a[188:191], a[152:155], v[56:59]
    ds_read_b64_tr_b16 a[214:215], v24 offset:25088
    v_mfma_f32_16x16x32_bf16 v[60:63], a[188:191], a[156:159], v[60:63]
    buffer_load_dwordx4 v5, s[12:15], s49 offen offset:3072 lds
    v_mfma_f32_16x16x32_bf16 v[64:67], a[188:191], a[160:163], v[64:67]
    v_mfma_f32_16x16x32_bf16 v[148:151], a[144:147], a[144:147], v[148:151]
    v_mfma_f32_16x16x32_bf16 v[152:155], a[148:151], a[148:151], v[152:155]
    v_mfma_f32_16x16x32_bf16 v[156:159], a[152:155], a[152:155], v[156:159]
    v_mfma_f32_16x16x32_bf16 v[160:163], a[156:159], a[156:159], v[160:163]
    v_mfma_f32_16x16x32_bf16 v[164:167], a[160:163], a[160:163], v[164:167]
    s_waitcnt lgkmcnt(0)
    s_barrier
    v_mfma_f32_16x16x32_bf16 v[68:71], a[216:219], a[164:167], v[68:71]
    s_add_u32 m0, s78, 24576
    s_mul_i32 s49, s59, 7
    v_mfma_f32_16x16x32_bf16 v[72:75], a[216:219], a[168:171], v[72:75]
    buffer_load_dwordx4 v2, s[12:15], s49 offen offset:0 lds
    v_mfma_f32_16x16x32_bf16 v[76:79], a[216:219], a[172:175], v[76:79]
    v_mfma_f32_16x16x32_bf16 v[80:83], a[216:219], a[176:179], v[80:83]
    v_mfma_f32_16x16x32_bf16 v[84:87], a[216:219], a[180:183], v[84:87]
    buffer_load_dwordx4 v3, s[12:15], s49 offen offset:1024 lds
    v_mfma_f32_16x16x32_bf16 v[88:91], a[220:223], a[164:167], v[88:91]
    v_mfma_f32_16x16x32_bf16 v[92:95], a[220:223], a[168:171], v[92:95]
    v_mfma_f32_16x16x32_bf16 v[96:99], a[220:223], a[172:175], v[96:99]
    v_mfma_f32_16x16x32_bf16 v[100:103], a[220:223], a[176:179], v[100:103]
    buffer_load_dwordx4 v4, s[12:15], s49 offen offset:2048 lds
    v_mfma_f32_16x16x32_bf16 v[104:107], a[220:223], a[180:183], v[104:107]
    v_mfma_f32_16x16x32_bf16 v[108:111], a[164:167], a[224:227], v[108:111]
    v_mfma_f32_16x16x32_bf16 v[112:115], a[168:171], a[224:227], v[112:115]
    buffer_load_dwordx4 v5, s[12:15], s49 offen offset:3072 lds
    v_mfma_f32_16x16x32_bf16 v[116:119], a[172:175], a[224:227], v[116:119]
    v_mfma_f32_16x16x32_bf16 v[120:123], a[176:179], a[224:227], v[120:123]
    v_mfma_f32_16x16x32_bf16 v[124:127], a[180:183], a[224:227], v[124:127]
    s_add_u32 m0, s78, 28672
    s_mul_i32 s49, s62, 25088
    s_add_u32 s49, s49, s61
    v_mfma_f32_16x16x32_bf16 v[128:131], a[164:167], a[228:231], v[128:131]
    buffer_load_dwordx4 v2, s[16:19], s49 offen offset:0 lds
    v_mfma_f32_16x16x32_bf16 v[132:135], a[168:171], a[228:231], v[132:135]
    v_mfma_f32_16x16x32_bf16 v[136:139], a[172:175], a[228:231], v[136:139]
    v_mfma_f32_16x16x32_bf16 v[140:143], a[176:179], a[228:231], v[140:143]
    buffer_load_dwordx4 v3, s[16:19], s49 offen offset:1024 lds
    v_mfma_f32_16x16x32_bf16 v[144:147], a[180:183], a[228:231], v[144:147]
    v_mfma_f32_16x16x32_bf16 v[28:31], a[208:211], a[164:167], v[28:31]
    v_mfma_f32_16x16x32_bf16 v[32:35], a[208:211], a[168:171], v[32:35]
    v_mfma_f32_16x16x32_bf16 v[36:39], a[208:211], a[172:175], v[36:39]
    buffer_load_dwordx4 v4, s[16:19], s49 offen offset:2048 lds
    v_mfma_f32_16x16x32_bf16 v[40:43], a[208:211], a[176:179], v[40:43]
    v_mfma_f32_16x16x32_bf16 v[44:47], a[208:211], a[180:183], v[44:47]
    v_mfma_f32_16x16x32_bf16 v[48:51], a[212:215], a[164:167], v[48:51]
    buffer_load_dwordx4 v5, s[16:19], s49 offen offset:3072 lds
    v_mfma_f32_16x16x32_bf16 v[52:55], a[212:215], a[168:171], v[52:55]
    v_mfma_f32_16x16x32_bf16 v[56:59], a[212:215], a[172:175], v[56:59]
    v_mfma_f32_16x16x32_bf16 v[60:63], a[212:215], a[176:179], v[60:63]
    v_mfma_f32_16x16x32_bf16 v[64:67], a[212:215], a[180:183], v[64:67]
    v_cndmask_b32 v19, v148, v149, s[66:67]
    v_cndmask_b32 v20, v152, v153, s[66:67]
    v_cndmask_b32 v21, v156, v157, s[66:67]
    v_cndmask_b32 v22, v160, v161, s[66:67]
    v_cndmask_b32 v23, v164, v165, s[66:67]
    v_cndmask_b32 v19, v19, v150, s[68:69]
    v_cndmask_b32 v20, v20, v154, s[68:69]
    v_cndmask_b32 v21, v21, v158, s[68:69]
    v_cndmask_b32 v22, v22, v162, s[68:69]
    v_cndmask_b32 v23, v23, v166, s[68:69]
    v_cndmask_b32 v19, v19, v151, s[70:71]
    v_cndmask_b32 v20, v20, v155, s[70:71]
    v_cndmask_b32 v21, v21, v159, s[70:71]
    v_cndmask_b32 v22, v22, v163, s[70:71]
    v_cndmask_b32 v23, v23, v167, s[70:71]
    s_mov_b64 exec, s[72:73]
    v_mov_b32 v24, v19
    ds_write_b128 v16, v[20:23]
    ds_write_b32 v16, v24 offset:16
    s_mov_b32 exec_lo, 0
    s_mov_b32 exec_hi, 0xffff0000
    ds_write_b32 v16, v88 offset:48
    ds_write_b32 v16, v92 offset:32
    ds_write_b32 v16, v96 offset:36
    ds_write_b32 v16, v100 offset:40
    ds_write_b32 v16, v104 offset:44
    s_mov_b64 exec, -1
    s_add_u32 m0, s78, 32768
    s_mul_i32 s49, s63, 25088
    s_add_u32 s49, s49, s61
    buffer_load_dwordx4 v2, s[16:19], s49 offen offset:0 lds
    buffer_load_dwordx4 v3, s[16:19], s49 offen offset:1024 lds
    buffer_load_dwordx4 v4, s[16:19], s49 offen offset:2048 lds
    buffer_load_dwordx4 v5, s[16:19], s49 offen offset:3072 lds
    s_waitcnt lgkmcnt(0)
    s_barrier
    ds_read_b128 v[148:151], v16 offset:0
    ds_read_b32 v152, v16 offset:16
    ds_read_b128 v[154:157], v17 offset:0
    ds_read_b32 v158, v17 offset:16
    ds_read_b128 v[160:163], v16 offset:32
    ds_read_b32 v164, v16 offset:48
    s_mul_i32 s49, s64, 25088
    s_add_u32 s49, s49, s61
    buffer_load_dwordx4 a[0:3], v2, s[16:19], s49 offen offset:0
    buffer_load_dwordx4 a[4:7], v3, s[16:19], s49 offen offset:1024
    buffer_load_dwordx4 a[8:11], v4, s[16:19], s49 offen offset:2048
    buffer_load_dwordx4 a[12:15], v5, s[16:19], s49 offen offset:3072
    s_waitcnt lgkmcnt(2)
    v_add_f32 v152, v152, v158
    v_add_f32 v148, v148, v154
    v_add_f32 v149, v149, v155
    v_add_f32 v150, v150, v156
    v_add_f32 v151, v151, v157
    s_waitcnt lgkmcnt(0)
    v_mul_f32 v208, 0xbb124925, v164
    v_mul_f32 v209, 0xbb124925, v160
    v_mul_f32 v210, 0xbb124925, v161
    v_mul_f32 v211, 0xbb124925, v162
    v_mul_f32 v212, 0xbb124925, v163
    v_mul_f32 v152, 0x3b124925, v152
    v_mul_f32 v148, 0x3b124925, v148
    v_mul_f32 v149, 0x3b124925, v149
    v_mul_f32 v150, 0x3b124925, v150
    v_mul_f32 v151, 0x3b124925, v151
    v_fma_f32 v152, -v208, v208, v152
    v_fma_f32 v148, -v209, v209, v148
    v_fma_f32 v149, -v210, v210, v149
    v_fma_f32 v150, -v211, v211, v150
    v_fma_f32 v151, -v212, v212, v151
    v_max_f32 v152, 0, v152
    v_max_f32 v148, 0, v148
    v_max_f32 v149, 0, v149
    v_max_f32 v150, 0, v150
    v_max_f32 v151, 0, v151
    v_add_f32 v152, 0x3727c5ac, v152
    v_add_f32 v148, 0x3727c5ac, v148
    v_add_f32 v149, 0x3727c5ac, v149
    v_add_f32 v150, 0x3727c5ac, v150
    v_add_f32 v151, 0x3727c5ac, v151
    v_rsq_f32 v213, v152
    v_rsq_f32 v214, v148
    v_rsq_f32 v215, v149
    v_rsq_f32 v216, v150
    v_rsq_f32 v217, v151
    s_mov_b64 exec, 0xffff
    ds_write2_b32 v18, v208, v213 offset0:0 offset1:128
    ds_write2_b32 v18, v209, v214 offset0:16 offset1:144
    ds_write2_b32 v18, v210, v215 offset0:32 offset1:160
    ds_write2_b32 v18, v211, v216 offset0:48 offset1:176
    ds_write2_b32 v18, v212, v217 offset0:64 offset1:192
    s_mov_b64 exec, -1
    s_mul_i32 s49, s65, 25088
    s_add_u32 s49, s49, s61
    buffer_load_dwordx4 a[16:19], v2, s[16:19], s49 offen offset:0
    buffer_load_dwordx4 a[20:23], v3, s[16:19], s49 offen offset:1024
    s_waitcnt lgkmcnt(0)
    ds_read_b128 v[168:171], v246 offset:0
    ds_read_b128 v[172:175], v246 offset:64
    ds_read_b128 v[176:179], v246 offset:128
    ds_read_b128 v[180:183], v246 offset:192
    ds_read_b128 v[184:187], v246 offset:256
    ds_read_b128 v[188:191], v246 offset:512
    ds_read_b128 v[192:195], v246 offset:576
    ds_read_b128 v[196:199], v246 offset:640
    ds_read_b128 v[200:203], v246 offset:704
    ds_read_b128 v[204:207], v246 offset:768
    v_mul_f32 v218, 0x3e8b97f6, v214
    v_mul_f32 v219, 0x3e8b97f6, v215
    v_mul_f32 v220, 0x3e8b97f6, v216
    v_mul_f32 v221, 0x3e8b97f6, v217
    v_cmp_gt_u32 vcc, 48, v1
    v_fmac_f32_dpp v72, v68, v209 row_newbcast:0 row_mask:0xf bank_mask:0xf
    buffer_load_dwordx4 a[24:27], v4, s[16:19], s49 offen offset:2048
    v_fmac_f32_dpp v73, v69, v209 row_newbcast:0 row_mask:0xf bank_mask:0xf
    v_fmac_f32_dpp v74, v70, v209 row_newbcast:0 row_mask:0xf bank_mask:0xf
    v_fmac_f32_dpp v75, v71, v209 row_newbcast:0 row_mask:0xf bank_mask:0xf
    v_fmac_f32_dpp v92, v88, v209 row_newbcast:0 row_mask:0xf bank_mask:0xf
    v_fmac_f32_dpp v93, v89, v209 row_newbcast:0 row_mask:0xf bank_mask:0xf
    v_fmac_f32_dpp v94, v90, v209 row_newbcast:0 row_mask:0xf bank_mask:0xf
    v_fmac_f32_dpp v95, v91, v209 row_newbcast:0 row_mask:0xf bank_mask:0xf
    v_fmac_f32_dpp v76, v68, v210 row_newbcast:0 row_mask:0xf bank_mask:0xf
    v_fmac_f32_dpp v77, v69, v210 row_newbcast:0 row_mask:0xf bank_mask:0xf
    v_fmac_f32_dpp v78, v70, v210 row_newbcast:0 row_mask:0xf bank_mask:0xf
    v_fmac_f32_dpp v79, v71, v210 row_newbcast:0 row_mask:0xf bank_mask:0xf
    v_fmac_f32_dpp v96, v88, v210 row_newbcast:0 row_mask:0xf bank_mask:0xf
    v_fmac_f32_dpp v97, v89, v210 row_newbcast:0 row_mask:0xf bank_mask:0xf
    v_fmac_f32_dpp v98, v90, v210 row_newbcast:0 row_mask:0xf bank_mask:0xf
    v_fmac_f32_dpp v99, v91, v210 row_newbcast:0 row_mask:0xf bank_mask:0xf
    v_fmac_f32_dpp v80, v68, v211 row_newbcast:0 row_mask:0xf bank_mask:0xf
    v_fmac_f32_dpp v81, v69, v211 row_newbcast:0 row_mask:0xf bank_mask:0xf
    v_fmac_f32_dpp v82, v70, v211 row_newbcast:0 row_mask:0xf bank_mask:0xf
    buffer_load_dwordx4 a[28:31], v5, s[16:19], s49 offen offset:3072
    v_fmac_f32_dpp v83, v71, v211 row_newbcast:0 row_mask:0xf bank_mask:0xf
    v_fmac_f32_dpp v100, v88, v211 row_newbcast:0 row_mask:0xf bank_mask:0xf
    v_fmac_f32_dpp v101, v89, v211 row_newbcast:0 row_mask:0xf bank_mask:0xf
    v_fmac_f32_dpp v102, v90, v211 row_newbcast:0 row_mask:0xf bank_mask:0xf
    v_fmac_f32_dpp v103, v91, v211 row_newbcast:0 row_mask:0xf bank_mask:0xf
    v_fmac_f32_dpp v84, v68, v212 row_newbcast:0 row_mask:0xf bank_mask:0xf
    v_fmac_f32_dpp v85, v69, v212 row_newbcast:0 row_mask:0xf bank_mask:0xf
    v_fmac_f32_dpp v86, v70, v212 row_newbcast:0 row_mask:0xf bank_mask:0xf
    v_fmac_f32_dpp v87, v71, v212 row_newbcast:0 row_mask:0xf bank_mask:0xf
    v_fmac_f32_dpp v104, v88, v212 row_newbcast:0 row_mask:0xf bank_mask:0xf
    v_fmac_f32_dpp v105, v89, v212 row_newbcast:0 row_mask:0xf bank_mask:0xf
    v_fmac_f32_dpp v106, v90, v212 row_newbcast:0 row_mask:0xf bank_mask:0xf
    v_fmac_f32_dpp v107, v91, v212 row_newbcast:0 row_mask:0xf bank_mask:0xf
    v_fmac_f32_dpp v68, v68, v208 row_newbcast:0 row_mask:0xf bank_mask:0xf
    v_fmac_f32_dpp v69, v69, v208 row_newbcast:0 row_mask:0xf bank_mask:0xf
    v_fmac_f32_dpp v70, v70, v208 row_newbcast:0 row_mask:0xf bank_mask:0xf
    v_fmac_f32_dpp v71, v71, v208 row_newbcast:0 row_mask:0xf bank_mask:0xf
    v_fmac_f32_dpp v88, v88, v208 row_newbcast:0 row_mask:0xf bank_mask:0xf
    s_mul_i32 s49, s53, 7
    s_add_u32 s49, s49, 114688
    buffer_load_dwordx4 a[32:35], v2, s[12:15], s49 offen offset:0
    v_fmac_f32_dpp v89, v89, v208 row_newbcast:0 row_mask:0xf bank_mask:0xf
    v_fmac_f32_dpp v90, v90, v208 row_newbcast:0 row_mask:0xf bank_mask:0xf
    v_fmac_f32_dpp v91, v91, v208 row_newbcast:0 row_mask:0xf bank_mask:0xf
    v_cndmask_b32 v25, 0, -1, vcc
    v_fmac_f32_dpp v32, v28, v209 row_newbcast:0 row_mask:0xf bank_mask:0xf
    v_fmac_f32_dpp v33, v29, v209 row_newbcast:0 row_mask:0xf bank_mask:0xf
    v_fmac_f32_dpp v34, v30, v209 row_newbcast:0 row_mask:0xf bank_mask:0xf
    v_fmac_f32_dpp v35, v31, v209 row_newbcast:0 row_mask:0xf bank_mask:0xf
    v_fmac_f32_dpp v52, v48, v209 row_newbcast:0 row_mask:0xf bank_mask:0xf
    v_fmac_f32_dpp v53, v49, v209 row_newbcast:0 row_mask:0xf bank_mask:0xf
    v_fmac_f32_dpp v54, v50, v209 row_newbcast:0 row_mask:0xf bank_mask:0xf
    v_fmac_f32_dpp v55, v51, v209 row_newbcast:0 row_mask:0xf bank_mask:0xf
    v_fmac_f32_dpp v36, v28, v210 row_newbcast:0 row_mask:0xf bank_mask:0xf
    v_fmac_f32_dpp v37, v29, v210 row_newbcast:0 row_mask:0xf bank_mask:0xf
    v_fmac_f32_dpp v38, v30, v210 row_newbcast:0 row_mask:0xf bank_mask:0xf
    v_fmac_f32_dpp v39, v31, v210 row_newbcast:0 row_mask:0xf bank_mask:0xf
    v_fmac_f32_dpp v56, v48, v210 row_newbcast:0 row_mask:0xf bank_mask:0xf
    v_fmac_f32_dpp v57, v49, v210 row_newbcast:0 row_mask:0xf bank_mask:0xf
    buffer_load_dwordx4 a[36:39], v3, s[12:15], s49 offen offset:1024
    v_fmac_f32_dpp v58, v50, v210 row_newbcast:0 row_mask:0xf bank_mask:0xf
    v_fmac_f32_dpp v59, v51, v210 row_newbcast:0 row_mask:0xf bank_mask:0xf
    v_fmac_f32_dpp v40, v28, v211 row_newbcast:0 row_mask:0xf bank_mask:0xf
    v_fmac_f32_dpp v41, v29, v211 row_newbcast:0 row_mask:0xf bank_mask:0xf
    v_fmac_f32_dpp v42, v30, v211 row_newbcast:0 row_mask:0xf bank_mask:0xf
    v_fmac_f32_dpp v43, v31, v211 row_newbcast:0 row_mask:0xf bank_mask:0xf
    v_fmac_f32_dpp v60, v48, v211 row_newbcast:0 row_mask:0xf bank_mask:0xf
    v_fmac_f32_dpp v61, v49, v211 row_newbcast:0 row_mask:0xf bank_mask:0xf
    v_fmac_f32_dpp v62, v50, v211 row_newbcast:0 row_mask:0xf bank_mask:0xf
    v_fmac_f32_dpp v63, v51, v211 row_newbcast:0 row_mask:0xf bank_mask:0xf
    v_fmac_f32_dpp v44, v28, v212 row_newbcast:0 row_mask:0xf bank_mask:0xf
    v_fmac_f32_dpp v45, v29, v212 row_newbcast:0 row_mask:0xf bank_mask:0xf
    v_fmac_f32_dpp v46, v30, v212 row_newbcast:0 row_mask:0xf bank_mask:0xf
    v_fmac_f32_dpp v47, v31, v212 row_newbcast:0 row_mask:0xf bank_mask:0xf
    v_fmac_f32_dpp v64, v48, v212 row_newbcast:0 row_mask:0xf bank_mask:0xf
    v_fmac_f32_dpp v65, v49, v212 row_newbcast:0 row_mask:0xf bank_mask:0xf
    v_fmac_f32_dpp v66, v50, v212 row_newbcast:0 row_mask:0xf bank_mask:0xf
    v_fmac_f32_dpp v67, v51, v212 row_newbcast:0 row_mask:0xf bank_mask:0xf
    v_cvt_pk_bf16_f32 v68, v68, v69
    buffer_load_dwordx4 a[40:43], v4, s[12:15], s49 offen offset:2048
    v_cvt_pk_bf16_f32 v69, v70, v71
    v_cvt_pk_bf16_f32 v70, v88, v89
    v_cvt_pk_bf16_f32 v71, v90, v91
    v_cvt_pk_bf16_f32 v72, v72, v73
    v_cvt_pk_bf16_f32 v73, v74, v75
    v_cvt_pk_bf16_f32 v74, v92, v93
    v_cvt_pk_bf16_f32 v75, v94, v95
    v_cvt_pk_bf16_f32 v76, v76, v77
    buffer_load_dwordx4 a[44:47], v5, s[12:15], s49 offen offset:3072
    v_cvt_pk_bf16_f32 v77, v78, v79
    v_cvt_pk_bf16_f32 v78, v96, v97
    v_cvt_pk_bf16_f32 v79, v98, v99
    v_cvt_pk_bf16_f32 v80, v80, v81
    v_cvt_pk_bf16_f32 v81, v82, v83
    v_cvt_pk_bf16_f32 v82, v100, v101
    v_cvt_pk_bf16_f32 v83, v102, v103
    v_cvt_pk_bf16_f32 v84, v84, v85
    v_cvt_pk_bf16_f32 v85, v86, v87
    s_mul_i32 s49, s54, 7
    s_add_u32 s49, s49, 114688
    buffer_load_dwordx4 a[48:51], v2, s[12:15], s49 offen offset:0
    v_cvt_pk_bf16_f32 v86, v104, v105
    v_cvt_pk_bf16_f32 v87, v106, v107
    v_cvt_pk_bf16_f32 v32, v32, v33
    v_cvt_pk_bf16_f32 v33, v34, v35
    v_cvt_pk_bf16_f32 v34, v52, v53
    v_cvt_pk_bf16_f32 v35, v54, v55
    v_and_b32 v34, v25, v34
    v_and_b32 v35, v25, v35
    buffer_load_dwordx4 a[52:55], v3, s[12:15], s49 offen offset:1024
    v_cvt_pk_bf16_f32 v36, v36, v37
    v_cvt_pk_bf16_f32 v37, v38, v39
    v_cvt_pk_bf16_f32 v38, v56, v57
    v_cvt_pk_bf16_f32 v39, v58, v59
    v_and_b32 v38, v25, v38
    v_and_b32 v39, v25, v39
    v_cvt_pk_bf16_f32 v40, v40, v41
    v_cvt_pk_bf16_f32 v41, v42, v43
    v_cvt_pk_bf16_f32 v42, v60, v61
    buffer_load_dwordx4 a[56:59], v4, s[12:15], s49 offen offset:2048
    v_cvt_pk_bf16_f32 v43, v62, v63
    v_and_b32 v42, v25, v42
    v_and_b32 v43, v25, v43
    v_cvt_pk_bf16_f32 v44, v44, v45
    v_cvt_pk_bf16_f32 v45, v46, v47
    v_cvt_pk_bf16_f32 v46, v64, v65
    v_cvt_pk_bf16_f32 v47, v66, v67
    v_and_b32 v46, v25, v46
    buffer_load_dwordx4 a[60:63], v5, s[12:15], s49 offen offset:3072
    v_and_b32 v47, v25, v47
    v_mov_b32 v20, v108
    v_mov_b32 v21, v108
    v_mov_b32 v22, v128
    v_mov_b32 v23, v128
    v_mfma_f32_16x16x32_bf16 v[148:151], v[68:71], v[32:35], 0
    v_mfma_f32_16x16x32_bf16 v[152:155], v[72:75], v[32:35], 0
    v_mfma_f32_16x16x32_bf16 v[156:159], v[72:75], v[36:39], 0
    v_mfma_f32_16x16x32_bf16 v[160:163], v[76:79], v[36:39], 0
    s_mul_i32 s49, s55, 7
    s_add_u32 s49, s49, 114688
    buffer_load_dwordx4 a[64:67], v2, s[12:15], s49 offen offset:0
    v_mfma_f32_16x16x32_bf16 v[48:51], v[76:79], v[40:43], 0
    v_mfma_f32_16x16x32_bf16 v[52:55], v[80:83], v[40:43], 0
    v_mfma_f32_16x16x32_bf16 v[56:59], v[80:83], v[44:47], 0
    v_mfma_f32_16x16x32_bf16 v[60:63], v[84:87], v[44:47], 0
    v_permlane32_swap_b32 v20, v21
    v_permlane32_swap_b32 v22, v23
    s_waitcnt lgkmcnt(9)
    v_pk_fma_f32 v[108:109], v[168:169], v[20:21], v[108:109] op_sel:[0,0,0] op_sel_hi:[1,0,1]
    v_pk_fma_f32 v[110:111], v[170:171], v[20:21], v[110:111] op_sel:[0,0,0] op_sel_hi:[1,0,1]
    s_waitcnt lgkmcnt(8)
    v_pk_fma_f32 v[112:113], v[172:173], v[20:21], v[112:113] op_sel:[0,0,0] op_sel_hi:[1,0,1]
    buffer_load_dwordx4 a[68:71], v3, s[12:15], s49 offen offset:1024
    v_pk_fma_f32 v[114:115], v[174:175], v[20:21], v[114:115] op_sel:[0,0,0] op_sel_hi:[1,0,1]
    s_waitcnt lgkmcnt(7)
    v_pk_fma_f32 v[116:117], v[176:177], v[20:21], v[116:117] op_sel:[0,0,0] op_sel_hi:[1,0,1]
    v_pk_fma_f32 v[118:119], v[178:179], v[20:21], v[118:119] op_sel:[0,0,0] op_sel_hi:[1,0,1]
    s_waitcnt lgkmcnt(6)
    v_pk_fma_f32 v[120:121], v[180:181], v[20:21], v[120:121] op_sel:[0,0,0] op_sel_hi:[1,0,1]
    v_pk_fma_f32 v[122:123], v[182:183], v[20:21], v[122:123] op_sel:[0,0,0] op_sel_hi:[1,0,1]
    s_waitcnt lgkmcnt(5)
    v_pk_fma_f32 v[124:125], v[184:185], v[20:21], v[124:125] op_sel:[0,0,0] op_sel_hi:[1,0,1]
    v_pk_fma_f32 v[126:127], v[186:187], v[20:21], v[126:127] op_sel:[0,0,0] op_sel_hi:[1,0,1]
    v_pk_fma_f32 v[128:129], v[168:169], v[22:23], v[128:129] op_sel:[0,0,0] op_sel_hi:[1,0,1]
    buffer_load_dwordx4 a[72:75], v4, s[12:15], s49 offen offset:2048
    v_pk_fma_f32 v[130:131], v[170:171], v[22:23], v[130:131] op_sel:[0,0,0] op_sel_hi:[1,0,1]
    v_pk_fma_f32 v[132:133], v[172:173], v[22:23], v[132:133] op_sel:[0,0,0] op_sel_hi:[1,0,1]
    v_pk_fma_f32 v[134:135], v[174:175], v[22:23], v[134:135] op_sel:[0,0,0] op_sel_hi:[1,0,1]
    v_pk_fma_f32 v[136:137], v[176:177], v[22:23], v[136:137] op_sel:[0,0,0] op_sel_hi:[1,0,1]
    v_pk_fma_f32 v[138:139], v[178:179], v[22:23], v[138:139] op_sel:[0,0,0] op_sel_hi:[1,0,1]
    v_pk_fma_f32 v[140:141], v[180:181], v[22:23], v[140:141] op_sel:[0,0,0] op_sel_hi:[1,0,1]
    v_pk_fma_f32 v[142:143], v[182:183], v[22:23], v[142:143] op_sel:[0,0,0] op_sel_hi:[1,0,1]
    v_pk_fma_f32 v[144:145], v[184:185], v[22:23], v[144:145] op_sel:[0,0,0] op_sel_hi:[1,0,1]
    v_pk_fma_f32 v[146:147], v[186:187], v[22:23], v[146:147] op_sel:[0,0,0] op_sel_hi:[1,0,1]
    buffer_load_dwordx4 a[76:79], v5, s[12:15], s49 offen offset:3072
    v_cvt_pk_bf16_f32 v108, v108, v109
    v_cvt_pk_bf16_f32 v109, v110, v111
    v_cvt_pk_bf16_f32 v110, v112, v113
    v_cvt_pk_bf16_f32 v111, v114, v115
    v_cvt_pk_bf16_f32 v112, v116, v117
    v_cvt_pk_bf16_f32 v113, v118, v119
    v_cvt_pk_bf16_f32 v114, v120, v121
    v_cvt_pk_bf16_f32 v115, v122, v123
    s_mul_i32 s49, s56, 7
    s_add_u32 s49, s49, 114688
    buffer_load_dwordx4 a[80:83], v2, s[12:15], s49 offen offset:0
    v_cvt_pk_bf16_f32 v116, v124, v125
    v_cvt_pk_bf16_f32 v117, v126, v127
    v_cvt_pk_bf16_f32 v128, v128, v129
    v_cvt_pk_bf16_f32 v129, v130, v131
    v_cvt_pk_bf16_f32 v130, v132, v133
    v_cvt_pk_bf16_f32 v131, v134, v135
    v_cvt_pk_bf16_f32 v132, v136, v137
    v_cvt_pk_bf16_f32 v133, v138, v139
    v_cvt_pk_bf16_f32 v134, v140, v141
    buffer_load_dwordx4 a[84:87], v3, s[12:15], s49 offen offset:1024
    v_cvt_pk_bf16_f32 v135, v142, v143
    v_cvt_pk_bf16_f32 v136, v144, v145
    v_cvt_pk_bf16_f32 v137, v146, v147
    s_waitcnt lgkmcnt(4)
    v_pk_fma_f32 v[148:149], v[148:149], v[188:189], v[242:243]
    v_pk_fma_f32 v[150:151], v[150:151], v[190:191], v[244:245]
    s_waitcnt lgkmcnt(3)
    v_pk_fma_f32 v[152:153], v[152:153], v[192:193], v[234:235]
    v_pk_fma_f32 v[154:155], v[154:155], v[194:195], v[236:237]
    v_pk_fma_f32 v[156:157], v[156:157], v[192:193], v[238:239]
    buffer_load_dwordx4 a[88:91], v4, s[12:15], s49 offen offset:2048
    v_pk_fma_f32 v[158:159], v[158:159], v[194:195], v[240:241]
    s_waitcnt lgkmcnt(2)
    v_pk_fma_f32 v[160:161], v[160:161], v[196:197], v[234:235]
    v_pk_fma_f32 v[162:163], v[162:163], v[198:199], v[236:237]
    v_pk_fma_f32 v[48:49], v[48:49], v[196:197], v[238:239]
    v_pk_fma_f32 v[50:51], v[50:51], v[198:199], v[240:241]
    s_waitcnt lgkmcnt(1)
    v_pk_fma_f32 v[52:53], v[52:53], v[200:201], v[234:235]
    v_pk_fma_f32 v[54:55], v[54:55], v[202:203], v[236:237]
    v_pk_fma_f32 v[56:57], v[56:57], v[200:201], v[238:239]
    v_pk_fma_f32 v[58:59], v[58:59], v[202:203], v[240:241]
    buffer_load_dwordx4 a[92:95], v5, s[12:15], s49 offen offset:3072
    s_waitcnt lgkmcnt(0)
    v_pk_fma_f32 v[60:61], v[60:61], v[204:205], v[234:235]
    v_pk_fma_f32 v[62:63], v[62:63], v[206:207], v[236:237]
    v_max3_f32 v222, v148, v149, v150
    v_max3_f32 v226, v151, v152, v153
    v_max3_f32 v223, v156, v157, v158
    v_max3_f32 v227, v159, v160, v161
    v_max3_f32 v224, v48, v49, v50
    v_max3_f32 v228, v51, v52, v53
    v_max3_f32 v225, v56, v57, v58
    s_mul_i32 s49, s57, 7
    s_add_u32 s49, s49, 114688
    buffer_load_dwordx4 a[96:99], v2, s[12:15], s49 offen offset:0
    v_max3_f32 v229, v59, v60, v61
    v_max3_f32 v222, v222, v154, v155
    v_max3_f32 v223, v223, v162, v163
    v_max3_f32 v224, v224, v54, v55
    v_max3_f32 v225, v225, v62, v63
    v_max_f32 v222, v222, v226
    v_max_f32 v223, v223, v227
    v_max_f32 v224, v224, v228
    buffer_load_dwordx4 a[100:103], v3, s[12:15], s49 offen offset:1024
    v_max_f32 v225, v225, v229
    v_mov_b32 v226, v222
    v_mov_b32 v227, v223
    v_mov_b32 v228, v224
    v_mov_b32 v229, v225
    v_permlane32_swap_b32 v222, v226
    v_permlane32_swap_b32 v223, v227
    v_permlane32_swap_b32 v224, v228
    v_permlane32_swap_b32 v225, v229
    buffer_load_dwordx4 a[104:107], v4, s[12:15], s49 offen offset:2048
    v_max_f32 v222, v222, v226
    v_max_f32 v223, v223, v227
    v_max_f32 v224, v224, v228
    v_max_f32 v225, v225, v229
    v_mov_b32 v226, v222
    v_mov_b32 v227, v223
    v_mov_b32 v228, v224
    v_mov_b32 v229, v225
    buffer_load_dwordx4 a[108:111], v5, s[12:15], s49 offen offset:3072
    v_permlane16_swap_b32 v222, v226
    v_permlane16_swap_b32 v223, v227
    v_permlane16_swap_b32 v224, v228
    v_permlane16_swap_b32 v225, v229
    v_max_f32 v222, v222, v226
    v_max_f32 v223, v223, v227
    v_max_f32 v224, v224, v228
    v_max_f32 v225, v225, v229
    v_mov_b32 v168, v218
    s_mul_i32 s49, s58, 7
    s_add_u32 s49, s49, 114688
    buffer_load_dwordx4 a[112:115], v2, s[12:15], s49 offen offset:0
    v_mul_f32 v169, -v222, v218
    v_mov_b32 v170, v219
    v_mul_f32 v171, -v223, v219
    v_mov_b32 v172, v220
    v_mul_f32 v173, -v224, v220
    v_mov_b32 v174, v221
    v_mul_f32 v175, -v225, v221
    v_pk_fma_f32 v[148:149], v[148:149], v[168:169], v[168:169] op_sel:[0,0,1] op_sel_hi:[1,0,1]
    buffer_load_dwordx4 a[116:119], v3, s[12:15], s49 offen offset:1024
    v_pk_fma_f32 v[150:151], v[150:151], v[168:169], v[168:169] op_sel:[0,0,1] op_sel_hi:[1,0,1]
    v_pk_fma_f32 v[152:153], v[152:153], v[168:169], v[168:169] op_sel:[0,0,1] op_sel_hi:[1,0,1]
    v_pk_fma_f32 v[154:155], v[154:155], v[168:169], v[168:169] op_sel:[0,0,1] op_sel_hi:[1,0,1]
    v_pk_fma_f32 v[156:157], v[156:157], v[170:171], v[170:171] op_sel:[0,0,1] op_sel_hi:[1,0,1]
    v_pk_fma_f32 v[158:159], v[158:159], v[170:171], v[170:171] op_sel:[0,0,1] op_sel_hi:[1,0,1]
    v_pk_fma_f32 v[160:161], v[160:161], v[170:171], v[170:171] op_sel:[0,0,1] op_sel_hi:[1,0,1]
    v_pk_fma_f32 v[162:163], v[162:163], v[170:171], v[170:171] op_sel:[0,0,1] op_sel_hi:[1,0,1]
    v_pk_fma_f32 v[48:49], v[48:49], v[172:173], v[172:173] op_sel:[0,0,1] op_sel_hi:[1,0,1]
    v_pk_fma_f32 v[50:51], v[50:51], v[172:173], v[172:173] op_sel:[0,0,1] op_sel_hi:[1,0,1]
    buffer_load_dwordx4 a[120:123], v4, s[12:15], s49 offen offset:2048
    v_pk_fma_f32 v[52:53], v[52:53], v[172:173], v[172:173] op_sel:[0,0,1] op_sel_hi:[1,0,1]
    v_pk_fma_f32 v[54:55], v[54:55], v[172:173], v[172:173] op_sel:[0,0,1] op_sel_hi:[1,0,1]
    v_pk_fma_f32 v[56:57], v[56:57], v[174:175], v[174:175] op_sel:[0,0,1] op_sel_hi:[1,0,1]
    v_pk_fma_f32 v[58:59], v[58:59], v[174:175], v[174:175] op_sel:[0,0,1] op_sel_hi:[1,0,1]
    v_pk_fma_f32 v[60:61], v[60:61], v[174:175], v[174:175] op_sel:[0,0,1] op_sel_hi:[1,0,1]
    v_pk_fma_f32 v[62:63], v[62:63], v[174:175], v[174:175] op_sel:[0,0,1] op_sel_hi:[1,0,1]
    v_exp_f32 v148, v148
    v_exp_f32 v149, v149
    v_exp_f32 v150, v150
    buffer_load_dwordx4 a[124:127], v5, s[12:15], s49 offen offset:3072
    v_exp_f32 v151, v151
    v_exp_f32 v152, v152
    v_exp_f32 v153, v153
    v_exp_f32 v154, v154
    v_exp_f32 v155, v155
    v_exp_f32 v156, v156
    v_exp_f32 v157, v157
    v_exp_f32 v158, v158
    s_mul_i32 s49, s59, 7
    s_add_u32 s49, s49, 114688
    buffer_load_dwordx4 a[128:131], v2, s[12:15], s49 offen offset:0
    v_exp_f32 v159, v159
    v_exp_f32 v160, v160
    v_exp_f32 v161, v161
    v_exp_f32 v162, v162
    v_exp_f32 v163, v163
    v_exp_f32 v48, v48
    v_exp_f32 v49, v49
    v_exp_f32 v50, v50
    v_exp_f32 v51, v51
    buffer_load_dwordx4 a[132:135], v3, s[12:15], s49 offen offset:1024
    v_exp_f32 v52, v52
    v_exp_f32 v53, v53
    v_exp_f32 v54, v54
    v_exp_f32 v55, v55
    v_exp_f32 v56, v56
    v_exp_f32 v57, v57
    v_exp_f32 v58, v58
    v_exp_f32 v59, v59
    buffer_load_dwordx4 a[136:139], v4, s[12:15], s49 offen offset:2048
    v_exp_f32 v60, v60
    v_exp_f32 v61, v61
    v_exp_f32 v62, v62
    v_exp_f32 v63, v63
    v_pk_add_f32 v[176:177], v[148:149], v[150:151]
    v_pk_add_f32 v[178:179], v[156:157], v[158:159]
    v_pk_add_f32 v[180:181], v[48:49], v[50:51]
    v_pk_add_f32 v[182:183], v[56:57], v[58:59]
    v_pk_add_f32 v[176:177], v[176:177], v[152:153]
    buffer_load_dwordx4 a[140:143], v5, s[12:15], s49 offen offset:3072
    v_pk_add_f32 v[178:179], v[178:179], v[160:161]
    v_pk_add_f32 v[180:181], v[180:181], v[52:53]
    v_pk_add_f32 v[182:183], v[182:183], v[60:61]
    v_pk_add_f32 v[176:177], v[176:177], v[154:155]
    v_pk_add_f32 v[178:179], v[178:179], v[162:163]
    v_pk_add_f32 v[180:181], v[180:181], v[54:55]
    v_pk_add_f32 v[182:183], v[182:183], v[62:63]
    v_pk_mul_f32 v[148:149], v[148:149], v[188:189]
    v_pk_mul_f32 v[150:151], v[150:151], v[190:191]
    v_pk_mul_f32 v[152:153], v[152:153], v[192:193]
    v_pk_mul_f32 v[154:155], v[154:155], v[194:195]
    v_pk_mul_f32 v[156:157], v[156:157], v[192:193]
    v_pk_mul_f32 v[158:159], v[158:159], v[194:195]
    v_pk_mul_f32 v[160:161], v[160:161], v[196:197]
    v_pk_mul_f32 v[162:163], v[162:163], v[198:199]
    v_pk_mul_f32 v[48:49], v[48:49], v[196:197]
    v_pk_mul_f32 v[50:51], v[50:51], v[198:199]
    v_pk_mul_f32 v[52:53], v[52:53], v[200:201]
    v_pk_mul_f32 v[54:55], v[54:55], v[202:203]
    v_pk_mul_f32 v[56:57], v[56:57], v[200:201]
    v_pk_mul_f32 v[58:59], v[58:59], v[202:203]
    v_pk_mul_f32 v[60:61], v[60:61], v[204:205]
    v_pk_mul_f32 v[62:63], v[62:63], v[206:207]
    v_cvt_pk_bf16_f32 v148, v148, v149
    v_cvt_pk_bf16_f32 v149, v150, v151
    v_cvt_pk_bf16_f32 v150, v152, v153
    v_cvt_pk_bf16_f32 v151, v154, v155
    v_cvt_pk_bf16_f32 v156, v156, v157
    v_cvt_pk_bf16_f32 v157, v158, v159
    v_cvt_pk_bf16_f32 v158, v160, v161
    v_cvt_pk_bf16_f32 v159, v162, v163
    v_cvt_pk_bf16_f32 v48, v48, v49
    v_cvt_pk_bf16_f32 v49, v50, v51
    v_cvt_pk_bf16_f32 v50, v52, v53
    v_cvt_pk_bf16_f32 v51, v54, v55
    v_cvt_pk_bf16_f32 v56, v56, v57
    v_cvt_pk_bf16_f32 v57, v58, v59
    v_cvt_pk_bf16_f32 v58, v60, v61
    v_cvt_pk_bf16_f32 v59, v62, v63
    v_add_f32 v222, v176, v177
    v_add_f32 v223, v178, v179
    v_add_f32 v224, v180, v181
    v_add_f32 v225, v182, v183
    v_mfma_f32_16x16x32_bf16 v[88:91], v[108:111], v[148:151], 0
    v_mfma_f32_16x16x32_bf16 v[92:95], v[128:131], v[148:151], 0
    v_mfma_f32_16x16x32_bf16 v[96:99], v[110:113], v[156:159], 0
    v_mfma_f32_16x16x32_bf16 v[100:103], v[130:133], v[156:159], 0
    v_mfma_f32_16x16x32_bf16 v[118:121], v[112:115], v[48:51], 0
    v_mfma_f32_16x16x32_bf16 v[122:125], v[132:135], v[48:51], 0
    v_mfma_f32_16x16x32_bf16 v[138:141], v[114:117], v[56:59], 0
    v_mfma_f32_16x16x32_bf16 v[142:145], v[134:137], v[56:59], 0
    v_mov_b32 v226, v222
    v_mov_b32 v227, v223
    v_mov_b32 v228, v224
    v_mov_b32 v229, v225
    v_permlane32_swap_b32 v222, v226
    v_permlane32_swap_b32 v223, v227
    v_permlane32_swap_b32 v224, v228
    v_permlane32_swap_b32 v225, v229
    v_add_f32 v222, v222, v226
    v_add_f32 v223, v223, v227
    v_add_f32 v224, v224, v228
    v_add_f32 v225, v225, v229
    s_mov_b32 s66, s76
    s_mov_b32 s67, s76
    s_buffer_load_dwordx8 s[68:75], s[20:23], s43
    v_mov_b32 v226, v222
    v_mov_b32 v227, v223
    v_mov_b32 v228, v224
    v_mov_b32 v229, v225
    v_permlane16_swap_b32 v222, v226
    v_permlane16_swap_b32 v223, v227
    v_permlane16_swap_b32 v224, v228
    v_permlane16_swap_b32 v225, v229
    v_add_f32 v222, v222, v226
    v_add_f32 v223, v223, v227
    v_add_f32 v224, v224, v228
    v_add_f32 v225, v225, v229
    v_rcp_f32 v168, v222
    v_rcp_f32 v170, v223
    v_rcp_f32 v172, v224
    v_rcp_f32 v174, v225
    v_and_b32 v169, v25, v168
    v_and_b32 v171, v25, v170
    v_and_b32 v173, v25, v172
    v_and_b32 v175, v25, v174
    v_pk_mul_f32 v[88:89], v[88:89], v[168:169] op_sel:[0,0] op_sel_hi:[1,0]
    v_pk_mul_f32 v[90:91], v[90:91], v[168:169] op_sel:[0,0] op_sel_hi:[1,0]
    v_pk_mul_f32 v[92:93], v[92:93], v[168:169] op_sel:[0,1] op_sel_hi:[1,1]
    v_pk_mul_f32 v[94:95], v[94:95], v[168:169] op_sel:[0,1] op_sel_hi:[1,1]
    v_cvt_pk_bf16_f32 v88, v88, v89
    v_cvt_pk_bf16_f32 v89, v90, v91
    v_cvt_pk_bf16_f32 v90, v92, v93
    v_cvt_pk_bf16_f32 v91, v94, v95
    s_nop 0
    v_permlane32_swap_b32 v88, v90
    v_permlane32_swap_b32 v89, v91
    buffer_store_dwordx4 v[88:91], v247, s[20:23], 0 offen offset:0 sc1
    v_pk_mul_f32 v[96:97], v[96:97], v[170:171] op_sel:[0,0] op_sel_hi:[1,0]
    v_pk_mul_f32 v[98:99], v[98:99], v[170:171] op_sel:[0,0] op_sel_hi:[1,0]
    v_pk_mul_f32 v[100:101], v[100:101], v[170:171] op_sel:[0,1] op_sel_hi:[1,1]
    v_pk_mul_f32 v[102:103], v[102:103], v[170:171] op_sel:[0,1] op_sel_hi:[1,1]
    v_cvt_pk_bf16_f32 v96, v96, v97
    v_cvt_pk_bf16_f32 v97, v98, v99
    v_cvt_pk_bf16_f32 v98, v100, v101
    v_cvt_pk_bf16_f32 v99, v102, v103
    s_nop 0
    v_permlane32_swap_b32 v96, v98
    v_permlane32_swap_b32 v97, v99
    buffer_store_dwordx4 v[96:99], v247, s[20:23], 0 offen offset:256 sc1
    v_pk_mul_f32 v[118:119], v[118:119], v[172:173] op_sel:[0,0] op_sel_hi:[1,0]
    v_pk_mul_f32 v[120:121], v[120:121], v[172:173] op_sel:[0,0] op_sel_hi:[1,0]
    v_pk_mul_f32 v[122:123], v[122:123], v[172:173] op_sel:[0,1] op_sel_hi:[1,1]
    v_pk_mul_f32 v[124:125], v[124:125], v[172:173] op_sel:[0,1] op_sel_hi:[1,1]
    v_cvt_pk_bf16_f32 v118, v118, v119
    v_cvt_pk_bf16_f32 v119, v120, v121
    v_cvt_pk_bf16_f32 v120, v122, v123
    v_cvt_pk_bf16_f32 v121, v124, v125
    s_nop 0
    v_permlane32_swap_b32 v118, v120
    v_permlane32_swap_b32 v119, v121
    buffer_store_dwordx4 v[118:121], v247, s[20:23], s3 offen offset:0 sc1
    v_pk_mul_f32 v[138:139], v[138:139], v[174:175] op_sel:[0,0] op_sel_hi:[1,0]
    v_pk_mul_f32 v[140:141], v[140:141], v[174:175] op_sel:[0,0] op_sel_hi:[1,0]
    v_pk_mul_f32 v[142:143], v[142:143], v[174:175] op_sel:[0,1] op_sel_hi:[1,1]
    v_pk_mul_f32 v[144:145], v[144:145], v[174:175] op_sel:[0,1] op_sel_hi:[1,1]
    v_cvt_pk_bf16_f32 v138, v138, v139
    v_cvt_pk_bf16_f32 v139, v140, v141
    v_cvt_pk_bf16_f32 v140, v142, v143
    v_cvt_pk_bf16_f32 v141, v144, v145
    s_nop 0
    v_permlane32_swap_b32 v138, v140
    v_permlane32_swap_b32 v139, v141
    buffer_store_dwordx4 v[138:141], v247, s[20:23], s3 offen offset:256 sc1
    s_cmp_eq_u32 s48, 7
    s_cbranch_scc1 Lq14
    s_waitcnt lgkmcnt(0)
    s_xor_b64 s[68:69], s[68:69], s[66:67]
    s_xor_b64 s[70:71], s[70:71], s[66:67]
    s_xor_b64 s[72:73], s[72:73], s[66:67]
    s_xor_b32 s74, s74, s66
    s_or_b64 s[68:69], s[68:69], s[70:71]
    s_or_b32 s72, s72, s74
    s_or_b64 s[68:69], s[68:69], s[72:73]
    s_cbranch_scc1 Lcq0_p
Lcq0_k:
    buffer_load_dwordx4 a[144:147], v8, s[20:23], s53 offen offset:0 sc1
    buffer_load_dwordx4 a[148:151], v9, s[20:23], s53 offen offset:0 sc1
    buffer_load_dwordx4 a[152:155], v8, s[20:23], s53 offen offset:2048 sc1
    buffer_load_dwordx4 a[156:159], v9, s[20:23], s53 offen offset:2048 sc1
    v_lshl_add_u32 v18, v1, 4, s78
    v_accvgpr_read_b32 v68, a240
    ds_read_b64_tr_b16 v[36:37], v6 offset:0
    v_accvgpr_read_b32 v69, a241
    v_accvgpr_read_b32 v70, a242
    v_accvgpr_read_b32 v71, a243
    ds_read_b64_tr_b16 v[38:39], v6 offset:1024
    v_accvgpr_read_b32 v72, a244
    v_accvgpr_read_b32 v73, a245
    v_accvgpr_read_b32 v74, a246
    v_accvgpr_read_b32 v75, a247
    ds_read_b64_tr_b16 v[40:41], v7 offset:0
    v_accvgpr_read_b32 v76, a248
    v_accvgpr_read_b32 v77, a249
    v_accvgpr_read_b32 v78, a250
    v_accvgpr_read_b32 v79, a251
    ds_read_b64_tr_b16 v[42:43], v7 offset:1024
    v_accvgpr_read_b32 v80, a252
    v_accvgpr_read_b32 v81, a253
    v_accvgpr_read_b32 v82, a254
    v_accvgpr_read_b32 v83, a255
    ds_read_b64_tr_b16 v[44:45], v6 offset:2048
    v_lshlrev_b32 v84, 16, v68
    v_and_b32 v85, 0xffff0000, v68
    v_lshlrev_b32 v19, 16, v76
    ds_read_b64_tr_b16 v[46:47], v6 offset:3072
    v_add_f32 v84, v84, v19
    v_and_b32 v19, 0xffff0000, v76
    v_add_f32 v85, v85, v19
    v_lshlrev_b32 v86, 16, v69
    ds_read_b64_tr_b16 v[48:49], v7 offset:2048
    v_and_b32 v87, 0xffff0000, v69
    v_lshlrev_b32 v19, 16, v77
    v_add_f32 v86, v86, v19
    v_and_b32 v19, 0xffff0000, v77
    ds_read_b64_tr_b16 v[50:51], v7 offset:3072
    v_add_f32 v87, v87, v19
    v_lshlrev_b32 v88, 16, v70
    v_and_b32 v89, 0xffff0000, v70
    v_lshlrev_b32 v19, 16, v78
    ds_read_b64_tr_b16 v[52:53], v6 offset:4096
    v_add_f32 v88, v88, v19
    v_and_b32 v19, 0xffff0000, v78
    v_add_f32 v89, v89, v19
    ds_read_b64_tr_b16 v[54:55], v6 offset:5120
    v_lshlrev_b32 v90, 16, v71
    v_and_b32 v91, 0xffff0000, v71
    v_lshlrev_b32 v19, 16, v79
    v_add_f32 v90, v90, v19
    ds_read_b64_tr_b16 v[56:57], v7 offset:4096
    v_and_b32 v19, 0xffff0000, v79
    v_add_f32 v91, v91, v19
    v_lshlrev_b32 v92, 16, v72
    v_and_b32 v93, 0xffff0000, v72
    ds_read_b64_tr_b16 v[58:59], v7 offset:5120
    v_lshlrev_b32 v19, 16, v80
    v_add_f32 v92, v92, v19
    v_and_b32 v19, 0xffff0000, v80
    v_add_f32 v93, v93, v19
    ds_read_b64_tr_b16 v[60:61], v6 offset:6144
    v_lshlrev_b32 v94, 16, v73
    v_and_b32 v95, 0xffff0000, v73
    v_lshlrev_b32 v19, 16, v81
    ds_read_b64_tr_b16 v[62:63], v6 offset:7168
    v_add_f32 v94, v94, v19
    v_and_b32 v19, 0xffff0000, v81
    v_add_f32 v95, v95, v19
    v_lshlrev_b32 v96, 16, v74
    ds_read_b64_tr_b16 v[64:65], v7 offset:6144
    v_and_b32 v97, 0xffff0000, v74
    v_lshlrev_b32 v19, 16, v82
    v_add_f32 v96, v96, v19
    v_and_b32 v19, 0xffff0000, v82
    ds_read_b64_tr_b16 v[66:67], v7 offset:7168
    v_add_f32 v97, v97, v19
    v_lshlrev_b32 v98, 16, v75
    v_and_b32 v99, 0xffff0000, v75
    v_lshlrev_b32 v19, 16, v83
    s_waitcnt vmcnt(43)
    ds_write_b128 v18, a[0:3] offset:0
    v_add_f32 v98, v98, v19
    v_and_b32 v19, 0xffff0000, v83
    v_add_f32 v99, v99, v19
    s_waitcnt vmcnt(42)
    ds_write_b128 v18, a[4:7] offset:1024
    s_lshl_b32 s51, s47, 6
    s_and_b32 s52, s44, 1
    s_add_u32 s51, s51, s52
    s_mul_i32 s51, s51, 896
    s_waitcnt vmcnt(41)
    ds_write_b128 v18, a[8:11] offset:2048
    v_and_b32 v14, 31, v1
    v_mul_u32_u24 v14, 1792, v14
    v_add_u32 v14, s51, v14
    s_lshr_b32 s51, s44, 1
    s_waitcnt vmcnt(40)
    ds_write_b128 v18, a[12:15] offset:3072
    s_lshl_b32 s51, s51, 6
    s_lshl_b32 s52, s48, 7
    s_add_u32 s51, s51, s52
    v_lshrrev_b32 v19, 5, v1
    s_waitcnt vmcnt(39)
    ds_write_b128 v18, a[16:19] offset:4096
    v_lshl_add_u32 v19, v19, 4, s51
    v_add_u32 v14, v14, v19
    s_xor_b32 s51, s44, 2
    s_waitcnt vmcnt(38)
    ds_write_b128 v18, a[20:23] offset:5120
    s_mul_i32 s51, s51, 40960
    s_add_u32 s51, s51, 0
    v_lshl_add_u32 v15, v1, 4, s51
    s_xor_b32 s51, s44, 1
    s_waitcnt vmcnt(37)
    ds_write_b128 v18, a[24:27] offset:6144
    s_mul_i32 s51, s51, 40960
    s_add_u32 s51, s51, 4096
    v_lshl_add_u32 v16, v1, 4, s51
    s_xor_b32 s51, s44, 3
    s_waitcnt vmcnt(36)
    ds_write_b128 v18, a[28:31] offset:7168
    s_mul_i32 s51, s51, 40960
    s_add_u32 s51, s51, 8192
    v_lshl_add_u32 v17, v1, 4, s51
    s_waitcnt vmcnt(4)
    buffer_store_dword v13, v0, s[20:23], 0 offen offset:28
    v_mov_b32 v244, 2146435072
Lp2:
    s_waitcnt vmcnt(4) lgkmcnt(15)
    v_mfma_f32_32x32x16_bf16 v[20:35], v[36:39], a[144:147], 0
    v_mfma_f32_32x32x16_bf16 v[112:127], v[40:43], a[144:147], 0
    buffer_load_dwordx4 a[160:163], v8, s[20:23], s54 offen offset:0 sc1
    s_waitcnt vmcnt(4)
    v_mfma_f32_32x32x16_bf16 v[128:143], v[36:39], a[148:151], 0
    buffer_load_dwordx4 a[164:167], v9, s[20:23], s54 offen offset:0 sc1
    v_mfma_f32_32x32x16_bf16 v[144:159], v[40:43], a[148:151], 0
    buffer_load_dwordx4 a[168:171], v8, s[20:23], s54 offen offset:2048 sc1
    s_waitcnt vmcnt(5)
    v_mfma_f32_32x32x16_bf16 v[20:35], v[44:47], a[152:155], v[20:35]
    v_mfma_f32_32x32x16_bf16 v[112:127], v[48:51], a[152:155], v[112:127]
    buffer_load_dwordx4 a[172:175], v9, s[20:23], s54 offen offset:2048 sc1
    s_waitcnt vmcnt(5)
    v_mfma_f32_32x32x16_bf16 v[128:143], v[44:47], a[156:159], v[128:143]
    buffer_load_dwordx4 a[176:179], v8, s[20:23], s55 offen offset:0 sc1
    v_mfma_f32_32x32x16_bf16 v[144:159], v[48:51], a[156:159], v[144:159]
    s_waitcnt vmcnt(4) lgkmcnt(14)
    v_mfma_f32_32x32x16_bf16 v[20:35], v[52:55], a[160:163], v[20:35]
    ds_read_b64_tr_b16 v[36:37], v6 offset:8192
    buffer_load_dwordx4 a[180:183], v9, s[20:23], s55 offen offset:0 sc1
    s_waitcnt lgkmcnt(13)
    v_mfma_f32_32x32x16_bf16 v[112:127], v[56:59], a[160:163], v[112:127]
    ds_read_b64_tr_b16 v[38:39], v6 offset:9216
    buffer_load_dwordx4 a[184:187], v8, s[20:23], s55 offen offset:2048 sc1
    s_waitcnt vmcnt(5)
    v_mfma_f32_32x32x16_bf16 v[128:143], v[52:55], a[164:167], v[128:143]
    ds_read_b64_tr_b16 v[40:41], v7 offset:8192
    buffer_load_dwordx4 a[188:191], v9, s[20:23], s55 offen offset:2048 sc1
    v_mfma_f32_32x32x16_bf16 v[144:159], v[56:59], a[164:167], v[144:159]
    ds_read_b64_tr_b16 v[42:43], v7 offset:9216
    s_waitcnt vmcnt(5) lgkmcnt(14)
    v_mfma_f32_32x32x16_bf16 v[20:35], v[60:63], a[168:171], v[20:35]
    ds_read_b64_tr_b16 v[44:45], v6 offset:10240
    buffer_load_dwordx4 a[192:195], v8, s[20:23], s56 offen offset:0 sc1
    s_waitcnt lgkmcnt(13)
    v_mfma_f32_32x32x16_bf16 v[112:127], v[64:67], a[168:171], v[112:127]
    ds_read_b64_tr_b16 v[46:47], v6 offset:11264
    buffer_load_dwordx4 a[196:199], v9, s[20:23], s56 offen offset:0 sc1
    s_waitcnt vmcnt(6)
    v_mfma_f32_32x32x16_bf16 v[128:143], v[60:63], a[172:175], v[128:143]
    ds_read_b64_tr_b16 v[48:49], v7 offset:10240
    v_mfma_f32_32x32x16_bf16 v[144:159], v[64:67], a[172:175], v[144:159]
    ds_read_b64_tr_b16 v[50:51], v7 offset:11264
    buffer_load_dwordx4 a[200:203], v8, s[20:23], s56 offen offset:2048 sc1
    s_waitcnt vmcnt(6) lgkmcnt(6)
    v_mfma_f32_32x32x16_bf16 v[20:35], v[36:39], a[176:179], v[20:35]
    ds_read_b64_tr_b16 v[52:53], v6 offset:12288
    buffer_load_dwordx4 a[204:207], v9, s[20:23], s56 offen offset:2048 sc1
    s_waitcnt lgkmcnt(5)
    v_mfma_f32_32x32x16_bf16 v[112:127], v[40:43], a[176:179], v[112:127]
    ds_read_b64_tr_b16 v[54:55], v6 offset:13312
    ds_write_b128 v18, a[32:35] offset:8192
    buffer_load_dwordx4 a[208:211], v8, s[20:23], s57 offen offset:0 sc1
    s_waitcnt vmcnt(7)
    v_mfma_f32_32x32x16_bf16 v[128:143], v[36:39], a[180:183], v[128:143]
    ds_read_b64_tr_b16 v[56:57], v7 offset:12288
    v_mfma_f32_32x32x16_bf16 v[144:159], v[40:43], a[180:183], v[144:159]
    ds_read_b64_tr_b16 v[58:59], v7 offset:13312
    ds_write_b128 v18, a[36:39] offset:9216
    buffer_load_dwordx4 a[212:215], v9, s[20:23], s57 offen offset:0 sc1
    s_waitcnt vmcnt(7) lgkmcnt(8)
    v_mfma_f32_32x32x16_bf16 v[20:35], v[44:47], a[184:187], v[20:35]
    ds_read_b64_tr_b16 v[60:61], v6 offset:14336
    buffer_load_dwordx4 a[216:219], v8, s[20:23], s57 offen offset:2048 sc1
    s_waitcnt lgkmcnt(7)
    v_mfma_f32_32x32x16_bf16 v[112:127], v[48:51], a[184:187], v[112:127]
    ds_read_b64_tr_b16 v[62:63], v6 offset:15360
    s_waitcnt vmcnt(7)
    v_mfma_f32_32x32x16_bf16 v[128:143], v[44:47], a[188:191], v[128:143]
    ds_read_b64_tr_b16 v[64:65], v7 offset:14336
    ds_write_b128 v18, a[40:43] offset:10240
    buffer_load_dwordx4 a[220:223], v9, s[20:23], s57 offen offset:2048 sc1
    v_mfma_f32_32x32x16_bf16 v[144:159], v[48:51], a[188:191], v[144:159]
    ds_read_b64_tr_b16 v[66:67], v7 offset:15360
    buffer_load_dword v12, v10, s[20:23], 0 offen sc1
    s_waitcnt vmcnt(8) lgkmcnt(9)
    v_mfma_f32_32x32x16_bf16 v[20:35], v[52:55], a[192:195], v[20:35]
    ds_read_b64_tr_b16 v[36:37], v6 offset:16384
    buffer_load_dwordx4 a[224:227], v8, s[20:23], s58 offen offset:0 sc1
    s_waitcnt lgkmcnt(7)
    v_mfma_f32_32x32x16_bf16 v[112:127], v[56:59], a[192:195], v[112:127]
    ds_read_b64_tr_b16 v[38:39], v6 offset:17408
    ds_write_b128 v18, a[44:47] offset:11264
    buffer_load_dwordx4 a[228:231], v9, s[20:23], s58 offen offset:0 sc1
    s_waitcnt vmcnt(9)
    v_mfma_f32_32x32x16_bf16 v[128:143], v[52:55], a[196:199], v[128:143]
    ds_read_b64_tr_b16 v[40:41], v7 offset:16384
    v_mfma_f32_32x32x16_bf16 v[144:159], v[56:59], a[196:199], v[144:159]
    ds_read_b64_tr_b16 v[42:43], v7 offset:17408
    buffer_load_dwordx4 a[232:235], v8, s[20:23], s58 offen offset:2048 sc1
    s_waitcnt vmcnt(9) lgkmcnt(8)
    v_mfma_f32_32x32x16_bf16 v[20:35], v[60:63], a[200:203], v[20:35]
    ds_read_b64_tr_b16 v[44:45], v6 offset:18432
    ds_write_b128 v18, a[48:51] offset:12288
    buffer_load_dwordx4 a[236:239], v9, s[20:23], s58 offen offset:2048 sc1
    s_waitcnt lgkmcnt(7)
    v_mfma_f32_32x32x16_bf16 v[112:127], v[64:67], a[200:203], v[112:127]
    ds_read_b64_tr_b16 v[46:47], v6 offset:19456
    s_waitcnt vmcnt(9)
    v_mfma_f32_32x32x16_bf16 v[128:143], v[60:63], a[204:207], v[128:143]
    ds_read_b64_tr_b16 v[48:49], v7 offset:18432
    buffer_load_dwordx4 a[240:243], v8, s[20:23], s59 offen offset:0 sc1
    v_mfma_f32_32x32x16_bf16 v[144:159], v[64:67], a[204:207], v[144:159]
    ds_read_b64_tr_b16 v[50:51], v7 offset:19456
    ds_write_b128 v18, a[52:55] offset:13312
    buffer_load_dwordx4 a[244:247], v9, s[20:23], s59 offen offset:0 sc1
    s_waitcnt vmcnt(10) lgkmcnt(9)
    v_mfma_f32_32x32x16_bf16 v[20:35], v[36:39], a[208:211], v[20:35]
    ds_read_b64_tr_b16 v[52:53], v6 offset:20480
    buffer_load_dwordx4 a[248:251], v8, s[20:23], s59 offen offset:2048 sc1
    s_waitcnt lgkmcnt(7)
    v_mfma_f32_32x32x16_bf16 v[112:127], v[40:43], a[208:211], v[112:127]
    ds_read_b64_tr_b16 v[54:55], v6 offset:21504
    ds_write_b128 v18, a[56:59] offset:14336
    s_waitcnt vmcnt(10)
    v_mfma_f32_32x32x16_bf16 v[128:143], v[36:39], a[212:215], v[128:143]
    ds_read_b64_tr_b16 v[56:57], v7 offset:20480
    buffer_load_dwordx4 a[252:255], v9, s[20:23], s59 offen offset:2048 sc1
    s_waitcnt vmcnt(8)
    v_cmp_eq_u32 vcc, s76, v12
    s_nop 0
    s_and_b32 s79, vcc_lo, 4177920
    s_cmp_eq_u32 s79, 4177920
    s_cbranch_scc0 Lco_p
Lco_k:
    v_mfma_f32_32x32x16_bf16 v[144:159], v[40:43], a[212:215], v[144:159]
    ds_read_b64_tr_b16 v[58:59], v7 offset:21504
    s_lshl_b32 s50, s62, 12
    s_add_u32 s50, s50, s60
    s_waitcnt lgkmcnt(8)
    v_mfma_f32_32x32x16_bf16 v[20:35], v[44:47], a[216:219], v[20:35]
    ds_read_b64_tr_b16 v[60:61], v6 offset:22528
    ds_write_b128 v18, a[60:63] offset:15360
    buffer_load_dwordx4 v[160:163], v8, s[20:23], s50 offen offset:0 sc1
    s_waitcnt lgkmcnt(8)
    v_mfma_f32_32x32x16_bf16 v[112:127], v[48:51], a[216:219], v[112:127]
    ds_read_b64_tr_b16 v[62:63], v6 offset:23552
    v_mfma_f32_32x32x16_bf16 v[128:143], v[44:47], a[220:223], v[128:143]
    ds_read_b64_tr_b16 v[64:65], v7 offset:22528
    buffer_load_dwordx4 v[164:167], v9, s[20:23], s50 offen offset:0 sc1
    v_mfma_f32_32x32x16_bf16 v[144:159], v[48:51], a[220:223], v[144:159]
    ds_read_b64_tr_b16 v[66:67], v7 offset:23552
    ds_write_b128 v18, a[64:67] offset:16384
    buffer_load_dwordx4 v[168:171], v8, s[20:23], s50 offen offset:2048 sc1
    s_waitcnt vmcnt(10) lgkmcnt(9)
    v_mfma_f32_32x32x16_bf16 v[20:35], v[52:55], a[224:227], v[20:35]
    ds_read_b64_tr_b16 v[36:37], v6 offset:24576
    s_waitcnt lgkmcnt(7)
    v_mfma_f32_32x32x16_bf16 v[112:127], v[56:59], a[224:227], v[112:127]
    ds_read_b64_tr_b16 v[38:39], v6 offset:25600
    buffer_load_dwordx4 v[172:175], v9, s[20:23], s50 offen offset:2048 sc1
    s_waitcnt vmcnt(10)
    v_mfma_f32_32x32x16_bf16 v[128:143], v[52:55], a[228:231], v[128:143]
    ds_read_b64_tr_b16 v[40:41], v7 offset:24576
    ds_write_b128 v18, a[68:71] offset:17408
    buffer_load_dword v12, v10, s[20:23], 0 offen sc1
    s_lshl_b32 s50, s63, 12
    s_add_u32 s50, s50, s60
    v_mfma_f32_32x32x16_bf16 v[144:159], v[56:59], a[228:231], v[144:159]
    ds_read_b64_tr_b16 v[42:43], v7 offset:25600
    buffer_load_dwordx4 v[176:179], v8, s[20:23], s50 offen offset:0 sc1
    s_waitcnt vmcnt(11) lgkmcnt(8)
    v_mfma_f32_32x32x16_bf16 v[20:35], v[60:63], a[232:235], v[20:35]
    ds_read_b64_tr_b16 v[44:45], v6 offset:26624
    s_waitcnt lgkmcnt(7)
    v_mfma_f32_32x32x16_bf16 v[112:127], v[64:67], a[232:235], v[112:127]
    ds_read_b64_tr_b16 v[46:47], v6 offset:27648
    ds_write_b128 v18, a[72:75] offset:18432
    buffer_load_dwordx4 v[180:183], v9, s[20:23], s50 offen offset:0 sc1
    s_waitcnt vmcnt(11)
    v_mfma_f32_32x32x16_bf16 v[128:143], v[60:63], a[236:239], v[128:143]
    ds_read_b64_tr_b16 v[48:49], v7 offset:26624
    buffer_load_dwordx4 v[184:187], v8, s[20:23], s50 offen offset:2048 sc1
    v_mfma_f32_32x32x16_bf16 v[144:159], v[64:67], a[236:239], v[144:159]
    ds_read_b64_tr_b16 v[50:51], v7 offset:27648
    ds_write_b128 v18, a[76:79] offset:19456
    s_waitcnt vmcnt(11) lgkmcnt(9)
    v_mfma_f32_32x32x16_bf16 v[20:35], v[36:39], a[240:243], v[20:35]
    ds_read_b64_tr_b16 v[52:53], v6 offset:28672
    buffer_load_dwordx4 v[188:191], v9, s[20:23], s50 offen offset:2048 sc1
    s_lshl_b32 s50, s64, 12
    s_add_u32 s50, s50, s60
    s_waitcnt lgkmcnt(7)
    v_mfma_f32_32x32x16_bf16 v[112:127], v[40:43], a[240:243], v[112:127]
    ds_read_b64_tr_b16 v[54:55], v6 offset:29696
    buffer_load_dwordx4 v[192:195], v8, s[20:23], s50 offen offset:0 sc1
    s_waitcnt vmcnt(12)
    v_mfma_f32_32x32x16_bf16 v[128:143], v[36:39], a[244:247], v[128:143]
    ds_read_b64_tr_b16 v[56:57], v7 offset:28672
    ds_write_b128 v18, a[80:83] offset:20480
    v_mfma_f32_32x32x16_bf16 v[144:159], v[40:43], a[244:247], v[144:159]
    ds_read_b64_tr_b16 v[58:59], v7 offset:29696
    buffer_load_dwordx4 v[196:199], v9, s[20:23], s50 offen offset:0 sc1
    s_waitcnt vmcnt(12) lgkmcnt(9)
    v_mfma_f32_32x32x16_bf16 v[20:35], v[44:47], a[248:251], v[20:35]
    ds_read_b64_tr_b16 v[60:61], v6 offset:30720
    buffer_load_dwordx4 v[200:203], v8, s[20:23], s50 offen offset:2048 sc1
    s_waitcnt lgkmcnt(7)
    v_mfma_f32_32x32x16_bf16 v[112:127], v[48:51], a[248:251], v[112:127]
    ds_read_b64_tr_b16 v[62:63], v6 offset:31744
    ds_write_b128 v18, a[84:87] offset:21504
    s_waitcnt vmcnt(12)
    v_mfma_f32_32x32x16_bf16 v[128:143], v[44:47], a[252:255], v[128:143]
    ds_read_b64_tr_b16 v[64:65], v7 offset:30720
    buffer_load_dwordx4 v[204:207], v9, s[20:23], s50 offen offset:2048 sc1
    s_lshl_b32 s50, s65, 12
    s_add_u32 s50, s50, s60
    v_mfma_f32_32x32x16_bf16 v[144:159], v[48:51], a[252:255], v[144:159]
    ds_read_b64_tr_b16 v[66:67], v7 offset:31744
    buffer_load_dwordx4 v[208:211], v8, s[20:23], s50 offen offset:0 sc1
    s_waitcnt vmcnt(13) lgkmcnt(8)
    v_mfma_f32_32x32x16_bf16 v[20:35], v[52:55], v[160:163], v[20:35]
    ds_read_b64_tr_b16 v[36:37], v6 offset:32768
    ds_write_b128 v18, a[88:91] offset:22528
    s_waitcnt lgkmcnt(7)
    v_mfma_f32_32x32x16_bf16 v[112:127], v[56:59], v[160:163], v[112:127]
    ds_read_b64_tr_b16 v[38:39], v6 offset:33792
    buffer_load_dwordx4 v[212:215], v9, s[20:23], s50 offen offset:0 sc1
    s_waitcnt vmcnt(13)
    v_mfma_f32_32x32x16_bf16 v[128:143], v[52:55], v[164:167], v[128:143]
    ds_read_b64_tr_b16 v[40:41], v7 offset:32768
    buffer_load_dwordx4 v[216:219], v8, s[20:23], s50 offen offset:2048 sc1
    v_mfma_f32_32x32x16_bf16 v[144:159], v[56:59], v[164:167], v[144:159]
    ds_read_b64_tr_b16 v[42:43], v7 offset:33792
    ds_write_b128 v18, a[92:95] offset:23552
    s_waitcnt vmcnt(13) lgkmcnt(9)
    v_mfma_f32_32x32x16_bf16 v[20:35], v[60:63], v[168:171], v[20:35]
    ds_read_b64_tr_b16 v[44:45], v6 offset:34816
    buffer_load_dwordx4 v[220:223], v9, s[20:23], s50 offen offset:2048 sc1
    s_waitcnt vmcnt(12)
    v_cmp_eq_u32 vcc, s76, v12
    s_nop 0
    s_and_b32 s79, vcc_lo, 16256
    s_cmp_eq_u32 s79, 16256
    s_cbranch_scc0 Lch1_p
Lch1_k:
    s_waitcnt lgkmcnt(7)
    v_mfma_f32_32x32x16_bf16 v[112:127], v[64:67], v[168:171], v[112:127]
    ds_read_b64_tr_b16 v[46:47], v6 offset:35840
    ds_write_b128 v18, a[96:99] offset:24576
    s_add_u32 s50, s53, 16384
    v_mfma_f32_32x32x16_bf16 v[128:143], v[60:63], v[172:175], v[128:143]
    ds_read_b64_tr_b16 v[48:49], v7 offset:34816
    buffer_load_dwordx4 a[144:147], v8, s[20:23], s50 offen offset:0 sc1
    v_mfma_f32_32x32x16_bf16 v[144:159], v[64:67], v[172:175], v[144:159]
    ds_read_b64_tr_b16 v[50:51], v7 offset:35840
    s_waitcnt vmcnt(12) lgkmcnt(8)
    v_mfma_f32_32x32x16_bf16 v[20:35], v[36:39], v[176:179], v[20:35]
    ds_read_b64_tr_b16 v[52:53], v6 offset:0
    ds_write_b128 v18, a[100:103] offset:25600
    buffer_load_dwordx4 a[148:151], v9, s[20:23], s50 offen offset:0 sc1
    s_waitcnt lgkmcnt(8)
    v_mfma_f32_32x32x16_bf16 v[112:127], v[40:43], v[176:179], v[112:127]
    ds_read_b64_tr_b16 v[54:55], v6 offset:1024
    s_waitcnt vmcnt(12)
    v_mfma_f32_32x32x16_bf16 v[128:143], v[36:39], v[180:183], v[128:143]
    ds_read_b64_tr_b16 v[56:57], v7 offset:0
    buffer_load_dwordx4 a[152:155], v8, s[20:23], s50 offen offset:2048 sc1
    v_mfma_f32_32x32x16_bf16 v[144:159], v[40:43], v[180:183], v[144:159]
    ds_read_b64_tr_b16 v[58:59], v7 offset:1024
    ds_write_b128 v18, a[104:107] offset:26624
    buffer_load_dwordx4 a[156:159], v9, s[20:23], s50 offen offset:2048 sc1
    s_waitcnt vmcnt(13) lgkmcnt(9)
    v_mfma_f32_32x32x16_bf16 v[20:35], v[44:47], v[184:187], v[20:35]
    ds_read_b64_tr_b16 v[60:61], v6 offset:2048
    s_add_u32 s50, s54, 16384
    s_waitcnt lgkmcnt(7)
    v_mfma_f32_32x32x16_bf16 v[112:127], v[48:51], v[184:187], v[112:127]
    ds_read_b64_tr_b16 v[62:63], v6 offset:3072
    buffer_load_dwordx4 a[160:163], v8, s[20:23], s50 offen offset:0 sc1
    s_waitcnt vmcnt(13)
    v_mfma_f32_32x32x16_bf16 v[128:143], v[44:47], v[188:191], v[128:143]
    ds_read_b64_tr_b16 v[64:65], v7 offset:2048
    ds_write_b128 v18, a[108:111] offset:27648
    v_mfma_f32_32x32x16_bf16 v[144:159], v[48:51], v[188:191], v[144:159]
    ds_read_b64_tr_b16 v[66:67], v7 offset:3072
    buffer_load_dwordx4 a[164:167], v9, s[20:23], s50 offen offset:0 sc1
    s_waitcnt vmcnt(13) lgkmcnt(8)
    v_mfma_f32_32x32x16_bf16 v[20:35], v[52:55], v[192:195], v[20:35]
    ds_read_b64_tr_b16 v[36:37], v6 offset:4096
    buffer_load_dwordx4 a[168:171], v8, s[20:23], s50 offen offset:2048 sc1
    s_waitcnt lgkmcnt(7)
    v_mfma_f32_32x32x16_bf16 v[112:127], v[56:59], v[192:195], v[112:127]
    ds_read_b64_tr_b16 v[38:39], v6 offset:5120
    ds_write_b128 v18, a[112:115] offset:28672
    s_waitcnt vmcnt(13)
    v_mfma_f32_32x32x16_bf16 v[128:143], v[52:55], v[196:199], v[128:143]
    ds_read_b64_tr_b16 v[40:41], v7 offset:4096
    buffer_load_dwordx4 a[172:175], v9, s[20:23], s50 offen offset:2048 sc1
    v_mfma_f32_32x32x16_bf16 v[144:159], v[56:59], v[196:199], v[144:159]
    ds_read_b64_tr_b16 v[42:43], v7 offset:5120
    ds_write_b128 v18, a[116:119] offset:29696
    s_add_u32 s50, s55, 16384
    s_waitcnt vmcnt(13) lgkmcnt(9)
    v_mfma_f32_32x32x16_bf16 v[20:35], v[60:63], v[200:203], v[20:35]
    ds_read_b64_tr_b16 v[44:45], v6 offset:6144
    buffer_load_dwordx4 a[176:179], v8, s[20:23], s50 offen offset:0 sc1
    s_waitcnt lgkmcnt(7)
    v_mfma_f32_32x32x16_bf16 v[112:127], v[64:67], v[200:203], v[112:127]
    ds_read_b64_tr_b16 v[46:47], v6 offset:7168
    buffer_load_dwordx4 a[180:183], v9, s[20:23], s50 offen offset:0 sc1
    s_waitcnt vmcnt(14)
    v_mfma_f32_32x32x16_bf16 v[128:143], v[60:63], v[204:207], v[128:143]
    ds_read_b64_tr_b16 v[48:49], v7 offset:6144
    ds_write_b128 v18, a[120:123] offset:30720
    v_mfma_f32_32x32x16_bf16 v[144:159], v[64:67], v[204:207], v[144:159]
    ds_read_b64_tr_b16 v[50:51], v7 offset:7168
    buffer_load_dwordx4 a[184:187], v8, s[20:23], s50 offen offset:2048 sc1
    s_waitcnt vmcnt(14) lgkmcnt(9)
    v_mfma_f32_32x32x16_bf16 v[20:35], v[36:39], v[208:211], v[20:35]
    ds_read_b64_tr_b16 v[160:161], v6 offset:22528
    ds_read_b64_tr_b16 v[52:53], v6 offset:8192
    s_waitcnt lgkmcnt(8)
    v_mfma_f32_32x32x16_bf16 v[112:127], v[40:43], v[208:211], v[112:127]
    ds_read_b64_tr_b16 v[162:163], v6 offset:23552
    ds_read_b64_tr_b16 v[54:55], v6 offset:9216
    ds_write_b128 v18, a[124:127] offset:31744
    buffer_load_dwordx4 a[188:191], v9, s[20:23], s50 offen offset:2048 sc1
    s_waitcnt vmcnt(14)
    v_mfma_f32_32x32x16_bf16 v[128:143], v[36:39], v[212:215], v[128:143]
    ds_read_b64_tr_b16 v[164:165], v7 offset:22528
    ds_read_b64_tr_b16 v[56:57], v7 offset:8192
    s_add_u32 s50, s56, 16384
    v_mfma_f32_32x32x16_bf16 v[144:159], v[40:43], v[212:215], v[144:159]
    ds_read_b64_tr_b16 v[166:167], v7 offset:23552
    ds_read_b64_tr_b16 v[58:59], v7 offset:9216
    buffer_load_dwordx4 a[192:195], v8, s[20:23], s50 offen offset:0 sc1
    s_waitcnt vmcnt(14) lgkmcnt(12)
    v_mfma_f32_32x32x16_bf16 v[20:35], v[44:47], v[216:219], v[20:35]
    ds_read_b64_tr_b16 v[168:169], v6 offset:24576
    ds_read_b64_tr_b16 v[60:61], v6 offset:10240
    ds_write_b128 v18, a[128:131] offset:32768
    buffer_load_dwordx4 a[200:203], v8, s[20:23], s50 offen offset:2048 sc1
    s_waitcnt lgkmcnt(12)
    v_mfma_f32_32x32x16_bf16 v[112:127], v[48:51], v[216:219], v[112:127]
    ds_read_b64_tr_b16 v[170:171], v6 offset:25600
    ds_read_b64_tr_b16 v[62:63], v6 offset:11264
    s_add_u32 s50, s57, 16384
    s_waitcnt vmcnt(14)
    v_mfma_f32_32x32x16_bf16 v[128:143], v[44:47], v[220:223], v[128:143]
    ds_read_b64_tr_b16 v[172:173], v7 offset:24576
    ds_read_b64_tr_b16 v[64:65], v7 offset:10240
    buffer_load_dwordx4 a[208:211], v8, s[20:23], s50 offen offset:0 sc1
    v_mfma_f32_32x32x16_bf16 v[144:159], v[48:51], v[220:223], v[144:159]
    ds_read_b64_tr_b16 v[174:175], v7 offset:25600
    ds_read_b64_tr_b16 v[66:67], v7 offset:11264
    ds_write_b128 v18, a[132:135] offset:33792
    s_waitcnt vmcnt(14) lgkmcnt(15)
    v_mfma_f32_32x32x16_bf16 v[20:35], v[52:55], a[144:147], v[20:35]
    ds_read_b64_tr_b16 v[176:177], v6 offset:26624
    ds_read_b64_tr_b16 v[36:37], v6 offset:12288
    buffer_load_dwordx4 a[216:219], v8, s[20:23], s50 offen offset:2048 sc1
    s_add_u32 s50, s58, 16384
    s_waitcnt lgkmcnt(12)
    v_mfma_f32_32x32x16_bf16 v[112:127], v[56:59], a[144:147], v[112:127]
    ds_read_b64_tr_b16 v[178:179], v6 offset:27648
    ds_read_b64_tr_b16 v[38:39], v6 offset:13312
    ds_write_b128 v18, a[136:139] offset:34816
    buffer_load_dwordx4 a[224:227], v8, s[20:23], s50 offen offset:0 sc1
    s_waitcnt vmcnt(15)
    v_mfma_f32_32x32x16_bf16 v[128:143], v[52:55], a[148:151], v[128:143]
    ds_read_b64_tr_b16 v[180:181], v7 offset:26624
    ds_read_b64_tr_b16 v[40:41], v7 offset:12288
    v_mfma_f32_32x32x16_bf16 v[144:159], v[56:59], a[148:151], v[144:159]
    ds_read_b64_tr_b16 v[182:183], v7 offset:27648
    ds_read_b64_tr_b16 v[42:43], v7 offset:13312
    buffer_load_dwordx4 a[232:235], v8, s[20:23], s50 offen offset:2048 sc1
    s_waitcnt vmcnt(15) lgkmcnt(14)
    v_mfma_f32_32x32x16_bf16 v[20:35], v[60:63], a[152:155], v[20:35]
    ds_read_b64_tr_b16 v[184:185], v6 offset:28672
    ds_read_b64_tr_b16 v[44:45], v6 offset:14336
    ds_write_b128 v18, a[140:143] offset:35840
    s_add_u32 s50, s59, 16384
    s_waitcnt lgkmcnt(13)
    v_mfma_f32_32x32x16_bf16 v[112:127], v[64:67], a[152:155], v[112:127]
    ds_read_b64_tr_b16 v[186:187], v6 offset:29696
    ds_read_b64_tr_b16 v[46:47], v6 offset:15360
    buffer_load_dwordx4 a[240:243], v8, s[20:23], s50 offen offset:0 sc1
    s_waitcnt vmcnt(15)
    v_mfma_f32_32x32x16_bf16 v[128:143], v[60:63], a[156:159], v[128:143]
    ds_read_b64_tr_b16 v[188:189], v7 offset:28672
    ds_read_b64_tr_b16 v[48:49], v7 offset:14336
    buffer_load_dwordx4 a[248:251], v8, s[20:23], s50 offen offset:2048 sc1
    v_mfma_f32_32x32x16_bf16 v[144:159], v[64:67], a[156:159], v[144:159]
    ds_read_b64_tr_b16 v[190:191], v7 offset:29696
    ds_read_b64_tr_b16 v[50:51], v7 offset:15360
    s_add_u32 s50, s56, 16384
    s_waitcnt vmcnt(15) lgkmcnt(14)
    v_mfma_f32_32x32x16_bf16 v[20:35], v[36:39], a[160:163], v[20:35]
    ds_read_b64_tr_b16 v[192:193], v6 offset:30720
    ds_read_b64_tr_b16 v[52:53], v6 offset:16384
    buffer_load_dwordx4 a[196:199], v9, s[20:23], s50 offen offset:0 sc1
    s_waitcnt lgkmcnt(11)
    v_mfma_f32_32x32x16_bf16 v[112:127], v[40:43], a[160:163], v[112:127]
    ds_read_b64_tr_b16 v[194:195], v6 offset:31744
    ds_read_b64_tr_b16 v[54:55], v6 offset:17408
    s_waitcnt vmcnt(15)
    v_mfma_f32_32x32x16_bf16 v[128:143], v[36:39], a[164:167], v[128:143]
    ds_read_b64_tr_b16 v[196:197], v7 offset:30720
    ds_read_b64_tr_b16 v[56:57], v7 offset:16384
    buffer_load_dwordx4 a[204:207], v9, s[20:23], s50 offen offset:2048 sc1
    v_mfma_f32_32x32x16_bf16 v[144:159], v[40:43], a[164:167], v[144:159]
    ds_read_b64_tr_b16 v[198:199], v7 offset:31744
    ds_read_b64_tr_b16 v[58:59], v7 offset:17408
    s_add_u32 s50, s57, 16384
    s_waitcnt vmcnt(15) lgkmcnt(12)
    v_mfma_f32_32x32x16_bf16 v[20:35], v[44:47], a[168:171], v[20:35]
    ds_read_b64_tr_b16 v[200:201], v6 offset:32768
    ds_read_b64_tr_b16 v[60:61], v6 offset:18432
    buffer_load_dwordx4 a[212:215], v9, s[20:23], s50 offen offset:0 sc1
    s_waitcnt lgkmcnt(10)
    v_mfma_f32_32x32x16_bf16 v[112:127], v[48:51], a[168:171], v[112:127]
    s_barrier
    ds_read_b64_tr_b16 v[202:203], v6 offset:33792
    ds_read_b64_tr_b16 v[62:63], v6 offset:19456
    buffer_load_dwordx4 a[220:223], v9, s[20:23], s50 offen offset:2048 sc1
    s_waitcnt vmcnt(16)
    v_mfma_f32_32x32x16_bf16 v[128:143], v[44:47], a[172:175], v[128:143]
    ds_read_b64_tr_b16 v[204:205], v7 offset:32768
    ds_read_b64_tr_b16 v[64:65], v7 offset:18432
    s_add_u32 s50, s58, 16384
    v_mfma_f32_32x32x16_bf16 v[144:159], v[48:51], a[172:175], v[144:159]
    ds_read_b64_tr_b16 v[206:207], v7 offset:33792
    ds_read_b64_tr_b16 v[66:67], v7 offset:19456
    buffer_load_dwordx4 a[228:231], v9, s[20:23], s50 offen offset:0 sc1
    s_waitcnt vmcnt(16) lgkmcnt(12)
    v_mfma_f32_32x32x16_bf16 v[20:35], v[52:55], a[176:179], v[20:35]
    ds_read_b64_tr_b16 v[208:209], v6 offset:34816
    ds_read_b64_tr_b16 v[36:37], v6 offset:20480
    s_waitcnt lgkmcnt(10)
    v_mfma_f32_32x32x16_bf16 v[112:127], v[56:59], a[176:179], v[112:127]
    ds_read_b64_tr_b16 v[210:211], v6 offset:35840
    ds_read_b64_tr_b16 v[38:39], v6 offset:21504
    buffer_load_dwordx4 a[236:239], v9, s[20:23], s50 offen offset:2048 sc1
    s_add_u32 s50, s59, 16384
    s_waitcnt vmcnt(16)
    v_mfma_f32_32x32x16_bf16 v[128:143], v[52:55], a[180:183], v[128:143]
    ds_read_b64_tr_b16 v[212:213], v7 offset:34816
    ds_read_b64_tr_b16 v[40:41], v7 offset:20480
    buffer_load_dwordx4 a[244:247], v9, s[20:23], s50 offen offset:0 sc1
    v_mfma_f32_32x32x16_bf16 v[144:159], v[56:59], a[180:183], v[144:159]
    ds_read_b64_tr_b16 v[214:215], v7 offset:35840
    ds_read_b64_tr_b16 v[42:43], v7 offset:21504
    s_waitcnt vmcnt(16) lgkmcnt(12)
    v_mfma_f32_32x32x16_bf16 v[20:35], v[60:63], a[184:187], v[20:35]
    buffer_load_dwordx4 a[252:255], v9, s[20:23], s50 offen offset:2048 sc1
    s_waitcnt lgkmcnt(8)
    v_mfma_f32_32x32x16_bf16 v[112:127], v[64:67], a[184:187], v[112:127]
    s_waitcnt vmcnt(16)
    v_mfma_f32_32x32x16_bf16 v[128:143], v[60:63], a[188:191], v[128:143]
    buffer_store_dword v13, v0, s[20:23], 0 offen offset:156 sc1
    v_mfma_f32_32x32x16_bf16 v[144:159], v[64:67], a[188:191], v[144:159]
    s_waitcnt vmcnt(16) lgkmcnt(0)
    v_mfma_f32_32x32x16_bf16 v[112:127], v[40:43], a[192:195], v[112:127]
    s_waitcnt vmcnt(15)
    v_mfma_f32_32x32x16_bf16 v[112:127], v[164:167], a[200:203], v[112:127]
    s_waitcnt vmcnt(14)
    v_mfma_f32_32x32x16_bf16 v[112:127], v[172:175], a[208:211], v[112:127]
    s_waitcnt vmcnt(13)
    v_mfma_f32_32x32x16_bf16 v[112:127], v[180:183], a[216:219], v[112:127]
    s_waitcnt vmcnt(12)
    v_mfma_f32_32x32x16_bf16 v[112:127], v[188:191], a[224:227], v[112:127]
    s_waitcnt vmcnt(11)
    v_mfma_f32_32x32x16_bf16 v[112:127], v[196:199], a[232:235], v[112:127]
    s_waitcnt vmcnt(10)
    v_mfma_f32_32x32x16_bf16 v[112:127], v[204:207], a[240:243], v[112:127]
    s_waitcnt vmcnt(9)
    v_mfma_f32_32x32x16_bf16 v[112:127], v[212:215], a[248:251], v[112:127]
    v_add_f32 v20, v20, v84
    v_add_f32 v21, v21, v85
    v_add_f32 v22, v22, v86
    v_add_f32 v23, v23, v87
    v_add_f32 v24, v24, v88
    s_waitcnt vmcnt(8)
    v_mfma_f32_32x32x16_bf16 v[128:143], v[36:39], a[196:199], v[128:143]
    v_add_f32 v25, v25, v89
    v_add_f32 v26, v26, v90
    v_add_f32 v27, v27, v91
    v_add_f32 v28, v28, v92
    v_add_f32 v29, v29, v93
    s_waitcnt vmcnt(7)
    v_mfma_f32_32x32x16_bf16 v[128:143], v[160:163], a[204:207], v[128:143]
    ds_write_b128 v15, v[112:115] offset:0
    s_waitcnt vmcnt(6)
    v_mfma_f32_32x32x16_bf16 v[128:143], v[168:171], a[212:215], v[128:143]
    ds_write_b128 v15, v[116:119] offset:1024
    s_waitcnt vmcnt(5)
    v_mfma_f32_32x32x16_bf16 v[128:143], v[176:179], a[220:223], v[128:143]
    s_waitcnt vmcnt(4)
    v_mfma_f32_32x32x16_bf16 v[128:143], v[184:187], a[228:231], v[128:143]
    ds_write_b128 v15, v[120:123] offset:2048
    s_waitcnt vmcnt(3)
    v_mfma_f32_32x32x16_bf16 v[128:143], v[192:195], a[236:239], v[128:143]
    ds_write_b128 v15, v[124:127] offset:3072
    s_waitcnt vmcnt(2)
    v_mfma_f32_32x32x16_bf16 v[128:143], v[200:203], a[244:247], v[128:143]
    s_waitcnt vmcnt(1)
    v_mfma_f32_32x32x16_bf16 v[128:143], v[208:211], a[252:255], v[128:143]
    v_add_f32 v30, v30, v94
    v_add_f32 v31, v31, v95
    v_add_f32 v32, v32, v96
    v_add_f32 v33, v33, v97
    v_add_f32 v34, v34, v98
    v_mfma_f32_32x32x16_bf16 v[144:159], v[40:43], a[196:199], v[144:159]
    v_add_f32 v35, v35, v99
    s_nop 3
    v_mfma_f32_32x32x16_bf16 v[144:159], v[164:167], a[204:207], v[144:159]
    ds_write_b128 v16, v[128:131] offset:0
    v_mfma_f32_32x32x16_bf16 v[144:159], v[172:175], a[212:215], v[144:159]
    ds_write_b128 v16, v[132:135] offset:1024
    v_mfma_f32_32x32x16_bf16 v[144:159], v[180:183], a[220:223], v[144:159]
    v_mfma_f32_32x32x16_bf16 v[144:159], v[188:191], a[228:231], v[144:159]
    ds_write_b128 v16, v[136:139] offset:2048
    v_mfma_f32_32x32x16_bf16 v[144:159], v[196:199], a[236:239], v[144:159]
    ds_write_b128 v16, v[140:143] offset:3072
    v_mfma_f32_32x32x16_bf16 v[144:159], v[204:207], a[244:247], v[144:159]
    v_mfma_f32_32x32x16_bf16 v[144:159], v[212:215], a[252:255], v[144:159]
    s_nop 4
    v_mfma_f32_32x32x16_bf16 v[20:35], v[36:39], a[192:195], v[20:35]
    s_nop 4
    v_mfma_f32_32x32x16_bf16 v[20:35], v[160:163], a[200:203], v[20:35]
    ds_write_b128 v17, v[144:147] offset:0
    v_mfma_f32_32x32x16_bf16 v[20:35], v[168:171], a[208:211], v[20:35]
    ds_write_b128 v17, v[148:151] offset:1024
    v_mfma_f32_32x32x16_bf16 v[20:35], v[176:179], a[216:219], v[20:35]
    v_mfma_f32_32x32x16_bf16 v[20:35], v[184:187], a[224:227], v[20:35]
    ds_write_b128 v17, v[152:155] offset:2048
    v_mfma_f32_32x32x16_bf16 v[20:35], v[192:195], a[232:235], v[20:35]
    ds_write_b128 v17, v[156:159] offset:3072
    v_mfma_f32_32x32x16_bf16 v[20:35], v[200:203], a[240:243], v[20:35]
    v_mfma_f32_32x32x16_bf16 v[20:35], v[208:211], a[248:251], v[20:35]
    s_waitcnt lgkmcnt(0)
    s_barrier
    ds_read_b128 v[112:115], v18 offset:0
    ds_read_b128 v[116:119], v18 offset:1024
    ds_read_b128 v[128:131], v18 offset:4096
    ds_read_b128 v[132:135], v18 offset:5120
    ds_read_b128 v[144:147], v18 offset:8192
    ds_read_b128 v[148:151], v18 offset:9216
    ds_read_b128 v[120:123], v18 offset:2048
    ds_read_b128 v[124:127], v18 offset:3072
    ds_read_b128 v[136:139], v18 offset:6144
    ds_read_b128 v[140:143], v18 offset:7168
    ds_read_b128 v[152:155], v18 offset:10240
    ds_read_b128 v[156:159], v18 offset:11264
    s_waitcnt lgkmcnt(11)
    v_pk_add_f32 v[20:21], v[20:21], v[112:113]
    v_pk_add_f32 v[22:23], v[22:23], v[114:115]
    s_waitcnt lgkmcnt(10)
    v_pk_add_f32 v[24:25], v[24:25], v[116:117]
    v_pk_add_f32 v[26:27], v[26:27], v[118:119]
    s_waitcnt lgkmcnt(9)
    v_pk_add_f32 v[20:21], v[20:21], v[128:129]
    v_pk_add_f32 v[22:23], v[22:23], v[130:131]
    s_waitcnt lgkmcnt(8)
    v_pk_add_f32 v[24:25], v[24:25], v[132:133]
    v_pk_add_f32 v[26:27], v[26:27], v[134:135]
    s_waitcnt lgkmcnt(7)
    v_pk_add_f32 v[20:21], v[20:21], v[144:145]
    v_pk_add_f32 v[22:23], v[22:23], v[146:147]
    s_waitcnt lgkmcnt(6)
    v_pk_add_f32 v[24:25], v[24:25], v[148:149]
    v_pk_add_f32 v[26:27], v[26:27], v[150:151]
    v_cvt_pk_bf16_f32 v84, v20, v21
    v_cvt_pk_bf16_f32 v85, v22, v23
    v_cvt_pk_bf16_f32 v86, v24, v25
    v_cvt_pk_bf16_f32 v87, v26, v27
    buffer_store_dwordx4 v[84:87], v14, s[24:27], 0 offen offset:0
    s_waitcnt lgkmcnt(5)
    v_pk_add_f32 v[28:29], v[28:29], v[120:121]
    v_pk_add_f32 v[30:31], v[30:31], v[122:123]
    s_waitcnt lgkmcnt(4)
    v_pk_add_f32 v[32:33], v[32:33], v[124:125]
    v_pk_add_f32 v[34:35], v[34:35], v[126:127]
    s_waitcnt lgkmcnt(3)
    v_pk_add_f32 v[28:29], v[28:29], v[136:137]
    v_pk_add_f32 v[30:31], v[30:31], v[138:139]
    s_waitcnt lgkmcnt(2)
    v_pk_add_f32 v[32:33], v[32:33], v[140:141]
    v_pk_add_f32 v[34:35], v[34:35], v[142:143]
    s_waitcnt lgkmcnt(1)
    v_pk_add_f32 v[28:29], v[28:29], v[152:153]
    v_pk_add_f32 v[30:31], v[30:31], v[154:155]
    s_waitcnt lgkmcnt(0)
    v_pk_add_f32 v[32:33], v[32:33], v[156:157]
    v_pk_add_f32 v[34:35], v[34:35], v[158:159]
    v_cvt_pk_bf16_f32 v88, v28, v29
    v_cvt_pk_bf16_f32 v89, v30, v31
    v_cvt_pk_bf16_f32 v90, v32, v33
    v_cvt_pk_bf16_f32 v91, v34, v35
    buffer_store_dwordx4 v[88:91], v14, s[24:27], 0 offen offset:32
Lfin:
Lfail:
    s_waitcnt vmcnt(0)
Lend:
    s_endpgm
Lnon_s:
    s_sub_u32 s77, s77, 1
    s_cbranch_scc1 Lfail
    buffer_load_dword v13, off, s[36:39], 0 sc1
    s_waitcnt vmcnt(0)
    v_readfirstlane_b32 s76, v13
    s_nop 0
    s_cmp_eq_u32 s76, 0
    s_cbranch_scc1 Lnon_s
    s_branch Lnon_k
Lcm0_p:
Lcm0_s:
    s_sub_u32 s77, s77, 1
    s_cbranch_scc1 Lfail
    s_and_b32 s41, s77, 7
    s_cbranch_scc0 Lcm0_f
    s_buffer_load_dwordx8 s[68:75], s[20:23], s43 glc
    s_waitcnt lgkmcnt(0)
    s_xor_b64 s[68:69], s[68:69], s[66:67]
    s_xor_b64 s[70:71], s[70:71], s[66:67]
    s_xor_b64 s[72:73], s[72:73], s[66:67]
    s_xor_b32 s74, s74, s66
    s_or_b64 s[68:69], s[68:69], s[70:71]
    s_or_b32 s72, s72, s74
    s_or_b64 s[68:69], s[68:69], s[72:73]
    s_cbranch_scc1 Lcm0_s
    s_branch Lcm0_k
Lcm0_f:
    s_mov_b64 exec, 1
    buffer_store_dword v13, v0, s[20:23], 0 offen offset:128 sc1
    s_mov_b64 exec, -1
    buffer_load_dword v12, v10, s[20:23], 0 offen offset:128 sc1
    s_waitcnt vmcnt(0)
    v_cmp_eq_u32 vcc, s76, v12
    s_nop 0
    s_and_b32 s79, vcc_lo, 127
    s_cmp_eq_u32 s79, 127
    s_cbranch_scc0 Lcm0_s
    s_branch Lcm0_k
Lco_m_p:
Lco_m_s:
    s_sub_u32 s77, s77, 1
    s_cbranch_scc1 Lfail
    s_and_b32 s41, s77, 7
    s_cbranch_scc0 Lco_m_f
    buffer_load_dword v12, v10, s[20:23], 0 offen sc1
Lco_m_c:
    s_waitcnt vmcnt(0)
    v_cmp_eq_u32 vcc, s76, v12
    s_nop 0
    s_or_b32 s79, s79, vcc_lo
    s_and_b32 s79, s79, 4177920
    s_cmp_eq_u32 s79, 4177920
    s_cbranch_scc0 Lco_m_s
    s_branch Lco_m_k
Lco_m_f:
    s_waitcnt vmcnt(0)
    buffer_store_dword v13, v0, s[20:23], 0 offen offset:28
    buffer_store_dword v13, v0, s[20:23], 0 offen offset:156 sc1
    buffer_load_dword v12, v10, s[20:23], 0 offen offset:128 sc1
    s_branch Lco_m_c
Lch1_m_p:
Lch1_m_s:
    s_sub_u32 s77, s77, 1
    s_cbranch_scc1 Lfail
    s_and_b32 s41, s77, 7
    s_cbranch_scc0 Lch1_m_f
    buffer_load_dword v12, v10, s[20:23], 0 offen sc1
Lch1_m_c:
    s_waitcnt vmcnt(0)
    v_cmp_eq_u32 vcc, s76, v12
    s_nop 0
    s_or_b32 s79, s79, vcc_lo
    s_and_b32 s79, s79, 16256
    s_cmp_eq_u32 s79, 16256
    s_cbranch_scc0 Lch1_m_s
    s_branch Lch1_m_k
Lch1_m_f:
    s_waitcnt vmcnt(0)
    buffer_store_dword v13, v0, s[20:23], 0 offen offset:28
    buffer_store_dword v13, v0, s[20:23], 0 offen offset:156 sc1
    buffer_load_dword v12, v10, s[20:23], 0 offen offset:128 sc1
    s_branch Lch1_m_c
Lnonq_s:
    s_sub_u32 s77, s77, 1
    s_cbranch_scc1 Lfail
    buffer_load_dword v13, off, s[36:39], 0 sc1
    s_waitcnt vmcnt(0)
    v_readfirstlane_b32 s76, v13
    s_nop 0
    s_cmp_eq_u32 s76, 0
    s_cbranch_scc1 Lnonq_s
    s_branch Lnonq_k
Lcq0_p:
Lcq0_s:
    s_sub_u32 s77, s77, 1
    s_cbranch_scc1 Lfail
    s_and_b32 s41, s77, 7
    s_cbranch_scc0 Lcq0_f
    s_buffer_load_dwordx8 s[68:75], s[20:23], s43 glc
    s_waitcnt lgkmcnt(0)
    s_xor_b64 s[68:69], s[68:69], s[66:67]
    s_xor_b64 s[70:71], s[70:71], s[66:67]
    s_xor_b64 s[72:73], s[72:73], s[66:67]
    s_xor_b32 s74, s74, s66
    s_or_b64 s[68:69], s[68:69], s[70:71]
    s_or_b32 s72, s72, s74
    s_or_b64 s[68:69], s[68:69], s[72:73]
    s_cbranch_scc1 Lcq0_s
    s_branch Lcq0_k
Lcq0_f:
    s_waitcnt vmcnt(0)
    buffer_store_dword v13, v0, s[20:23], 0 offen offset:28
    buffer_store_dword v13, v0, s[20:23], 0 offen offset:156 sc1
    buffer_load_dword v12, v10, s[20:23], 0 offen offset:128 sc1
    s_waitcnt vmcnt(0)
    v_cmp_eq_u32 vcc, s76, v12
    s_nop 0
    s_and_b32 s79, vcc_lo, 127
    s_cmp_eq_u32 s79, 127
    s_cbranch_scc0 Lcq0_s
    s_branch Lcq0_k
Lq14:
    s_waitcnt vmcnt(0)
    buffer_store_dword v13, v0, s[20:23], 0 offen offset:28
    buffer_store_dword v13, v0, s[20:23], 0 offen offset:156 sc1
    s_branch Lfin
Lco_p:
Lco_s:
    s_sub_u32 s77, s77, 1
    s_cbranch_scc1 Lfail
    s_and_b32 s41, s77, 7
    s_cbranch_scc0 Lco_f
    buffer_load_dword v12, v10, s[20:23], 0 offen sc1
Lco_c:
    s_waitcnt vmcnt(0)
    v_cmp_eq_u32 vcc, s76, v12
    s_nop 0
    s_or_b32 s79, s79, vcc_lo
    s_and_b32 s79, s79, 4177920
    s_cmp_eq_u32 s79, 4177920
    s_cbranch_scc0 Lco_s
    s_branch Lco_k
Lco_f:
    s_waitcnt vmcnt(0)
    buffer_store_dword v13, v0, s[20:23], 0 offen offset:28
    buffer_store_dword v13, v0, s[20:23], 0 offen offset:156 sc1
    buffer_load_dword v12, v10, s[20:23], 0 offen offset:128 sc1
    s_branch Lco_c
Lch1_p:
Lch1_s:
    s_sub_u32 s77, s77, 1
    s_cbranch_scc1 Lfail
    s_and_b32 s41, s77, 7
    s_cbranch_scc0 Lch1_f
    buffer_load_dword v12, v10, s[20:23], 0 offen sc1
Lch1_c:
    s_waitcnt vmcnt(0)
    v_cmp_eq_u32 vcc, s76, v12
    s_nop 0
    s_or_b32 s79, s79, vcc_lo
    s_and_b32 s79, s79, 16256
    s_cmp_eq_u32 s79, 16256
    s_cbranch_scc0 Lch1_s
    s_branch Lch1_k
Lch1_f:
    s_waitcnt vmcnt(0)
    buffer_store_dword v13, v0, s[20:23], 0 offen offset:28
    buffer_store_dword v13, v0, s[20:23], 0 offen offset:156 sc1
    buffer_load_dword v12, v10, s[20:23], 0 offen offset:128 sc1
    s_branch Lch1_c
Lextra:
    s_cmp_ge_u32 s2, 248
    s_cbranch_scc1 Lend
    s_load_dwordx2 s[12:13], s[0:1], 48
    s_load_dwordx2 s[16:17], s[0:1], 16
    s_mov_b32 s14, 1605632
    s_mov_b32 s15, 0x00020000
    s_mov_b32 s18, 401408
    s_mov_b32 s19, 0x00020000
    s_cmp_eq_u32 s2, 240
    s_cbranch_scc1 Lhelp0
    s_sub_u32 s49, s2, 241
    s_lshl_b32 s49, s49, 15
    v_lshl_add_u32 v8, v0, 7, s49
    s_waitcnt lgkmcnt(0)
    buffer_load_dword v9, v8, s[16:19], 0 offen
    v_add_u32 v8, 229376, v8
    buffer_load_dword v9, v8, s[16:19], 0 offen
    v_add_u32 v8, 229376, v8
    v_lshl_add_u32 v8, v0, 7, s49
    buffer_load_dword v9, v8, s[12:15], 0 offen
    v_add_u32 v8, 229376, v8
    buffer_load_dword v9, v8, s[12:15], 0 offen
    v_add_u32 v8, 229376, v8
    buffer_load_dword v9, v8, s[12:15], 0 offen
    v_add_u32 v8, 229376, v8
    buffer_load_dword v9, v8, s[12:15], 0 offen
    v_add_u32 v8, 229376, v8
    buffer_load_dword v9, v8, s[12:15], 0 offen
    v_add_u32 v8, 229376, v8
    buffer_load_dword v9, v8, s[12:15], 0 offen
    v_add_u32 v8, 229376, v8
    buffer_load_dword v9, v8, s[12:15], 0 offen
    v_add_u32 v8, 229376, v8
    s_load_dwordx2 s[28:29], s[0:1], 40
    s_load_dwordx2 s[32:33], s[0:1], 56
    s_mov_b32 s30, 3584
    s_mov_b32 s31, 0x00020000
    s_mov_b32 s34, 896
    s_mov_b32 s35, 0x00020000
    v_lshlrev_b32 v8, 7, v0
    s_waitcnt lgkmcnt(0)
    buffer_load_dword v9, v8, s[32:35], 0 offen
    s_waitcnt vmcnt(0)
    s_endpgm
Lhelp0:
    s_load_dwordx2 s[20:21], s[0:1], 80
    s_load_dwordx2 s[36:37], s[0:1], 72
    s_mov_b32 s22, 268435456
    s_mov_b32 s23, 0x00020000
    s_mov_b32 s38, 256
    s_mov_b32 s39, 0x00020000
    v_cmp_eq_u32 vcc, 0, v0
    v_mov_b32 v2, 2146435072
    s_mov_b32 s49, 12599296
    v_cndmask_b32 v2, v2, 0, vcc
    s_waitcnt lgkmcnt(0)
    buffer_load_dword v3, v2, s[20:23], s49 offen sc1
    v_lshlrev_b32 v5, 7, v0
    v_min_u32 v5, 16256, v5
    s_mov_b32 s50, 12582912
    v_mov_b32 v4, 0x9E3779B1
    s_waitcnt vmcnt(0)
    v_mul_lo_u32 v3, v3, v4
    v_add_u32 v3, 0x7F4A7C15, v3
    v_max_u32 v3, 1, v3
    buffer_store_dword v3, v2, s[20:23], s49 offen sc1
    s_waitcnt vmcnt(0)
    buffer_store_dword v3, v2, s[36:39], 0 offen sc1
    buffer_load_dword v6, v5, s[20:23], s50 offen sc1
    s_waitcnt vmcnt(0)
    s_endpgm
Lcode_end:
.section .rodata,"a"
.p2align 6
.amdhsa_kernel parallel_sum__sliding_local_dilated__mixer_channel_mlp__prompt_kernel
      .amdhsa_next_free_vgpr 512
      .amdhsa_next_free_sgpr 102
      .amdhsa_accum_offset 256
      .amdhsa_group_segment_fixed_size 0
      .amdhsa_kernarg_size 88
      .amdhsa_user_sgpr_count 2
      .amdhsa_user_sgpr_kernarg_segment_ptr 1
      .amdhsa_system_sgpr_workgroup_id_x 1
.end_amdhsa_kernel
```
